```python
import torch

def _softmax(x, axis=-1):
    return torch.softmax(x, dim=axis)
def _gelu(x):
    return torch.nn.functional.gelu(x, approximate="tanh")
def _silu(x):
    return torch.nn.functional.silu(x)
def _sigmoid(x):
    return torch.sigmoid(x)
def _layernorm(x, axis=-1, eps=1e-5):
    m = x.mean(dim=axis, keepdim=True)
    v = x.var(dim=axis, keepdim=True, unbiased=False)
    return (x - m) / torch.sqrt(v + eps)
def _scatter_add(tgt, idx, src, axis=0):
    return tgt.clone().index_add_(axis, idx, src)
def _segment_sum(src, seg, n):
    out = torch.zeros((n,) + src.shape[1:], dtype=src.dtype)
    return out.index_add_(0, seg, src)
def _pad(x, pw):
    flat = tuple(v for pair in reversed(pw) for v in pair)
    return torch.nn.functional.pad(x, flat)

kernel_name = 'interleave_layers__spectral_gfnet__grouped_kv_mqa__prompt'

def setup_inputs():

    _w = (lambda a: (lambda t: t.to(torch.bfloat16) if t.is_floating_point() else t)(torch.as_tensor(a)))
    def _A_setup():
        B, S, D = 1, 2048, 576
        Df = D // 2 + 1
        return {
            "x": _w((lambda *s: torch.randn(*s, dtype=torch.bfloat16) * 0.05)(B, S, D)),
            "w_r": _w((lambda *s: torch.randn(*s, dtype=torch.bfloat16) * 1.6)(S, Df) * 0.02),
            "w_i": _w((lambda *s: torch.randn(*s, dtype=torch.bfloat16) * 1.6)(S, Df) * 0.02),
        }
    _A_in = _A_setup()

    def _B_setup():
        B, S, D, H = 1, 2048, 576, 32
        Dh = D // H
        return {
            "x": _w((lambda *s: torch.randn(*s, dtype=torch.bfloat16) * 0.05)(B, S, D)),
            "wq": _w((lambda *s: torch.randn(*s, dtype=torch.bfloat16) * 0.05)(D, H * Dh)),
            "wk": _w((lambda *s: torch.randn(*s, dtype=torch.bfloat16) * 0.05)(D, Dh)),
            "wv": _w((lambda *s: torch.randn(*s, dtype=torch.bfloat16) * 0.05)(D, Dh)),
            "wo": _w((lambda *s: torch.randn(*s, dtype=torch.bfloat16) * 0.05)(H * Dh, D)),
        }
    _B_in = _B_setup()

    return {
        "A_x": _A_in["x"],
        "A_w_r": _A_in["w_r"],
        "A_w_i": _A_in["w_i"],
        "B_x": _B_in["x"],
        "B_wq": _B_in["wq"],
        "B_wk": _B_in["wk"],
        "B_wv": _B_in["wv"],
        "B_wo": _B_in["wo"],
    }

def reference(A_x, A_w_r, A_w_i, B_x, B_wq, B_wk, B_wv, B_wo):
    def _A_ref(x, w_r, w_i):
        B, S, D = x.shape
        X = (lambda x, axes=(-2,-1): torch.fft.rfft2(x.float(), dim=axes))(x, axes=(-2, -1))
        W = w_r + 1j * w_i
        X = X * W
        y = (lambda x, s, axes=(-2,-1): torch.fft.irfft2(x, s=s, dim=axes).to(torch.bfloat16))(X, (S, D), axes=(-2, -1))
        return y

    def _B_ref(x, wq, wk, wv, wo):
        B, S, D = x.shape
        H = 32
        Dh = D // H
        q = (lambda x, *d: x.permute(*d))((x @ wq).reshape(B, S, H, Dh), 0, 2, 1, 3)
        k = x @ wk
        v = x @ wv
        scores = torch.einsum("bhqd,bkd->bhqk", q, k) * (Dh ** -0.5)
        p = _softmax(scores, axis=-1)
        o = torch.einsum("bhqk,bkd->bhqd", p, v)
        return (lambda x, *d: x.permute(*d))(o, 0, 2, 1, 3).reshape(B, S, H * Dh) @ wo

    x = A_x
    x = x + _A_ref(_layernorm(x, axis=-1), A_w_r, A_w_i)
    x = x + _B_ref(_layernorm(x, axis=-1), B_wq, B_wk, B_wv, B_wo)
    x = x + _A_ref(_layernorm(x, axis=-1), A_w_r, A_w_i)
    x = x + _B_ref(_layernorm(x, axis=-1), B_wq, B_wk, B_wv, B_wo)
    return x
```

```asm
; @launch grid=(256,1,1) block=(512,1,1) lds=163840
.amdgcn_target "amdgcn-amd-amdhsa--gfx950"
.text
.globl interleave_layers__spectral_gfnet__grouped_kv_mqa__prompt_kernel
.p2align 8
.type interleave_layers__spectral_gfnet__grouped_kv_mqa__prompt_kernel,@function
interleave_layers__spectral_gfnet__grouped_kv_mqa__prompt_kernel:
L_code_begin:
  s_cmp_ge_u32 s2, 256
  s_cbranch_scc1 L_end
  s_getpc_b64 s[36:37]
  s_and_b32 s36, s36, 0xffffff00
  s_mov_b32 s38, L_code_end-L_code_begin
  s_mov_b32 s39, 0x20000
  s_lshr_b32 s3, s2, 3
  s_lshl_b32 s3, s3, 11
  v_lshlrev_b32 v4, 2, v0
  v_add_u32 v4, s3, v4
  buffer_load_dword v253, v4, s[36:39], 0 offen
  s_load_dwordx4 s[4:7], s[0:1], 0
  s_load_dwordx2 s[8:9], s[0:1], 16
  s_load_dwordx8 s[12:19], s[0:1], 32
  s_load_dwordx4 s[20:23], s[0:1], 64
  s_load_dwordx2 s[24:25], s[0:1], 80
  v_and_b32 v1, 63, v0
  v_lshrrev_b32 v4, 6, v0
  v_and_b32 v2, 15, v0
  v_lshrrev_b32 v3, 4, v1
  v_readfirstlane_b32 s26, v4
  s_and_b32 s48, s2, 7
  s_lshr_b32 s49, s2, 3
  s_lshl_b32 s48, s48, 3
  s_lshr_b32 s50, s49, 2
  s_add_u32 s27, s48, s50
  s_and_b32 s44, s49, 3
  s_mov_b32 s45, 0
  s_mul_i32 s56, s44, 9
  s_add_u32 s60, s56, s26
  s_lshl_b32 s50, s60, 4
  v_add_u32 v4, s50, v2
  v_lshrrev_b32 v5, 1, v4
  v_and_b32 v6, 1, v4
  v_mul_u32_u24 v6, 144, v6
  v_mov_b32 v7, 0x3d715bef
  s_cmp_lg_u32 s60, 0
  s_cbranch_scc1 L_ftsp_1
  v_cmp_gt_u32 vcc, 2, v4
  v_mov_b32 v8, 0x3d2aaaab
  s_nop 0
  v_cndmask_b32 v7, v7, v8, vcc
  v_mov_b32 v8, 0
  v_cndmask_b32 v6, v6, v8, vcc
  v_cmp_eq_u32 vcc, 0, v4
  v_mov_b32 v8, 288
  s_nop 0
  v_cndmask_b32 v5, v5, v8, vcc
L_ftsp_1:
  s_mov_b32 s51, 7456541
  v_lshlrev_b32 v10, 3, v3
  v_mul_u32_u24 v10, v5, v10
  v_add_u32 v10, v10, v6
  v_mul_hi_u32 v9, v10, s51
  v_mul_u32_u24 v9, 576, v9
  v_sub_u32 v10, v10, v9
  v_lshlrev_b32 v11, 5, v5
  v_mul_hi_u32 v9, v11, s51
  v_mul_u32_u24 v9, 576, v9
  v_sub_u32 v11, v11, v9
  v_add_u32 v9, v11, v11
  v_subrev_u32 v8, 576, v9
  v_min_u32 v12, v9, v8
  v_sub_u32 v13, 576, v11
  v_sub_u32 v14, 576, v12
  v_mov_b32 v16, v10
  v_add_u32 v9, v10, v11
  v_subrev_u32 v8, 576, v9
  v_min_u32 v17, v9, v8
  v_add_u32 v9, v10, v5
  v_subrev_u32 v8, 576, v9
  v_min_u32 v18, v9, v8
  v_add_u32 v9, v17, v5
  v_subrev_u32 v8, 576, v9
  v_min_u32 v19, v9, v8
  v_add_u32 v9, v10, v14
  v_subrev_u32 v8, 576, v9
  v_min_u32 v20, v9, v8
  v_add_u32 v9, v10, v13
  v_subrev_u32 v8, 576, v9
  v_min_u32 v21, v9, v8
  v_add_u32 v9, v20, v5
  v_subrev_u32 v8, 576, v9
  v_min_u32 v22, v9, v8
  v_add_u32 v9, v21, v5
  v_subrev_u32 v8, 576, v9
  v_min_u32 v23, v9, v8
  v_mov_b32 v24, v5
  v_mov_b32 v25, v12
  v_cvt_f32_u32 v16, v16
  v_cvt_f32_u32 v17, v17
  v_cvt_f32_u32 v18, v18
  v_cvt_f32_u32 v19, v19
  v_cvt_f32_u32 v20, v20
  v_cvt_f32_u32 v21, v21
  v_cvt_f32_u32 v22, v22
  v_cvt_f32_u32 v23, v23
  v_cvt_f32_u32 v24, v24
  v_cvt_f32_u32 v25, v25
  v_mul_f32 v16, 0x3ae38e39, v16
  v_mul_f32 v17, 0x3ae38e39, v17
  v_mul_f32 v18, 0x3ae38e39, v18
  v_mul_f32 v19, 0x3ae38e39, v19
  v_mul_f32 v20, 0x3ae38e39, v20
  v_mul_f32 v21, 0x3ae38e39, v21
  v_mul_f32 v22, 0x3ae38e39, v22
  v_mul_f32 v23, 0x3ae38e39, v23
  v_mul_f32 v24, 0x3ae38e39, v24
  v_mul_f32 v25, 0x3ae38e39, v25
  v_cos_f32 v16, v16
  v_cos_f32 v17, v17
  v_cos_f32 v18, v18
  v_cos_f32 v19, v19
  v_cos_f32 v20, v20
  v_cos_f32 v21, v21
  v_cos_f32 v22, v22
  v_cos_f32 v23, v23
  v_cos_f32 v24, v24
  v_cos_f32 v25, v25
  v_mul_f32 v16, v16, v7
  v_mul_f32 v17, v17, v7
  v_mul_f32 v18, v18, v7
  v_mul_f32 v19, v19, v7
  v_mul_f32 v20, v20, v7
  v_mul_f32 v21, v21, v7
  v_mul_f32 v22, v22, v7
  v_mul_f32 v23, v23, v7
  v_add_f32 v24, v24, v24
  v_add_f32 v25, v25, v25
  v_pk_fma_f32 v[30:31], v[24:25], v[18:19], v[16:17] op_sel:[0,0,0] op_sel_hi:[0,1,1] neg_lo:[0,0,1] neg_hi:[0,0,1]
  v_pk_fma_f32 v[26:27], v[24:25], v[16:17], v[20:21] op_sel:[1,0,0] op_sel_hi:[1,1,1] neg_lo:[0,0,1] neg_hi:[0,0,1]
  v_cvt_pk_bf16_f32 v64, v16, v18
  v_pk_fma_f32 v[32:33], v[24:25], v[30:31], v[18:19] op_sel:[0,0,0] op_sel_hi:[0,1,1] neg_lo:[0,0,1] neg_hi:[0,0,1]
  v_pk_fma_f32 v[28:29], v[24:25], v[18:19], v[22:23] op_sel:[1,0,0] op_sel_hi:[1,1,1] neg_lo:[0,0,1] neg_hi:[0,0,1]
  v_cvt_pk_bf16_f32 v68, v17, v19
  v_pk_fma_f32 v[34:35], v[24:25], v[32:33], v[30:31] op_sel:[0,0,0] op_sel_hi:[0,1,1] neg_lo:[0,0,1] neg_hi:[0,0,1]
  v_pk_fma_f32 v[36:37], v[24:25], v[34:35], v[32:33] op_sel:[0,0,0] op_sel_hi:[0,1,1] neg_lo:[0,0,1] neg_hi:[0,0,1]
  v_cvt_pk_bf16_f32 v65, v30, v32
  v_cvt_pk_bf16_f32 v69, v31, v33
  v_pk_fma_f32 v[38:39], v[24:25], v[36:37], v[34:35] op_sel:[0,0,0] op_sel_hi:[0,1,1] neg_lo:[0,0,1] neg_hi:[0,0,1]
  v_cvt_pk_bf16_f32 v66, v34, v36
  v_pk_fma_f32 v[40:41], v[24:25], v[38:39], v[36:37] op_sel:[0,0,0] op_sel_hi:[0,1,1] neg_lo:[0,0,1] neg_hi:[0,0,1]
  v_cvt_pk_bf16_f32 v70, v35, v37
  v_cvt_pk_bf16_f32 v67, v38, v40
  v_cvt_pk_bf16_f32 v71, v39, v41
  v_pk_fma_f32 v[30:31], v[24:25], v[28:29], v[26:27] op_sel:[0,0,0] op_sel_hi:[0,1,1] neg_lo:[0,0,1] neg_hi:[0,0,1]
  v_pk_fma_f32 v[20:21], v[24:25], v[26:27], v[16:17] op_sel:[1,0,0] op_sel_hi:[1,1,1] neg_lo:[0,0,1] neg_hi:[0,0,1]
  v_cvt_pk_bf16_f32 v72, v26, v28
  v_pk_fma_f32 v[32:33], v[24:25], v[30:31], v[28:29] op_sel:[0,0,0] op_sel_hi:[0,1,1] neg_lo:[0,0,1] neg_hi:[0,0,1]
  v_pk_fma_f32 v[22:23], v[24:25], v[28:29], v[18:19] op_sel:[1,0,0] op_sel_hi:[1,1,1] neg_lo:[0,0,1] neg_hi:[0,0,1]
  v_cvt_pk_bf16_f32 v76, v27, v29
  v_pk_fma_f32 v[34:35], v[24:25], v[32:33], v[30:31] op_sel:[0,0,0] op_sel_hi:[0,1,1] neg_lo:[0,0,1] neg_hi:[0,0,1]
  v_pk_fma_f32 v[36:37], v[24:25], v[34:35], v[32:33] op_sel:[0,0,0] op_sel_hi:[0,1,1] neg_lo:[0,0,1] neg_hi:[0,0,1]
  v_cvt_pk_bf16_f32 v73, v30, v32
  v_cvt_pk_bf16_f32 v77, v31, v33
  v_pk_fma_f32 v[38:39], v[24:25], v[36:37], v[34:35] op_sel:[0,0,0] op_sel_hi:[0,1,1] neg_lo:[0,0,1] neg_hi:[0,0,1]
  v_cvt_pk_bf16_f32 v74, v34, v36
  v_pk_fma_f32 v[40:41], v[24:25], v[38:39], v[36:37] op_sel:[0,0,0] op_sel_hi:[0,1,1] neg_lo:[0,0,1] neg_hi:[0,0,1]
  v_cvt_pk_bf16_f32 v78, v35, v37
  v_cvt_pk_bf16_f32 v75, v38, v40
  v_cvt_pk_bf16_f32 v79, v39, v41
  s_waitcnt lgkmcnt(0)
  s_mov_b32 s28, s24
  s_mov_b32 s29, s25
  s_mov_b32 s30, 19603456
  s_mov_b32 s31, 0x20000
  s_cmp_lg_u32 s2, 0
  s_cbranch_scc1 L_nozero_2
  v_mov_b32 v12, 0
  v_lshlrev_b32 v9, 8, v0
  buffer_store_dword v12, v9, s[28:31], 0 offen sc1
L_nozero_2:
  s_mov_b32 s32, s4
  s_mov_b32 s33, s5
  s_mov_b32 s34, 2359296
  s_mov_b32 s35, 0x20000
  v_lshrrev_b32 v6, 3, v1
  s_lshl_b32 s50, s27, 5
  v_add_u32 v4, s50, v6
  v_mul_u32_u24 v4, 1152, v4
  v_and_b32 v7, 7, v1
  v_xor_b32 v7, v7, v6
  v_lshl_add_u32 v4, v7, 4, v4
  s_add_u32 s50, s26, 0
  s_mul_hi_u32 s51, s50, 477218589
  s_mul_i32 s52, s51, 9
  s_sub_u32 s52, s50, s52
  s_lshl_b32 s52, s52, 7
  s_mul_i32 s51, s51, 9216
  s_add_u32 s51, s51, s52
  s_lshl_b32 m0, s50, 10
  s_nop 0
  buffer_load_dwordx4 v4, s[32:35], s51 offen lds
  s_add_u32 s50, s26, 8
  s_mul_hi_u32 s51, s50, 477218589
  s_mul_i32 s52, s51, 9
  s_sub_u32 s52, s50, s52
  s_lshl_b32 s52, s52, 7
  s_mul_i32 s51, s51, 9216
  s_add_u32 s51, s51, s52
  s_lshl_b32 m0, s50, 10
  s_nop 0
  buffer_load_dwordx4 v4, s[32:35], s51 offen lds
  s_add_u32 s50, s26, 16
  s_mul_hi_u32 s51, s50, 477218589
  s_mul_i32 s52, s51, 9
  s_sub_u32 s52, s50, s52
  s_lshl_b32 s52, s52, 7
  s_mul_i32 s51, s51, 9216
  s_add_u32 s51, s51, s52
  s_lshl_b32 m0, s50, 10
  s_nop 0
  buffer_load_dwordx4 v4, s[32:35], s51 offen lds
  s_add_u32 s50, s26, 24
  s_mul_hi_u32 s51, s50, 477218589
  s_mul_i32 s52, s51, 9
  s_sub_u32 s52, s50, s52
  s_lshl_b32 s52, s52, 7
  s_mul_i32 s51, s51, 9216
  s_add_u32 s51, s51, s52
  s_lshl_b32 m0, s50, 10
  s_nop 0
  buffer_load_dwordx4 v4, s[32:35], s51 offen lds
  s_cmp_ge_u32 s26, 4
  s_cbranch_scc1 L_p0dma_3
  s_add_u32 s50, s26, 32
  s_mul_hi_u32 s51, s50, 477218589
  s_mul_i32 s52, s51, 9
  s_sub_u32 s52, s50, s52
  s_lshl_b32 s52, s52, 7
  s_mul_i32 s51, s51, 9216
  s_add_u32 s51, s51, s52
  s_lshl_b32 m0, s50, 10
  s_nop 0
  buffer_load_dwordx4 v4, s[32:35], s51 offen lds
L_p0dma_3:
  s_mov_b32 s32, s6
  s_mov_b32 s33, s7
  s_mov_b32 s34, 1183744
  s_mov_b32 s35, 0x20000
  s_mov_b32 s36, s8
  s_mov_b32 s37, s9
  s_mov_b32 s38, 1183744
  s_mov_b32 s39, 0x20000
  s_lshr_b32 s50, s2, 2
  s_and_b32 s51, s2, 3
  s_lshr_b32 s52, s50, 3
  s_and_b32 s53, s50, 7
  s_lshl_b32 s53, s53, 3
  s_add_u32 s52, s52, s53
  s_lshl_b32 s53, s26, 6
  s_add_u32 s52, s52, s53
  s_mul_i32 s52, s52, 578
  s_mul_i32 s54, s51, 72
  s_lshl_b32 s55, s50, 7
  s_lshl_b32 s58, s54, 13
  s_add_u32 s55, s55, s58
  s_add_u32 s77, s55, 9633792
  v_add_u32 v9, s54, v1
  v_cmp_eq_u32 vcc, 0, v9
  v_mov_b32 v10, 288
  s_nop 0
  v_cndmask_b32 v10, v9, v10, vcc
  v_lshlrev_b32 v10, 1, v10
  v_lshrrev_b32 v11, 3, v1
  v_and_b32 v11, 3, v11
  v_mul_u32_u24 v11, 147968, v11
  v_and_b32 v12, 7, v1
  v_add_u32 v11, v11, v12
  s_add_u32 s59, s54, 64
  v_add_u32 v11, s59, v11
  v_lshlrev_b32 v11, 1, v11
  s_add_u32 s59, s52, 0
  buffer_load_ushort v208, v10, s[32:35], s59 offen
  buffer_load_ushort v220, v10, s[36:39], s59 offen
  s_add_u32 s59, s52, 295936
  buffer_load_ushort v209, v10, s[32:35], s59 offen
  buffer_load_ushort v221, v10, s[36:39], s59 offen
  s_add_u32 s59, s52, 591872
  buffer_load_ushort v210, v10, s[32:35], s59 offen
  buffer_load_ushort v222, v10, s[36:39], s59 offen
  s_add_u32 s59, s52, 887808
  buffer_load_ushort v211, v10, s[32:35], s59 offen
  buffer_load_ushort v223, v10, s[36:39], s59 offen
  s_mov_b32 exec_hi, 0
  buffer_load_ushort v212, v11, s[32:35], s52 offen
  buffer_load_ushort v224, v11, s[36:39], s52 offen
  s_mov_b64 exec, -1
  v_pk_fma_f32 v[30:31], v[24:25], v[22:23], v[20:21] op_sel:[0,0,0] op_sel_hi:[0,1,1] neg_lo:[0,0,1] neg_hi:[0,0,1]
  v_pk_fma_f32 v[16:17], v[24:25], v[20:21], v[26:27] op_sel:[1,0,0] op_sel_hi:[1,1,1] neg_lo:[0,0,1] neg_hi:[0,0,1]
  v_cvt_pk_bf16_f32 v80, v20, v22
  v_pk_fma_f32 v[32:33], v[24:25], v[30:31], v[22:23] op_sel:[0,0,0] op_sel_hi:[0,1,1] neg_lo:[0,0,1] neg_hi:[0,0,1]
  v_pk_fma_f32 v[18:19], v[24:25], v[22:23], v[28:29] op_sel:[1,0,0] op_sel_hi:[1,1,1] neg_lo:[0,0,1] neg_hi:[0,0,1]
  v_cvt_pk_bf16_f32 v84, v21, v23
  v_pk_fma_f32 v[34:35], v[24:25], v[32:33], v[30:31] op_sel:[0,0,0] op_sel_hi:[0,1,1] neg_lo:[0,0,1] neg_hi:[0,0,1]
  v_pk_fma_f32 v[36:37], v[24:25], v[34:35], v[32:33] op_sel:[0,0,0] op_sel_hi:[0,1,1] neg_lo:[0,0,1] neg_hi:[0,0,1]
  v_cvt_pk_bf16_f32 v81, v30, v32
  v_cvt_pk_bf16_f32 v85, v31, v33
  v_pk_fma_f32 v[38:39], v[24:25], v[36:37], v[34:35] op_sel:[0,0,0] op_sel_hi:[0,1,1] neg_lo:[0,0,1] neg_hi:[0,0,1]
  v_cvt_pk_bf16_f32 v82, v34, v36
  v_pk_fma_f32 v[40:41], v[24:25], v[38:39], v[36:37] op_sel:[0,0,0] op_sel_hi:[0,1,1] neg_lo:[0,0,1] neg_hi:[0,0,1]
  v_cvt_pk_bf16_f32 v86, v35, v37
  v_cvt_pk_bf16_f32 v83, v38, v40
  v_cvt_pk_bf16_f32 v87, v39, v41
  v_pk_fma_f32 v[30:31], v[24:25], v[18:19], v[16:17] op_sel:[0,0,0] op_sel_hi:[0,1,1] neg_lo:[0,0,1] neg_hi:[0,0,1]
  v_pk_fma_f32 v[26:27], v[24:25], v[16:17], v[20:21] op_sel:[1,0,0] op_sel_hi:[1,1,1] neg_lo:[0,0,1] neg_hi:[0,0,1]
  v_cvt_pk_bf16_f32 v88, v16, v18
  v_pk_fma_f32 v[32:33], v[24:25], v[30:31], v[18:19] op_sel:[0,0,0] op_sel_hi:[0,1,1] neg_lo:[0,0,1] neg_hi:[0,0,1]
  v_pk_fma_f32 v[28:29], v[24:25], v[18:19], v[22:23] op_sel:[1,0,0] op_sel_hi:[1,1,1] neg_lo:[0,0,1] neg_hi:[0,0,1]
  v_cvt_pk_bf16_f32 v92, v17, v19
  v_pk_fma_f32 v[34:35], v[24:25], v[32:33], v[30:31] op_sel:[0,0,0] op_sel_hi:[0,1,1] neg_lo:[0,0,1] neg_hi:[0,0,1]
  v_pk_fma_f32 v[36:37], v[24:25], v[34:35], v[32:33] op_sel:[0,0,0] op_sel_hi:[0,1,1] neg_lo:[0,0,1] neg_hi:[0,0,1]
  v_cvt_pk_bf16_f32 v89, v30, v32
  v_cvt_pk_bf16_f32 v93, v31, v33
  v_pk_fma_f32 v[38:39], v[24:25], v[36:37], v[34:35] op_sel:[0,0,0] op_sel_hi:[0,1,1] neg_lo:[0,0,1] neg_hi:[0,0,1]
  v_cvt_pk_bf16_f32 v90, v34, v36
  v_pk_fma_f32 v[40:41], v[24:25], v[38:39], v[36:37] op_sel:[0,0,0] op_sel_hi:[0,1,1] neg_lo:[0,0,1] neg_hi:[0,0,1]
  v_cvt_pk_bf16_f32 v94, v35, v37
  v_cvt_pk_bf16_f32 v91, v38, v40
  v_cvt_pk_bf16_f32 v95, v39, v41
  v_pk_fma_f32 v[30:31], v[24:25], v[28:29], v[26:27] op_sel:[0,0,0] op_sel_hi:[0,1,1] neg_lo:[0,0,1] neg_hi:[0,0,1]
  v_pk_fma_f32 v[20:21], v[24:25], v[26:27], v[16:17] op_sel:[1,0,0] op_sel_hi:[1,1,1] neg_lo:[0,0,1] neg_hi:[0,0,1]
  v_cvt_pk_bf16_f32 v96, v26, v28
  v_pk_fma_f32 v[32:33], v[24:25], v[30:31], v[28:29] op_sel:[0,0,0] op_sel_hi:[0,1,1] neg_lo:[0,0,1] neg_hi:[0,0,1]
  v_pk_fma_f32 v[22:23], v[24:25], v[28:29], v[18:19] op_sel:[1,0,0] op_sel_hi:[1,1,1] neg_lo:[0,0,1] neg_hi:[0,0,1]
  v_cvt_pk_bf16_f32 v100, v27, v29
  v_pk_fma_f32 v[34:35], v[24:25], v[32:33], v[30:31] op_sel:[0,0,0] op_sel_hi:[0,1,1] neg_lo:[0,0,1] neg_hi:[0,0,1]
  v_pk_fma_f32 v[36:37], v[24:25], v[34:35], v[32:33] op_sel:[0,0,0] op_sel_hi:[0,1,1] neg_lo:[0,0,1] neg_hi:[0,0,1]
  v_cvt_pk_bf16_f32 v97, v30, v32
  v_cvt_pk_bf16_f32 v101, v31, v33
  v_pk_fma_f32 v[38:39], v[24:25], v[36:37], v[34:35] op_sel:[0,0,0] op_sel_hi:[0,1,1] neg_lo:[0,0,1] neg_hi:[0,0,1]
  v_cvt_pk_bf16_f32 v98, v34, v36
  v_pk_fma_f32 v[40:41], v[24:25], v[38:39], v[36:37] op_sel:[0,0,0] op_sel_hi:[0,1,1] neg_lo:[0,0,1] neg_hi:[0,0,1]
  v_cvt_pk_bf16_f32 v102, v35, v37
  v_cvt_pk_bf16_f32 v99, v38, v40
  v_cvt_pk_bf16_f32 v103, v39, v41
  v_pk_fma_f32 v[30:31], v[24:25], v[22:23], v[20:21] op_sel:[0,0,0] op_sel_hi:[0,1,1] neg_lo:[0,0,1] neg_hi:[0,0,1]
  v_pk_fma_f32 v[16:17], v[24:25], v[20:21], v[26:27] op_sel:[1,0,0] op_sel_hi:[1,1,1] neg_lo:[0,0,1] neg_hi:[0,0,1]
  v_cvt_pk_bf16_f32 v104, v20, v22
  v_pk_fma_f32 v[32:33], v[24:25], v[30:31], v[22:23] op_sel:[0,0,0] op_sel_hi:[0,1,1] neg_lo:[0,0,1] neg_hi:[0,0,1]
  v_pk_fma_f32 v[18:19], v[24:25], v[22:23], v[28:29] op_sel:[1,0,0] op_sel_hi:[1,1,1] neg_lo:[0,0,1] neg_hi:[0,0,1]
  v_cvt_pk_bf16_f32 v108, v21, v23
  v_pk_fma_f32 v[34:35], v[24:25], v[32:33], v[30:31] op_sel:[0,0,0] op_sel_hi:[0,1,1] neg_lo:[0,0,1] neg_hi:[0,0,1]
  v_pk_fma_f32 v[36:37], v[24:25], v[34:35], v[32:33] op_sel:[0,0,0] op_sel_hi:[0,1,1] neg_lo:[0,0,1] neg_hi:[0,0,1]
  v_cvt_pk_bf16_f32 v105, v30, v32
  v_cvt_pk_bf16_f32 v109, v31, v33
  v_pk_fma_f32 v[38:39], v[24:25], v[36:37], v[34:35] op_sel:[0,0,0] op_sel_hi:[0,1,1] neg_lo:[0,0,1] neg_hi:[0,0,1]
  v_cvt_pk_bf16_f32 v106, v34, v36
  v_pk_fma_f32 v[40:41], v[24:25], v[38:39], v[36:37] op_sel:[0,0,0] op_sel_hi:[0,1,1] neg_lo:[0,0,1] neg_hi:[0,0,1]
  v_cvt_pk_bf16_f32 v110, v35, v37
  v_cvt_pk_bf16_f32 v107, v38, v40
  v_cvt_pk_bf16_f32 v111, v39, v41
  v_pk_fma_f32 v[30:31], v[24:25], v[18:19], v[16:17] op_sel:[0,0,0] op_sel_hi:[0,1,1] neg_lo:[0,0,1] neg_hi:[0,0,1]
  v_pk_fma_f32 v[26:27], v[24:25], v[16:17], v[20:21] op_sel:[1,0,0] op_sel_hi:[1,1,1] neg_lo:[0,0,1] neg_hi:[0,0,1]
  v_cvt_pk_bf16_f32 v112, v16, v18
  v_pk_fma_f32 v[32:33], v[24:25], v[30:31], v[18:19] op_sel:[0,0,0] op_sel_hi:[0,1,1] neg_lo:[0,0,1] neg_hi:[0,0,1]
  v_pk_fma_f32 v[28:29], v[24:25], v[18:19], v[22:23] op_sel:[1,0,0] op_sel_hi:[1,1,1] neg_lo:[0,0,1] neg_hi:[0,0,1]
  v_cvt_pk_bf16_f32 v116, v17, v19
  v_pk_fma_f32 v[34:35], v[24:25], v[32:33], v[30:31] op_sel:[0,0,0] op_sel_hi:[0,1,1] neg_lo:[0,0,1] neg_hi:[0,0,1]
  v_pk_fma_f32 v[36:37], v[24:25], v[34:35], v[32:33] op_sel:[0,0,0] op_sel_hi:[0,1,1] neg_lo:[0,0,1] neg_hi:[0,0,1]
  v_cvt_pk_bf16_f32 v113, v30, v32
  v_cvt_pk_bf16_f32 v117, v31, v33
  v_pk_fma_f32 v[38:39], v[24:25], v[36:37], v[34:35] op_sel:[0,0,0] op_sel_hi:[0,1,1] neg_lo:[0,0,1] neg_hi:[0,0,1]
  v_cvt_pk_bf16_f32 v114, v34, v36
  v_pk_fma_f32 v[40:41], v[24:25], v[38:39], v[36:37] op_sel:[0,0,0] op_sel_hi:[0,1,1] neg_lo:[0,0,1] neg_hi:[0,0,1]
  v_cvt_pk_bf16_f32 v118, v35, v37
  v_cvt_pk_bf16_f32 v115, v38, v40
  v_cvt_pk_bf16_f32 v119, v39, v41
  v_pk_fma_f32 v[30:31], v[24:25], v[28:29], v[26:27] op_sel:[0,0,0] op_sel_hi:[0,1,1] neg_lo:[0,0,1] neg_hi:[0,0,1]
  v_pk_fma_f32 v[20:21], v[24:25], v[26:27], v[16:17] op_sel:[1,0,0] op_sel_hi:[1,1,1] neg_lo:[0,0,1] neg_hi:[0,0,1]
  v_cvt_pk_bf16_f32 v120, v26, v28
  v_pk_fma_f32 v[32:33], v[24:25], v[30:31], v[28:29] op_sel:[0,0,0] op_sel_hi:[0,1,1] neg_lo:[0,0,1] neg_hi:[0,0,1]
  v_pk_fma_f32 v[22:23], v[24:25], v[28:29], v[18:19] op_sel:[1,0,0] op_sel_hi:[1,1,1] neg_lo:[0,0,1] neg_hi:[0,0,1]
  v_cvt_pk_bf16_f32 v124, v27, v29
  v_pk_fma_f32 v[34:35], v[24:25], v[32:33], v[30:31] op_sel:[0,0,0] op_sel_hi:[0,1,1] neg_lo:[0,0,1] neg_hi:[0,0,1]
  v_pk_fma_f32 v[36:37], v[24:25], v[34:35], v[32:33] op_sel:[0,0,0] op_sel_hi:[0,1,1] neg_lo:[0,0,1] neg_hi:[0,0,1]
  v_cvt_pk_bf16_f32 v121, v30, v32
  v_cvt_pk_bf16_f32 v125, v31, v33
  v_pk_fma_f32 v[38:39], v[24:25], v[36:37], v[34:35] op_sel:[0,0,0] op_sel_hi:[0,1,1] neg_lo:[0,0,1] neg_hi:[0,0,1]
  v_cvt_pk_bf16_f32 v122, v34, v36
  v_pk_fma_f32 v[40:41], v[24:25], v[38:39], v[36:37] op_sel:[0,0,0] op_sel_hi:[0,1,1] neg_lo:[0,0,1] neg_hi:[0,0,1]
  v_cvt_pk_bf16_f32 v126, v35, v37
  v_cvt_pk_bf16_f32 v123, v38, v40
  v_cvt_pk_bf16_f32 v127, v39, v41
  v_pk_fma_f32 v[30:31], v[24:25], v[22:23], v[20:21] op_sel:[0,0,0] op_sel_hi:[0,1,1] neg_lo:[0,0,1] neg_hi:[0,0,1]
  v_cvt_pk_bf16_f32 v128, v20, v22
  v_pk_fma_f32 v[32:33], v[24:25], v[30:31], v[22:23] op_sel:[0,0,0] op_sel_hi:[0,1,1] neg_lo:[0,0,1] neg_hi:[0,0,1]
  v_cvt_pk_bf16_f32 v132, v21, v23
  v_pk_fma_f32 v[34:35], v[24:25], v[32:33], v[30:31] op_sel:[0,0,0] op_sel_hi:[0,1,1] neg_lo:[0,0,1] neg_hi:[0,0,1]
  v_pk_fma_f32 v[36:37], v[24:25], v[34:35], v[32:33] op_sel:[0,0,0] op_sel_hi:[0,1,1] neg_lo:[0,0,1] neg_hi:[0,0,1]
  v_cvt_pk_bf16_f32 v129, v30, v32
  v_cvt_pk_bf16_f32 v133, v31, v33
  v_pk_fma_f32 v[38:39], v[24:25], v[36:37], v[34:35] op_sel:[0,0,0] op_sel_hi:[0,1,1] neg_lo:[0,0,1] neg_hi:[0,0,1]
  v_cvt_pk_bf16_f32 v130, v34, v36
  v_pk_fma_f32 v[40:41], v[24:25], v[38:39], v[36:37] op_sel:[0,0,0] op_sel_hi:[0,1,1] neg_lo:[0,0,1] neg_hi:[0,0,1]
  v_cvt_pk_bf16_f32 v134, v35, v37
  v_cvt_pk_bf16_f32 v131, v38, v40
  v_cvt_pk_bf16_f32 v135, v39, v41
  s_cmp_ge_u32 s26, 2
  s_cbranch_scc1 L_p0nx_4
  s_mul_i32 s61, s44, 9
  s_add_u32 s61, s61, 8
  s_lshl_b32 s50, s61, 4
  v_add_u32 v4, s50, v2
  v_lshrrev_b32 v5, 1, v4
  v_and_b32 v6, 1, v4
  v_mul_u32_u24 v6, 144, v6
  v_mov_b32 v7, 0x3d715bef
  s_cmp_lg_u32 s61, 0
  s_cbranch_scc1 L_ftsp_5
  v_cmp_gt_u32 vcc, 2, v4
  v_mov_b32 v8, 0x3d2aaaab
  s_nop 0
  v_cndmask_b32 v7, v7, v8, vcc
  v_mov_b32 v8, 0
  v_cndmask_b32 v6, v6, v8, vcc
  v_cmp_eq_u32 vcc, 0, v4
  v_mov_b32 v8, 288
  s_nop 0
  v_cndmask_b32 v5, v5, v8, vcc
L_ftsp_5:
  s_mov_b32 s51, 7456541
  v_lshlrev_b32 v10, 3, v3
  v_mul_u32_u24 v10, v5, v10
  v_add_u32 v10, v10, v6
  v_mul_hi_u32 v9, v10, s51
  v_mul_u32_u24 v9, 576, v9
  v_sub_u32 v10, v10, v9
  v_lshlrev_b32 v11, 5, v5
  v_mul_hi_u32 v9, v11, s51
  v_mul_u32_u24 v9, 576, v9
  v_sub_u32 v11, v11, v9
  v_add_u32 v9, v11, v11
  v_subrev_u32 v8, 576, v9
  v_min_u32 v12, v9, v8
  v_sub_u32 v13, 576, v11
  v_sub_u32 v14, 576, v12
  v_mov_b32 v16, v10
  v_add_u32 v9, v10, v11
  v_subrev_u32 v8, 576, v9
  v_min_u32 v17, v9, v8
  v_add_u32 v9, v10, v5
  v_subrev_u32 v8, 576, v9
  v_min_u32 v18, v9, v8
  v_add_u32 v9, v17, v5
  v_subrev_u32 v8, 576, v9
  v_min_u32 v19, v9, v8
  v_add_u32 v9, v10, v14
  v_subrev_u32 v8, 576, v9
  v_min_u32 v20, v9, v8
  v_add_u32 v9, v10, v13
  v_subrev_u32 v8, 576, v9
  v_min_u32 v21, v9, v8
  v_add_u32 v9, v20, v5
  v_subrev_u32 v8, 576, v9
  v_min_u32 v22, v9, v8
  v_add_u32 v9, v21, v5
  v_subrev_u32 v8, 576, v9
  v_min_u32 v23, v9, v8
  v_mov_b32 v24, v5
  v_mov_b32 v25, v12
  v_cvt_f32_u32 v16, v16
  v_cvt_f32_u32 v17, v17
  v_cvt_f32_u32 v18, v18
  v_cvt_f32_u32 v19, v19
  v_cvt_f32_u32 v20, v20
  v_cvt_f32_u32 v21, v21
  v_cvt_f32_u32 v22, v22
  v_cvt_f32_u32 v23, v23
  v_cvt_f32_u32 v24, v24
  v_cvt_f32_u32 v25, v25
  v_mul_f32 v16, 0x3ae38e39, v16
  v_mul_f32 v17, 0x3ae38e39, v17
  v_mul_f32 v18, 0x3ae38e39, v18
  v_mul_f32 v19, 0x3ae38e39, v19
  v_mul_f32 v20, 0x3ae38e39, v20
  v_mul_f32 v21, 0x3ae38e39, v21
  v_mul_f32 v22, 0x3ae38e39, v22
  v_mul_f32 v23, 0x3ae38e39, v23
  v_mul_f32 v24, 0x3ae38e39, v24
  v_mul_f32 v25, 0x3ae38e39, v25
  v_cos_f32 v16, v16
  v_cos_f32 v17, v17
  v_cos_f32 v18, v18
  v_cos_f32 v19, v19
  v_cos_f32 v20, v20
  v_cos_f32 v21, v21
  v_cos_f32 v22, v22
  v_cos_f32 v23, v23
  v_cos_f32 v24, v24
  v_cos_f32 v25, v25
  v_mul_f32 v16, v16, v7
  v_mul_f32 v17, v17, v7
  v_mul_f32 v18, v18, v7
  v_mul_f32 v19, v19, v7
  v_mul_f32 v20, v20, v7
  v_mul_f32 v21, v21, v7
  v_mul_f32 v22, v22, v7
  v_mul_f32 v23, v23, v7
  v_add_f32 v24, v24, v24
  v_add_f32 v25, v25, v25
  v_pk_fma_f32 v[30:31], v[24:25], v[18:19], v[16:17] op_sel:[0,0,0] op_sel_hi:[0,1,1] neg_lo:[0,0,1] neg_hi:[0,0,1]
  v_pk_fma_f32 v[26:27], v[24:25], v[16:17], v[20:21] op_sel:[1,0,0] op_sel_hi:[1,1,1] neg_lo:[0,0,1] neg_hi:[0,0,1]
  v_cvt_pk_bf16_f32 v136, v16, v18
  v_pk_fma_f32 v[32:33], v[24:25], v[30:31], v[18:19] op_sel:[0,0,0] op_sel_hi:[0,1,1] neg_lo:[0,0,1] neg_hi:[0,0,1]
  v_pk_fma_f32 v[28:29], v[24:25], v[18:19], v[22:23] op_sel:[1,0,0] op_sel_hi:[1,1,1] neg_lo:[0,0,1] neg_hi:[0,0,1]
  v_cvt_pk_bf16_f32 v140, v17, v19
  v_pk_fma_f32 v[34:35], v[24:25], v[32:33], v[30:31] op_sel:[0,0,0] op_sel_hi:[0,1,1] neg_lo:[0,0,1] neg_hi:[0,0,1]
  v_pk_fma_f32 v[36:37], v[24:25], v[34:35], v[32:33] op_sel:[0,0,0] op_sel_hi:[0,1,1] neg_lo:[0,0,1] neg_hi:[0,0,1]
  v_cvt_pk_bf16_f32 v137, v30, v32
  v_cvt_pk_bf16_f32 v141, v31, v33
  v_pk_fma_f32 v[38:39], v[24:25], v[36:37], v[34:35] op_sel:[0,0,0] op_sel_hi:[0,1,1] neg_lo:[0,0,1] neg_hi:[0,0,1]
  v_cvt_pk_bf16_f32 v138, v34, v36
  v_pk_fma_f32 v[40:41], v[24:25], v[38:39], v[36:37] op_sel:[0,0,0] op_sel_hi:[0,1,1] neg_lo:[0,0,1] neg_hi:[0,0,1]
  v_cvt_pk_bf16_f32 v142, v35, v37
  v_cvt_pk_bf16_f32 v139, v38, v40
  v_cvt_pk_bf16_f32 v143, v39, v41
  v_pk_fma_f32 v[30:31], v[24:25], v[28:29], v[26:27] op_sel:[0,0,0] op_sel_hi:[0,1,1] neg_lo:[0,0,1] neg_hi:[0,0,1]
  v_pk_fma_f32 v[20:21], v[24:25], v[26:27], v[16:17] op_sel:[1,0,0] op_sel_hi:[1,1,1] neg_lo:[0,0,1] neg_hi:[0,0,1]
  v_cvt_pk_bf16_f32 v144, v26, v28
  v_pk_fma_f32 v[32:33], v[24:25], v[30:31], v[28:29] op_sel:[0,0,0] op_sel_hi:[0,1,1] neg_lo:[0,0,1] neg_hi:[0,0,1]
  v_pk_fma_f32 v[22:23], v[24:25], v[28:29], v[18:19] op_sel:[1,0,0] op_sel_hi:[1,1,1] neg_lo:[0,0,1] neg_hi:[0,0,1]
  v_cvt_pk_bf16_f32 v148, v27, v29
  v_pk_fma_f32 v[34:35], v[24:25], v[32:33], v[30:31] op_sel:[0,0,0] op_sel_hi:[0,1,1] neg_lo:[0,0,1] neg_hi:[0,0,1]
  v_pk_fma_f32 v[36:37], v[24:25], v[34:35], v[32:33] op_sel:[0,0,0] op_sel_hi:[0,1,1] neg_lo:[0,0,1] neg_hi:[0,0,1]
  v_cvt_pk_bf16_f32 v145, v30, v32
  v_cvt_pk_bf16_f32 v149, v31, v33
  v_pk_fma_f32 v[38:39], v[24:25], v[36:37], v[34:35] op_sel:[0,0,0] op_sel_hi:[0,1,1] neg_lo:[0,0,1] neg_hi:[0,0,1]
  v_cvt_pk_bf16_f32 v146, v34, v36
  v_pk_fma_f32 v[40:41], v[24:25], v[38:39], v[36:37] op_sel:[0,0,0] op_sel_hi:[0,1,1] neg_lo:[0,0,1] neg_hi:[0,0,1]
  v_cvt_pk_bf16_f32 v150, v35, v37
  v_cvt_pk_bf16_f32 v147, v38, v40
  v_cvt_pk_bf16_f32 v151, v39, v41
  v_pk_fma_f32 v[30:31], v[24:25], v[22:23], v[20:21] op_sel:[0,0,0] op_sel_hi:[0,1,1] neg_lo:[0,0,1] neg_hi:[0,0,1]
  v_pk_fma_f32 v[16:17], v[24:25], v[20:21], v[26:27] op_sel:[1,0,0] op_sel_hi:[1,1,1] neg_lo:[0,0,1] neg_hi:[0,0,1]
  v_cvt_pk_bf16_f32 v152, v20, v22
  v_pk_fma_f32 v[32:33], v[24:25], v[30:31], v[22:23] op_sel:[0,0,0] op_sel_hi:[0,1,1] neg_lo:[0,0,1] neg_hi:[0,0,1]
  v_pk_fma_f32 v[18:19], v[24:25], v[22:23], v[28:29] op_sel:[1,0,0] op_sel_hi:[1,1,1] neg_lo:[0,0,1] neg_hi:[0,0,1]
  v_cvt_pk_bf16_f32 v156, v21, v23
  v_pk_fma_f32 v[34:35], v[24:25], v[32:33], v[30:31] op_sel:[0,0,0] op_sel_hi:[0,1,1] neg_lo:[0,0,1] neg_hi:[0,0,1]
  v_pk_fma_f32 v[36:37], v[24:25], v[34:35], v[32:33] op_sel:[0,0,0] op_sel_hi:[0,1,1] neg_lo:[0,0,1] neg_hi:[0,0,1]
  v_cvt_pk_bf16_f32 v153, v30, v32
  v_cvt_pk_bf16_f32 v157, v31, v33
  v_pk_fma_f32 v[38:39], v[24:25], v[36:37], v[34:35] op_sel:[0,0,0] op_sel_hi:[0,1,1] neg_lo:[0,0,1] neg_hi:[0,0,1]
  v_cvt_pk_bf16_f32 v154, v34, v36
  v_pk_fma_f32 v[40:41], v[24:25], v[38:39], v[36:37] op_sel:[0,0,0] op_sel_hi:[0,1,1] neg_lo:[0,0,1] neg_hi:[0,0,1]
  v_cvt_pk_bf16_f32 v158, v35, v37
  v_cvt_pk_bf16_f32 v155, v38, v40
  v_cvt_pk_bf16_f32 v159, v39, v41
  v_pk_fma_f32 v[30:31], v[24:25], v[18:19], v[16:17] op_sel:[0,0,0] op_sel_hi:[0,1,1] neg_lo:[0,0,1] neg_hi:[0,0,1]
  v_pk_fma_f32 v[26:27], v[24:25], v[16:17], v[20:21] op_sel:[1,0,0] op_sel_hi:[1,1,1] neg_lo:[0,0,1] neg_hi:[0,0,1]
  v_cvt_pk_bf16_f32 v160, v16, v18
  v_pk_fma_f32 v[32:33], v[24:25], v[30:31], v[18:19] op_sel:[0,0,0] op_sel_hi:[0,1,1] neg_lo:[0,0,1] neg_hi:[0,0,1]
  v_pk_fma_f32 v[28:29], v[24:25], v[18:19], v[22:23] op_sel:[1,0,0] op_sel_hi:[1,1,1] neg_lo:[0,0,1] neg_hi:[0,0,1]
  v_cvt_pk_bf16_f32 v164, v17, v19
  v_pk_fma_f32 v[34:35], v[24:25], v[32:33], v[30:31] op_sel:[0,0,0] op_sel_hi:[0,1,1] neg_lo:[0,0,1] neg_hi:[0,0,1]
  v_pk_fma_f32 v[36:37], v[24:25], v[34:35], v[32:33] op_sel:[0,0,0] op_sel_hi:[0,1,1] neg_lo:[0,0,1] neg_hi:[0,0,1]
  v_cvt_pk_bf16_f32 v161, v30, v32
  v_cvt_pk_bf16_f32 v165, v31, v33
  v_pk_fma_f32 v[38:39], v[24:25], v[36:37], v[34:35] op_sel:[0,0,0] op_sel_hi:[0,1,1] neg_lo:[0,0,1] neg_hi:[0,0,1]
  v_cvt_pk_bf16_f32 v162, v34, v36
  v_pk_fma_f32 v[40:41], v[24:25], v[38:39], v[36:37] op_sel:[0,0,0] op_sel_hi:[0,1,1] neg_lo:[0,0,1] neg_hi:[0,0,1]
  v_cvt_pk_bf16_f32 v166, v35, v37
  v_cvt_pk_bf16_f32 v163, v38, v40
  v_cvt_pk_bf16_f32 v167, v39, v41
  v_pk_fma_f32 v[30:31], v[24:25], v[28:29], v[26:27] op_sel:[0,0,0] op_sel_hi:[0,1,1] neg_lo:[0,0,1] neg_hi:[0,0,1]
  v_pk_fma_f32 v[20:21], v[24:25], v[26:27], v[16:17] op_sel:[1,0,0] op_sel_hi:[1,1,1] neg_lo:[0,0,1] neg_hi:[0,0,1]
  v_cvt_pk_bf16_f32 v168, v26, v28
  v_pk_fma_f32 v[32:33], v[24:25], v[30:31], v[28:29] op_sel:[0,0,0] op_sel_hi:[0,1,1] neg_lo:[0,0,1] neg_hi:[0,0,1]
  v_pk_fma_f32 v[22:23], v[24:25], v[28:29], v[18:19] op_sel:[1,0,0] op_sel_hi:[1,1,1] neg_lo:[0,0,1] neg_hi:[0,0,1]
  v_cvt_pk_bf16_f32 v172, v27, v29
  v_pk_fma_f32 v[34:35], v[24:25], v[32:33], v[30:31] op_sel:[0,0,0] op_sel_hi:[0,1,1] neg_lo:[0,0,1] neg_hi:[0,0,1]
  v_pk_fma_f32 v[36:37], v[24:25], v[34:35], v[32:33] op_sel:[0,0,0] op_sel_hi:[0,1,1] neg_lo:[0,0,1] neg_hi:[0,0,1]
  v_cvt_pk_bf16_f32 v169, v30, v32
  v_cvt_pk_bf16_f32 v173, v31, v33
  v_pk_fma_f32 v[38:39], v[24:25], v[36:37], v[34:35] op_sel:[0,0,0] op_sel_hi:[0,1,1] neg_lo:[0,0,1] neg_hi:[0,0,1]
  v_cvt_pk_bf16_f32 v170, v34, v36
  v_pk_fma_f32 v[40:41], v[24:25], v[38:39], v[36:37] op_sel:[0,0,0] op_sel_hi:[0,1,1] neg_lo:[0,0,1] neg_hi:[0,0,1]
  v_cvt_pk_bf16_f32 v174, v35, v37
  v_cvt_pk_bf16_f32 v171, v38, v40
  v_cvt_pk_bf16_f32 v175, v39, v41
  v_pk_fma_f32 v[30:31], v[24:25], v[22:23], v[20:21] op_sel:[0,0,0] op_sel_hi:[0,1,1] neg_lo:[0,0,1] neg_hi:[0,0,1]
  v_pk_fma_f32 v[16:17], v[24:25], v[20:21], v[26:27] op_sel:[1,0,0] op_sel_hi:[1,1,1] neg_lo:[0,0,1] neg_hi:[0,0,1]
  v_cvt_pk_bf16_f32 v176, v20, v22
  v_pk_fma_f32 v[32:33], v[24:25], v[30:31], v[22:23] op_sel:[0,0,0] op_sel_hi:[0,1,1] neg_lo:[0,0,1] neg_hi:[0,0,1]
  v_pk_fma_f32 v[18:19], v[24:25], v[22:23], v[28:29] op_sel:[1,0,0] op_sel_hi:[1,1,1] neg_lo:[0,0,1] neg_hi:[0,0,1]
  v_cvt_pk_bf16_f32 v180, v21, v23
  v_pk_fma_f32 v[34:35], v[24:25], v[32:33], v[30:31] op_sel:[0,0,0] op_sel_hi:[0,1,1] neg_lo:[0,0,1] neg_hi:[0,0,1]
  v_pk_fma_f32 v[36:37], v[24:25], v[34:35], v[32:33] op_sel:[0,0,0] op_sel_hi:[0,1,1] neg_lo:[0,0,1] neg_hi:[0,0,1]
  v_cvt_pk_bf16_f32 v177, v30, v32
  v_cvt_pk_bf16_f32 v181, v31, v33
  v_pk_fma_f32 v[38:39], v[24:25], v[36:37], v[34:35] op_sel:[0,0,0] op_sel_hi:[0,1,1] neg_lo:[0,0,1] neg_hi:[0,0,1]
  v_cvt_pk_bf16_f32 v178, v34, v36
  v_pk_fma_f32 v[40:41], v[24:25], v[38:39], v[36:37] op_sel:[0,0,0] op_sel_hi:[0,1,1] neg_lo:[0,0,1] neg_hi:[0,0,1]
  v_cvt_pk_bf16_f32 v182, v35, v37
  v_cvt_pk_bf16_f32 v179, v38, v40
  v_cvt_pk_bf16_f32 v183, v39, v41
  v_pk_fma_f32 v[30:31], v[24:25], v[18:19], v[16:17] op_sel:[0,0,0] op_sel_hi:[0,1,1] neg_lo:[0,0,1] neg_hi:[0,0,1]
  v_pk_fma_f32 v[26:27], v[24:25], v[16:17], v[20:21] op_sel:[1,0,0] op_sel_hi:[1,1,1] neg_lo:[0,0,1] neg_hi:[0,0,1]
  v_cvt_pk_bf16_f32 v184, v16, v18
  v_pk_fma_f32 v[32:33], v[24:25], v[30:31], v[18:19] op_sel:[0,0,0] op_sel_hi:[0,1,1] neg_lo:[0,0,1] neg_hi:[0,0,1]
  v_pk_fma_f32 v[28:29], v[24:25], v[18:19], v[22:23] op_sel:[1,0,0] op_sel_hi:[1,1,1] neg_lo:[0,0,1] neg_hi:[0,0,1]
  v_cvt_pk_bf16_f32 v188, v17, v19
  v_pk_fma_f32 v[34:35], v[24:25], v[32:33], v[30:31] op_sel:[0,0,0] op_sel_hi:[0,1,1] neg_lo:[0,0,1] neg_hi:[0,0,1]
  v_pk_fma_f32 v[36:37], v[24:25], v[34:35], v[32:33] op_sel:[0,0,0] op_sel_hi:[0,1,1] neg_lo:[0,0,1] neg_hi:[0,0,1]
  v_cvt_pk_bf16_f32 v185, v30, v32
  v_cvt_pk_bf16_f32 v189, v31, v33
  v_pk_fma_f32 v[38:39], v[24:25], v[36:37], v[34:35] op_sel:[0,0,0] op_sel_hi:[0,1,1] neg_lo:[0,0,1] neg_hi:[0,0,1]
  v_cvt_pk_bf16_f32 v186, v34, v36
  v_pk_fma_f32 v[40:41], v[24:25], v[38:39], v[36:37] op_sel:[0,0,0] op_sel_hi:[0,1,1] neg_lo:[0,0,1] neg_hi:[0,0,1]
  v_cvt_pk_bf16_f32 v190, v35, v37
  v_cvt_pk_bf16_f32 v187, v38, v40
  v_cvt_pk_bf16_f32 v191, v39, v41
  v_pk_fma_f32 v[30:31], v[24:25], v[28:29], v[26:27] op_sel:[0,0,0] op_sel_hi:[0,1,1] neg_lo:[0,0,1] neg_hi:[0,0,1]
  v_pk_fma_f32 v[20:21], v[24:25], v[26:27], v[16:17] op_sel:[1,0,0] op_sel_hi:[1,1,1] neg_lo:[0,0,1] neg_hi:[0,0,1]
  v_cvt_pk_bf16_f32 v192, v26, v28
  v_pk_fma_f32 v[32:33], v[24:25], v[30:31], v[28:29] op_sel:[0,0,0] op_sel_hi:[0,1,1] neg_lo:[0,0,1] neg_hi:[0,0,1]
  v_pk_fma_f32 v[22:23], v[24:25], v[28:29], v[18:19] op_sel:[1,0,0] op_sel_hi:[1,1,1] neg_lo:[0,0,1] neg_hi:[0,0,1]
  v_cvt_pk_bf16_f32 v196, v27, v29
  v_pk_fma_f32 v[34:35], v[24:25], v[32:33], v[30:31] op_sel:[0,0,0] op_sel_hi:[0,1,1] neg_lo:[0,0,1] neg_hi:[0,0,1]
  v_pk_fma_f32 v[36:37], v[24:25], v[34:35], v[32:33] op_sel:[0,0,0] op_sel_hi:[0,1,1] neg_lo:[0,0,1] neg_hi:[0,0,1]
  v_cvt_pk_bf16_f32 v193, v30, v32
  v_cvt_pk_bf16_f32 v197, v31, v33
  v_pk_fma_f32 v[38:39], v[24:25], v[36:37], v[34:35] op_sel:[0,0,0] op_sel_hi:[0,1,1] neg_lo:[0,0,1] neg_hi:[0,0,1]
  v_cvt_pk_bf16_f32 v194, v34, v36
  v_pk_fma_f32 v[40:41], v[24:25], v[38:39], v[36:37] op_sel:[0,0,0] op_sel_hi:[0,1,1] neg_lo:[0,0,1] neg_hi:[0,0,1]
  v_cvt_pk_bf16_f32 v198, v35, v37
  v_cvt_pk_bf16_f32 v195, v38, v40
  v_cvt_pk_bf16_f32 v199, v39, v41
  v_pk_fma_f32 v[30:31], v[24:25], v[22:23], v[20:21] op_sel:[0,0,0] op_sel_hi:[0,1,1] neg_lo:[0,0,1] neg_hi:[0,0,1]
  v_cvt_pk_bf16_f32 v200, v20, v22
  v_pk_fma_f32 v[32:33], v[24:25], v[30:31], v[22:23] op_sel:[0,0,0] op_sel_hi:[0,1,1] neg_lo:[0,0,1] neg_hi:[0,0,1]
  v_cvt_pk_bf16_f32 v204, v21, v23
  v_pk_fma_f32 v[34:35], v[24:25], v[32:33], v[30:31] op_sel:[0,0,0] op_sel_hi:[0,1,1] neg_lo:[0,0,1] neg_hi:[0,0,1]
  v_pk_fma_f32 v[36:37], v[24:25], v[34:35], v[32:33] op_sel:[0,0,0] op_sel_hi:[0,1,1] neg_lo:[0,0,1] neg_hi:[0,0,1]
  v_cvt_pk_bf16_f32 v201, v30, v32
  v_cvt_pk_bf16_f32 v205, v31, v33
  v_pk_fma_f32 v[38:39], v[24:25], v[36:37], v[34:35] op_sel:[0,0,0] op_sel_hi:[0,1,1] neg_lo:[0,0,1] neg_hi:[0,0,1]
  v_cvt_pk_bf16_f32 v202, v34, v36
  v_pk_fma_f32 v[40:41], v[24:25], v[38:39], v[36:37] op_sel:[0,0,0] op_sel_hi:[0,1,1] neg_lo:[0,0,1] neg_hi:[0,0,1]
  v_cvt_pk_bf16_f32 v206, v35, v37
  v_cvt_pk_bf16_f32 v203, v38, v40
  v_cvt_pk_bf16_f32 v207, v39, v41
L_p0nx_4:
  s_mov_b32 s79, 0
  s_and_b32 s50, s26, 1
  v_and_b32 v4, 7, v2
  v_xor_b32 v5, v4, v3
  v_lshlrev_b32 v5, 4, v5
  v_lshl_add_u32 v5, v4, 7, v5
  v_lshrrev_b32 v6, 3, v2
  v_mul_u32_u24 v6, 9216, v6
  v_add_u32 v5, v5, v6
  s_mul_i32 s51, s50, 18432
  v_add_u32 v56, s51, v5
  v_xor_b32 v57, 64, v56
  s_sub_u32 s51, 18432, s51
  v_add_u32 v58, s51, v5
  v_xor_b32 v59, 64, v58
  s_mul_i32 s50, s27, 144
  s_mul_i32 s51, s44, 36
  s_add_u32 s50, s50, s51
  s_lshl_b32 s51, s26, 2
  s_add_u32 s51, s51, s50
  s_lshl_b32 s51, s51, 8
  s_add_u32 s80, s51, 131072
  s_add_u32 s52, s50, 32
  s_lshl_b32 s52, s52, 8
  s_add_u32 s81, s52, 131072
  s_lshl_b32 s50, s44, 13
  s_lshl_b32 s51, s27, 7
  s_add_u32 s50, s50, s51
  s_add_u32 s82, s50, 9568256
  s_and_b32 s53, s26, 1
  v_lshrrev_b32 v4, 1, v3
  v_xor_b32 v5, s53, v4
  v_lshlrev_b32 v6, 8, v3
  v_lshl_add_u32 v6, v2, 3, v6
  v_lshl_add_u32 v61, v5, 7, v6
  v_xor_b32 v62, 128, v61
  s_lshl_b32 s54, s26, 7
  s_lshl_b32 s55, s53, 6
  s_add_u32 s54, s54, s55
  s_add_u32 s54, s54, 161280
  v_lshlrev_b32 v63, 2, v2
  v_add_u32 v63, s54, v63
  s_waitcnt vmcnt(0) lgkmcnt(0)
  s_barrier
  s_or_b32 s50, s2, s26
  s_cmp_lg_u32 s50, 0
  s_cbranch_scc1 L_nogo_6
  s_mov_b32 s92, s22
  s_mov_b32 s93, s23
  s_mov_b32 s94, 256
  s_mov_b32 s95, 0x20000
  v_mov_b32 v9, 0
  v_mov_b32 v12, 1
  s_mov_b64 exec, 1
  buffer_store_dword v12, v9, s[92:95], 0 offen sc1
  s_mov_b64 exec, -1
  s_waitcnt vmcnt(0)
L_nogo_6:
  s_cmp_ge_u32 s26, 2
  s_cbranch_scc1 L_g_noex_7
  ds_read_b128 v[16:19], v56 offset:0
  ds_read_b128 v[20:23], v58 offset:0
  ds_read_b128 v[24:27], v57 offset:0
  ds_read_b128 v[28:31], v59 offset:0
  ds_read_b128 v[32:35], v56 offset:1024
  ds_read_b128 v[36:39], v58 offset:1024
  s_waitcnt lgkmcnt(4)
  v_mfma_f32_16x16x32_bf16 v[40:43], v[64:67], v[16:19], 0
  v_mfma_f32_16x16x32_bf16 v[44:47], v[64:67], v[20:23], 0
  v_mfma_f32_16x16x32_bf16 v[48:51], v[136:139], v[16:19], 0
  ds_read_b128 v[16:19], v57 offset:1024
  ds_read_b128 v[20:23], v59 offset:1024
  s_waitcnt lgkmcnt(4)
  v_mfma_f32_16x16x32_bf16 v[40:43], v[68:71], v[24:27], v[40:43]
  v_mfma_f32_16x16x32_bf16 v[44:47], v[68:71], v[28:31], v[44:47]
  v_mfma_f32_16x16x32_bf16 v[48:51], v[140:143], v[24:27], v[48:51]
  ds_read_b128 v[24:27], v56 offset:2048
  ds_read_b128 v[28:31], v58 offset:2048
  s_waitcnt lgkmcnt(4)
  v_mfma_f32_16x16x32_bf16 v[40:43], v[72:75], v[32:35], v[40:43]
  v_mfma_f32_16x16x32_bf16 v[44:47], v[72:75], v[36:39], v[44:47]
  v_mfma_f32_16x16x32_bf16 v[48:51], v[144:147], v[32:35], v[48:51]
  ds_read_b128 v[32:35], v57 offset:2048
  ds_read_b128 v[36:39], v59 offset:2048
  s_waitcnt lgkmcnt(4)
  v_mfma_f32_16x16x32_bf16 v[40:43], v[76:79], v[16:19], v[40:43]
  v_mfma_f32_16x16x32_bf16 v[44:47], v[76:79], v[20:23], v[44:47]
  v_mfma_f32_16x16x32_bf16 v[48:51], v[148:151], v[16:19], v[48:51]
  ds_read_b128 v[16:19], v56 offset:3072
  ds_read_b128 v[20:23], v58 offset:3072
  s_waitcnt lgkmcnt(4)
  v_mfma_f32_16x16x32_bf16 v[40:43], v[80:83], v[24:27], v[40:43]
  v_mfma_f32_16x16x32_bf16 v[44:47], v[80:83], v[28:31], v[44:47]
  v_mfma_f32_16x16x32_bf16 v[48:51], v[152:155], v[24:27], v[48:51]
  ds_read_b128 v[24:27], v57 offset:3072
  ds_read_b128 v[28:31], v59 offset:3072
  s_waitcnt lgkmcnt(4)
  v_mfma_f32_16x16x32_bf16 v[40:43], v[84:87], v[32:35], v[40:43]
  v_mfma_f32_16x16x32_bf16 v[44:47], v[84:87], v[36:39], v[44:47]
  v_mfma_f32_16x16x32_bf16 v[48:51], v[156:159], v[32:35], v[48:51]
  ds_read_b128 v[32:35], v56 offset:4096
  ds_read_b128 v[36:39], v58 offset:4096
  s_waitcnt lgkmcnt(4)
  v_mfma_f32_16x16x32_bf16 v[40:43], v[88:91], v[16:19], v[40:43]
  v_mfma_f32_16x16x32_bf16 v[44:47], v[88:91], v[20:23], v[44:47]
  v_mfma_f32_16x16x32_bf16 v[48:51], v[160:163], v[16:19], v[48:51]
  ds_read_b128 v[16:19], v57 offset:4096
  ds_read_b128 v[20:23], v59 offset:4096
  s_waitcnt lgkmcnt(4)
  v_mfma_f32_16x16x32_bf16 v[40:43], v[92:95], v[24:27], v[40:43]
  v_mfma_f32_16x16x32_bf16 v[44:47], v[92:95], v[28:31], v[44:47]
  v_mfma_f32_16x16x32_bf16 v[48:51], v[164:167], v[24:27], v[48:51]
  ds_read_b128 v[24:27], v56 offset:5120
  ds_read_b128 v[28:31], v58 offset:5120
  s_waitcnt lgkmcnt(4)
  v_mfma_f32_16x16x32_bf16 v[40:43], v[96:99], v[32:35], v[40:43]
  v_mfma_f32_16x16x32_bf16 v[44:47], v[96:99], v[36:39], v[44:47]
  v_mfma_f32_16x16x32_bf16 v[48:51], v[168:171], v[32:35], v[48:51]
  ds_read_b128 v[32:35], v57 offset:5120
  ds_read_b128 v[36:39], v59 offset:5120
  s_waitcnt lgkmcnt(4)
  v_mfma_f32_16x16x32_bf16 v[40:43], v[100:103], v[16:19], v[40:43]
  v_mfma_f32_16x16x32_bf16 v[44:47], v[100:103], v[20:23], v[44:47]
  v_mfma_f32_16x16x32_bf16 v[48:51], v[172:175], v[16:19], v[48:51]
  ds_read_b128 v[16:19], v56 offset:6144
  ds_read_b128 v[20:23], v58 offset:6144
  s_waitcnt lgkmcnt(4)
  v_mfma_f32_16x16x32_bf16 v[40:43], v[104:107], v[24:27], v[40:43]
  v_mfma_f32_16x16x32_bf16 v[44:47], v[104:107], v[28:31], v[44:47]
  v_mfma_f32_16x16x32_bf16 v[48:51], v[176:179], v[24:27], v[48:51]
  ds_read_b128 v[24:27], v57 offset:6144
  ds_read_b128 v[28:31], v59 offset:6144
  s_waitcnt lgkmcnt(4)
  v_mfma_f32_16x16x32_bf16 v[40:43], v[108:111], v[32:35], v[40:43]
  v_mfma_f32_16x16x32_bf16 v[44:47], v[108:111], v[36:39], v[44:47]
  v_mfma_f32_16x16x32_bf16 v[48:51], v[180:183], v[32:35], v[48:51]
  ds_read_b128 v[32:35], v56 offset:7168
  ds_read_b128 v[36:39], v58 offset:7168
  s_waitcnt lgkmcnt(4)
  v_mfma_f32_16x16x32_bf16 v[40:43], v[112:115], v[16:19], v[40:43]
  v_mfma_f32_16x16x32_bf16 v[44:47], v[112:115], v[20:23], v[44:47]
  v_mfma_f32_16x16x32_bf16 v[48:51], v[184:187], v[16:19], v[48:51]
  ds_read_b128 v[16:19], v57 offset:7168
  ds_read_b128 v[20:23], v59 offset:7168
  s_waitcnt lgkmcnt(4)
  v_mfma_f32_16x16x32_bf16 v[40:43], v[116:119], v[24:27], v[40:43]
  v_mfma_f32_16x16x32_bf16 v[44:47], v[116:119], v[28:31], v[44:47]
  v_mfma_f32_16x16x32_bf16 v[48:51], v[188:191], v[24:27], v[48:51]
  ds_read_b128 v[24:27], v56 offset:8192
  ds_read_b128 v[28:31], v58 offset:8192
  s_waitcnt lgkmcnt(4)
  v_mfma_f32_16x16x32_bf16 v[40:43], v[120:123], v[32:35], v[40:43]
  v_mfma_f32_16x16x32_bf16 v[44:47], v[120:123], v[36:39], v[44:47]
  v_mfma_f32_16x16x32_bf16 v[48:51], v[192:195], v[32:35], v[48:51]
  ds_read_b128 v[32:35], v57 offset:8192
  ds_read_b128 v[36:39], v59 offset:8192
  s_waitcnt lgkmcnt(4)
  v_mfma_f32_16x16x32_bf16 v[40:43], v[124:127], v[16:19], v[40:43]
  v_mfma_f32_16x16x32_bf16 v[44:47], v[124:127], v[20:23], v[44:47]
  v_mfma_f32_16x16x32_bf16 v[48:51], v[196:199], v[16:19], v[48:51]
  s_waitcnt lgkmcnt(2)
  v_mfma_f32_16x16x32_bf16 v[40:43], v[128:131], v[24:27], v[40:43]
  v_mfma_f32_16x16x32_bf16 v[44:47], v[128:131], v[28:31], v[44:47]
  v_mfma_f32_16x16x32_bf16 v[48:51], v[200:203], v[24:27], v[48:51]
  s_waitcnt lgkmcnt(0)
  v_mfma_f32_16x16x32_bf16 v[40:43], v[132:135], v[32:35], v[40:43]
  v_mfma_f32_16x16x32_bf16 v[44:47], v[132:135], v[36:39], v[44:47]
  v_mfma_f32_16x16x32_bf16 v[48:51], v[204:207], v[32:35], v[48:51]
  s_branch L_g_done_8
L_g_noex_7:
  ds_read_b128 v[16:19], v56 offset:0
  ds_read_b128 v[20:23], v58 offset:0
  ds_read_b128 v[24:27], v57 offset:0
  ds_read_b128 v[28:31], v59 offset:0
  ds_read_b128 v[32:35], v56 offset:1024
  ds_read_b128 v[36:39], v58 offset:1024
  s_waitcnt lgkmcnt(4)
  v_mfma_f32_16x16x32_bf16 v[40:43], v[64:67], v[16:19], 0
  v_mfma_f32_16x16x32_bf16 v[44:47], v[64:67], v[20:23], 0
  ds_read_b128 v[16:19], v57 offset:1024
  ds_read_b128 v[20:23], v59 offset:1024
  s_waitcnt lgkmcnt(4)
  v_mfma_f32_16x16x32_bf16 v[40:43], v[68:71], v[24:27], v[40:43]
  v_mfma_f32_16x16x32_bf16 v[44:47], v[68:71], v[28:31], v[44:47]
  ds_read_b128 v[24:27], v56 offset:2048
  ds_read_b128 v[28:31], v58 offset:2048
  s_waitcnt lgkmcnt(4)
  v_mfma_f32_16x16x32_bf16 v[40:43], v[72:75], v[32:35], v[40:43]
  v_mfma_f32_16x16x32_bf16 v[44:47], v[72:75], v[36:39], v[44:47]
  ds_read_b128 v[32:35], v57 offset:2048
  ds_read_b128 v[36:39], v59 offset:2048
  s_waitcnt lgkmcnt(4)
  v_mfma_f32_16x16x32_bf16 v[40:43], v[76:79], v[16:19], v[40:43]
  v_mfma_f32_16x16x32_bf16 v[44:47], v[76:79], v[20:23], v[44:47]
  ds_read_b128 v[16:19], v56 offset:3072
  ds_read_b128 v[20:23], v58 offset:3072
  s_waitcnt lgkmcnt(4)
  v_mfma_f32_16x16x32_bf16 v[40:43], v[80:83], v[24:27], v[40:43]
  v_mfma_f32_16x16x32_bf16 v[44:47], v[80:83], v[28:31], v[44:47]
  ds_read_b128 v[24:27], v57 offset:3072
  ds_read_b128 v[28:31], v59 offset:3072
  s_waitcnt lgkmcnt(4)
  v_mfma_f32_16x16x32_bf16 v[40:43], v[84:87], v[32:35], v[40:43]
  v_mfma_f32_16x16x32_bf16 v[44:47], v[84:87], v[36:39], v[44:47]
  ds_read_b128 v[32:35], v56 offset:4096
  ds_read_b128 v[36:39], v58 offset:4096
  s_waitcnt lgkmcnt(4)
  v_mfma_f32_16x16x32_bf16 v[40:43], v[88:91], v[16:19], v[40:43]
  v_mfma_f32_16x16x32_bf16 v[44:47], v[88:91], v[20:23], v[44:47]
  ds_read_b128 v[16:19], v57 offset:4096
  ds_read_b128 v[20:23], v59 offset:4096
  s_waitcnt lgkmcnt(4)
  v_mfma_f32_16x16x32_bf16 v[40:43], v[92:95], v[24:27], v[40:43]
  v_mfma_f32_16x16x32_bf16 v[44:47], v[92:95], v[28:31], v[44:47]
  ds_read_b128 v[24:27], v56 offset:5120
  ds_read_b128 v[28:31], v58 offset:5120
  s_waitcnt lgkmcnt(4)
  v_mfma_f32_16x16x32_bf16 v[40:43], v[96:99], v[32:35], v[40:43]
  v_mfma_f32_16x16x32_bf16 v[44:47], v[96:99], v[36:39], v[44:47]
  ds_read_b128 v[32:35], v57 offset:5120
  ds_read_b128 v[36:39], v59 offset:5120
  s_waitcnt lgkmcnt(4)
  v_mfma_f32_16x16x32_bf16 v[40:43], v[100:103], v[16:19], v[40:43]
  v_mfma_f32_16x16x32_bf16 v[44:47], v[100:103], v[20:23], v[44:47]
  ds_read_b128 v[16:19], v56 offset:6144
  ds_read_b128 v[20:23], v58 offset:6144
  s_waitcnt lgkmcnt(4)
  v_mfma_f32_16x16x32_bf16 v[40:43], v[104:107], v[24:27], v[40:43]
  v_mfma_f32_16x16x32_bf16 v[44:47], v[104:107], v[28:31], v[44:47]
  ds_read_b128 v[24:27], v57 offset:6144
  ds_read_b128 v[28:31], v59 offset:6144
  s_waitcnt lgkmcnt(4)
  v_mfma_f32_16x16x32_bf16 v[40:43], v[108:111], v[32:35], v[40:43]
  v_mfma_f32_16x16x32_bf16 v[44:47], v[108:111], v[36:39], v[44:47]
  ds_read_b128 v[32:35], v56 offset:7168
  ds_read_b128 v[36:39], v58 offset:7168
  s_waitcnt lgkmcnt(4)
  v_mfma_f32_16x16x32_bf16 v[40:43], v[112:115], v[16:19], v[40:43]
  v_mfma_f32_16x16x32_bf16 v[44:47], v[112:115], v[20:23], v[44:47]
  ds_read_b128 v[16:19], v57 offset:7168
  ds_read_b128 v[20:23], v59 offset:7168
  s_waitcnt lgkmcnt(4)
  v_mfma_f32_16x16x32_bf16 v[40:43], v[116:119], v[24:27], v[40:43]
  v_mfma_f32_16x16x32_bf16 v[44:47], v[116:119], v[28:31], v[44:47]
  ds_read_b128 v[24:27], v56 offset:8192
  ds_read_b128 v[28:31], v58 offset:8192
  s_waitcnt lgkmcnt(4)
  v_mfma_f32_16x16x32_bf16 v[40:43], v[120:123], v[32:35], v[40:43]
  v_mfma_f32_16x16x32_bf16 v[44:47], v[120:123], v[36:39], v[44:47]
  ds_read_b128 v[32:35], v57 offset:8192
  ds_read_b128 v[36:39], v59 offset:8192
  s_waitcnt lgkmcnt(4)
  v_mfma_f32_16x16x32_bf16 v[40:43], v[124:127], v[16:19], v[40:43]
  v_mfma_f32_16x16x32_bf16 v[44:47], v[124:127], v[20:23], v[44:47]
  s_waitcnt lgkmcnt(2)
  v_mfma_f32_16x16x32_bf16 v[40:43], v[128:131], v[24:27], v[40:43]
  v_mfma_f32_16x16x32_bf16 v[44:47], v[128:131], v[28:31], v[44:47]
  s_waitcnt lgkmcnt(0)
  v_mfma_f32_16x16x32_bf16 v[40:43], v[132:135], v[32:35], v[40:43]
  v_mfma_f32_16x16x32_bf16 v[44:47], v[132:135], v[36:39], v[44:47]
L_g_done_8:
  s_mov_b32 s36, s22
  s_mov_b32 s37, s23
  s_mov_b32 s38, 256
  s_mov_b32 s39, 0x20000
  v_mov_b32 v9, 0
  buffer_load_dword v252, v9, s[36:39], 0 offen sc1
  s_nop 0
  v_mul_f32 v9, v40, v40
  v_mul_f32 v10, v44, v44
  v_mul_f32 v11, v41, v41
  v_mul_f32 v12, v45, v45
  s_or_b32 s53, s44, s26
  s_cmp_lg_u32 s53, 0
  s_cbranch_scc1 L_nodc_9
  v_cmp_eq_u32 vcc, 0, v3
  v_mov_b32 v13, 0
  s_nop 0
  v_cndmask_b32 v11, v11, v13, vcc
  v_cndmask_b32 v12, v12, v13, vcc
L_nodc_9:
  v_add_f32 v9, v9, v11
  v_add_f32 v10, v10, v12
  v_fmac_f32 v9, v42, v42
  v_fmac_f32 v10, v46, v46
  v_fmac_f32 v9, v43, v43
  v_fmac_f32 v10, v47, v47
  v_mov_b32 v11, v9
  v_mov_b32 v12, v10
  v_cvt_pk_bf16_f32 v14, v40, v41
  v_cvt_pk_bf16_f32 v15, v42, v43
  v_permlane16_swap_b32 v11, v9
  v_permlane16_swap_b32 v12, v10
  v_add_f32 v9, v9, v11
  v_add_f32 v10, v10, v12
  v_mov_b32 v11, v9
  v_mov_b32 v12, v10
  v_cvt_pk_bf16_f32 v52, v44, v45
  v_cvt_pk_bf16_f32 v53, v46, v47
  v_permlane32_swap_b32 v11, v9
  v_permlane32_swap_b32 v12, v10
  v_add_f32 v9, v9, v11
  v_add_f32 v10, v10, v12
  v_xor_b32 v12, 64, v63
  ds_write_b32 v63, v9
  ds_write_b32 v12, v10
  buffer_store_dwordx2 v[14:15], v61, s[28:31], s80 offen sc1
  buffer_store_dwordx2 v[52:53], v62, s[28:31], s80 offen sc1
  s_cmp_ge_u32 s26, 2
  s_cbranch_scc1 L_ep_noex_10
  v_mul_f32 v9, v48, v48
  v_fmac_f32 v9, v49, v49
  v_fmac_f32 v9, v50, v50
  v_fmac_f32 v9, v51, v51
  v_cvt_pk_bf16_f32 v54, v48, v49
  v_cvt_pk_bf16_f32 v55, v50, v51
  v_mov_b32 v13, v9
  s_nop 1
  v_permlane16_swap_b32 v13, v9
  v_add_f32 v9, v9, v13
  v_mov_b32 v13, v9
  s_nop 1
  v_permlane32_swap_b32 v13, v9
  v_add_f32 v9, v9, v13
  s_lshl_b32 s55, s26, 6
  s_add_u32 s55, s55, 162304
  v_lshlrev_b32 v11, 2, v2
  v_add_u32 v11, s55, v11
  ds_write_b32 v11, v9
  buffer_store_dwordx2 v[54:55], v61, s[28:31], s81 offen sc1
L_ep_noex_10:
  v_lshl_or_b32 v208, v220, 16, v208
  v_lshl_or_b32 v209, v221, 16, v209
  v_lshl_or_b32 v210, v222, 16, v210
  v_lshl_or_b32 v211, v223, 16, v211
  v_lshl_or_b32 v212, v224, 16, v212
  s_lshl_b32 s53, s26, 4
  s_add_u32 s53, s53, 40960
  v_lshlrev_b32 v216, 7, v1
  v_add_u32 v216, s53, v216
  ds_write_b128 v216, v[208:211]
  v_and_b32 v217, 7, v1
  v_lshlrev_b32 v217, 7, v217
  v_bfe_u32 v218, v1, 3, 2
  v_lshl_add_u32 v217, v218, 2, v217
  s_add_u32 s53, s53, 8192
  v_add_u32 v217, s53, v217
  s_mov_b32 exec_hi, 0
  ds_write_b32 v217, v212
  s_mov_b64 exec, -1
  s_waitcnt lgkmcnt(0)
  s_barrier
  v_lshlrev_b32 v216, 4, v0
  ds_read_b128 v[208:211], v216 offset:40960
  ds_read_b128 v[220:223], v216 offset:49152
  v_lshrrev_b32 v217, 3, v0
  v_lshlrev_b32 v217, 13, v217
  v_and_b32 v218, 7, v0
  v_lshl_add_u32 v217, v218, 4, v217
  s_waitcnt lgkmcnt(0)
  buffer_store_dwordx4 v[208:211], v217, s[28:31], s77 offen sc1
  s_cmp_lg_u32 s26, 0
  s_cbranch_scc1 L_wt2_11
  s_add_u32 s53, s77, 524288
  buffer_store_dwordx4 v[220:223], v217, s[28:31], s53 offen sc1
L_wt2_11:
  s_cmp_lg_u32 s26, 7
  s_cbranch_scc1 L_ep_fin_12
  v_and_b32 v4, 31, v1
  v_lshlrev_b32 v4, 2, v4
  v_add_u32 v14, 161280, v4
  ds_read_b32 v5, v14 offset:0
  ds_read_b32 v6, v14 offset:128
  ds_read_b32 v7, v14 offset:256
  ds_read_b32 v8, v14 offset:384
  ds_read_b32 v9, v14 offset:512
  ds_read_b32 v10, v14 offset:640
  ds_read_b32 v11, v14 offset:768
  ds_read_b32 v12, v14 offset:896
  ds_read_b32 v13, v14 offset:1024
  s_waitcnt lgkmcnt(0)
  v_add_f32 v5, v5, v6
  v_add_f32 v5, v5, v7
  v_add_f32 v5, v5, v8
  v_add_f32 v5, v5, v9
  v_add_f32 v5, v5, v10
  v_add_f32 v5, v5, v11
  v_add_f32 v5, v5, v12
  v_add_f32 v5, v5, v13
  s_mov_b32 exec_hi, 0
  buffer_store_dword v5, v4, s[28:31], s82 offen sc1
  s_mov_b64 exec, -1
L_ep_fin_12:
  s_waitcnt vmcnt(0) lgkmcnt(0)
  s_barrier
  s_cmp_lg_u32 s26, 0
  s_cbranch_scc1 L_arr_13
  v_readfirstlane_b32 s48, v252
  s_nop 3
  s_cmp_lg_u32 s48, 0
  s_cbranch_scc1 L_gook_15
  s_mov_b32 s32, s22
  s_mov_b32 s33, s23
  s_mov_b32 s34, 256
  s_mov_b32 s35, 0x20000
  v_mov_b32 v4, 0
  s_mov_b32 s48, 0
L_go_14:
  buffer_load_dword v5, v4, s[32:35], 0 offen sc1
  s_waitcnt vmcnt(0)
  v_cmp_eq_u32 vcc, 0, v5
  s_add_u32 s48, s48, 1
  s_cmp_gt_u32 s48, 60000
  s_cbranch_scc1 L_gook_15
  s_nop 1
  s_cbranch_vccz L_gook_15
  s_sleep 1
  s_branch L_go_14
L_gook_15:
  s_mov_b32 s48, 0
  s_and_b32 s49, s2, 31
  s_lshl_b32 s49, s49, 8
  s_add_u32 s48, s48, s49
  v_mov_b32 v4, s48
  v_mov_b32 v5, 1
  s_mov_b64 exec, 1
  buffer_atomic_add v5, v4, s[28:31], 0 offen sc1
  s_mov_b64 exec, -1
L_arr_13:
L_layer:
  s_cmp_ge_u32 s2, 144
  s_cbranch_scc1 L_nofft_16
  v_and_b32 v4, 255, v0
  v_cvt_f32_u32 v4, v4
  v_mul_f32 v4, 0x3a000000, v4
  v_cos_f32 v136, v4
  v_sin_f32 v137, -v4
  v_and_b32 v4, 31, v0
  v_lshlrev_b32 v4, 3, v4
  v_cvt_f32_u32 v4, v4
  v_mul_f32 v4, 0x3a000000, v4
  v_cos_f32 v150, v4
  v_sin_f32 v151, -v4
  v_and_b32 v4, 3, v0
  v_lshlrev_b32 v4, 6, v4
  v_cvt_f32_u32 v4, v4
  v_mul_f32 v4, 0x3a000000, v4
  v_cos_f32 v164, v4
  v_sin_f32 v165, -v4
  v_pk_mul_f32 v[138:139], v[136:137], v[136:137] op_sel:[0,0] op_sel_hi:[1,0]
  v_pk_fma_f32 v[138:139], v[136:137], v[136:137], v[138:139] op_sel:[1,1,0] op_sel_hi:[0,1,1] neg_lo:[1,0,0]
  v_pk_mul_f32 v[152:153], v[150:151], v[150:151] op_sel:[0,0] op_sel_hi:[1,0]
  v_pk_fma_f32 v[152:153], v[150:151], v[150:151], v[152:153] op_sel:[1,1,0] op_sel_hi:[0,1,1] neg_lo:[1,0,0]
  v_pk_mul_f32 v[166:167], v[164:165], v[164:165] op_sel:[0,0] op_sel_hi:[1,0]
  v_pk_fma_f32 v[166:167], v[164:165], v[164:165], v[166:167] op_sel:[1,1,0] op_sel_hi:[0,1,1] neg_lo:[1,0,0]
  v_pk_mul_f32 v[140:141], v[138:139], v[136:137] op_sel:[0,0] op_sel_hi:[1,0]
  v_pk_fma_f32 v[140:141], v[138:139], v[136:137], v[140:141] op_sel:[1,1,0] op_sel_hi:[0,1,1] neg_lo:[1,0,0]
  v_pk_mul_f32 v[154:155], v[152:153], v[150:151] op_sel:[0,0] op_sel_hi:[1,0]
  v_pk_fma_f32 v[154:155], v[152:153], v[150:151], v[154:155] op_sel:[1,1,0] op_sel_hi:[0,1,1] neg_lo:[1,0,0]
  v_pk_mul_f32 v[168:169], v[166:167], v[164:165] op_sel:[0,0] op_sel_hi:[1,0]
  v_pk_fma_f32 v[168:169], v[166:167], v[164:165], v[168:169] op_sel:[1,1,0] op_sel_hi:[0,1,1] neg_lo:[1,0,0]
  v_pk_mul_f32 v[142:143], v[138:139], v[138:139] op_sel:[0,0] op_sel_hi:[1,0]
  v_pk_fma_f32 v[142:143], v[138:139], v[138:139], v[142:143] op_sel:[1,1,0] op_sel_hi:[0,1,1] neg_lo:[1,0,0]
  v_pk_mul_f32 v[156:157], v[152:153], v[152:153] op_sel:[0,0] op_sel_hi:[1,0]
  v_pk_fma_f32 v[156:157], v[152:153], v[152:153], v[156:157] op_sel:[1,1,0] op_sel_hi:[0,1,1] neg_lo:[1,0,0]
  v_pk_mul_f32 v[170:171], v[166:167], v[166:167] op_sel:[0,0] op_sel_hi:[1,0]
  v_pk_fma_f32 v[170:171], v[166:167], v[166:167], v[170:171] op_sel:[1,1,0] op_sel_hi:[0,1,1] neg_lo:[1,0,0]
  v_pk_mul_f32 v[144:145], v[142:143], v[136:137] op_sel:[0,0] op_sel_hi:[1,0]
  v_pk_fma_f32 v[144:145], v[142:143], v[136:137], v[144:145] op_sel:[1,1,0] op_sel_hi:[0,1,1] neg_lo:[1,0,0]
  v_pk_mul_f32 v[158:159], v[156:157], v[150:151] op_sel:[0,0] op_sel_hi:[1,0]
  v_pk_fma_f32 v[158:159], v[156:157], v[150:151], v[158:159] op_sel:[1,1,0] op_sel_hi:[0,1,1] neg_lo:[1,0,0]
  v_pk_mul_f32 v[172:173], v[170:171], v[164:165] op_sel:[0,0] op_sel_hi:[1,0]
  v_pk_fma_f32 v[172:173], v[170:171], v[164:165], v[172:173] op_sel:[1,1,0] op_sel_hi:[0,1,1] neg_lo:[1,0,0]
  v_pk_mul_f32 v[146:147], v[140:141], v[140:141] op_sel:[0,0] op_sel_hi:[1,0]
  v_pk_fma_f32 v[146:147], v[140:141], v[140:141], v[146:147] op_sel:[1,1,0] op_sel_hi:[0,1,1] neg_lo:[1,0,0]
  v_pk_mul_f32 v[160:161], v[154:155], v[154:155] op_sel:[0,0] op_sel_hi:[1,0]
  v_pk_fma_f32 v[160:161], v[154:155], v[154:155], v[160:161] op_sel:[1,1,0] op_sel_hi:[0,1,1] neg_lo:[1,0,0]
  v_pk_mul_f32 v[174:175], v[168:169], v[168:169] op_sel:[0,0] op_sel_hi:[1,0]
  v_pk_fma_f32 v[174:175], v[168:169], v[168:169], v[174:175] op_sel:[1,1,0] op_sel_hi:[0,1,1] neg_lo:[1,0,0]
  v_pk_mul_f32 v[148:149], v[142:143], v[140:141] op_sel:[0,0] op_sel_hi:[1,0]
  v_pk_fma_f32 v[148:149], v[142:143], v[140:141], v[148:149] op_sel:[1,1,0] op_sel_hi:[0,1,1] neg_lo:[1,0,0]
  v_pk_mul_f32 v[162:163], v[156:157], v[154:155] op_sel:[0,0] op_sel_hi:[1,0]
  v_pk_fma_f32 v[162:163], v[156:157], v[154:155], v[162:163] op_sel:[1,1,0] op_sel_hi:[0,1,1] neg_lo:[1,0,0]
  v_pk_mul_f32 v[176:177], v[170:171], v[168:169] op_sel:[0,0] op_sel_hi:[1,0]
  v_pk_fma_f32 v[176:177], v[170:171], v[168:169], v[176:177] op_sel:[1,1,0] op_sel_hi:[0,1,1] neg_lo:[1,0,0]
  s_cmp_lg_u32 s26, 7
  s_cbranch_scc1 L_wdone_19
  s_mul_i32 s48, s45, 24576
  s_add_u32 s48, s48, 0
  v_and_b32 v4, 31, v1
  v_lshlrev_b32 v4, 8, v4
  v_add_u32 v4, s48, v4
  s_mov_b32 s48, 0
  s_setprio 3
  s_sleep 28
L_poll_20:
  buffer_load_dword v5, v4, s[28:31], 0 offen sc1
  s_waitcnt vmcnt(0)
  v_cmp_gt_u32 vcc, 8, v5
  s_add_u32 s48, s48, 1
  s_cmp_gt_u32 s48, 60000
  s_cbranch_scc1 L_wdone_19
  s_nop 1
  s_cbranch_vccz L_wdone_19
  s_sleep 4
  s_branch L_poll_20
L_wdone_19:
  s_setprio 0
  s_barrier
  s_cmp_eq_u32 s45, 0
  s_mov_b32 s72, 4849664
  s_cselect_b32 s72, 131072, s72
  s_mov_b32 s73, 7208960
  s_cselect_b32 s73, 2490368, s73
  s_mov_b32 s74, 9601024
  s_cselect_b32 s74, 9568256, s74
  v_lshlrev_b32 v4, 4, v0
  s_add_u32 s50, s74, 0
  buffer_load_dwordx4 v[16:19], v4, s[28:31], s50 offen sc1
  s_add_u32 s50, s74, 8192
  buffer_load_dwordx4 v[20:23], v4, s[28:31], s50 offen sc1
  s_add_u32 s50, s74, 16384
  buffer_load_dwordx4 v[24:27], v4, s[28:31], s50 offen sc1
  s_add_u32 s50, s74, 24576
  buffer_load_dwordx4 v[28:31], v4, s[28:31], s50 offen sc1
  s_lshr_b32 s51, s26, 2
  v_and_b32 v5, 255, v0
  v_lshrrev_b32 v6, 5, v5
  v_mul_u32_u24 v6, 36864, v6
  v_lshrrev_b32 v7, 4, v5
  v_and_b32 v7, 1, v7
  s_lshr_b32 s52, s2, 1
  s_and_b32 s52, s52, 1
  v_xor_b32 v7, s52, v7
  v_lshl_add_u32 v6, v7, 7, v6
  v_and_b32 v7, 15, v5
  v_lshl_add_u32 v6, v7, 3, v6
  s_lshl_b32 s53, s2, 8
  s_lshl_b32 s54, s51, 2
  s_add_u32 s53, s53, s54
  s_add_u32 s53, s53, s72
  s_add_u32 s50, s53, 0
  buffer_load_dword v32, v6, s[28:31], s50 offen sc1
  s_add_u32 s50, s53, 294912
  buffer_load_dword v33, v6, s[28:31], s50 offen sc1
  s_add_u32 s50, s53, 589824
  buffer_load_dword v34, v6, s[28:31], s50 offen sc1
  s_add_u32 s50, s53, 884736
  buffer_load_dword v35, v6, s[28:31], s50 offen sc1
  s_add_u32 s50, s53, 1179648
  buffer_load_dword v36, v6, s[28:31], s50 offen sc1
  s_add_u32 s50, s53, 1474560
  buffer_load_dword v37, v6, s[28:31], s50 offen sc1
  s_add_u32 s50, s53, 1769472
  buffer_load_dword v38, v6, s[28:31], s50 offen sc1
  s_add_u32 s50, s53, 2064384
  buffer_load_dword v39, v6, s[28:31], s50 offen sc1
  s_lshl_b32 s54, s2, 1
  s_add_u32 s54, s54, s51
  s_lshl_b32 s54, s54, 13
  s_add_u32 s54, s54, 9633792
  v_lshlrev_b32 v8, 5, v5
  buffer_load_dwordx4 v[178:181], v8, s[28:31], s54 offen sc1
  buffer_load_dwordx4 v[182:185], v8, s[28:31], s54 offen offset:16 sc1
  v_mov_b32 v202, 0x3f3504f3
  v_mov_b32 v203, 0x3f3504f3
  v_mov_b32 v204, 1.0
  s_lshl_b32 s55, s2, 1
  s_or_b32 s55, s55, s51
  s_cmp_eq_u32 s55, 0
  s_cselect_b32 s56, 0, 1.0
  v_mov_b32 v205, s56
  s_mul_i32 s57, s51, 18432
  s_add_u32 s57, s57, 8192
  v_lshlrev_b32 v206, 3, v5
  v_add_u32 v206, s57, v206
  v_lshrrev_b32 v9, 5, v5
  v_mul_u32_u24 v9, 2304, v9
  v_add_u32 v9, s57, v9
  v_and_b32 v10, 31, v5
  v_lshl_add_u32 v207, v10, 3, v9
  v_lshrrev_b32 v11, 2, v10
  v_mul_u32_u24 v11, 288, v11
  v_add_u32 v11, v11, v9
  v_and_b32 v12, 3, v5
  v_lshl_add_u32 v208, v12, 3, v11
  v_lshl_add_u32 v209, v12, 6, v11
  s_mul_i32 s58, s44, 9
  s_add_u32 s58, s58, s26
  s_mul_i32 s58, s58, 18432
  s_add_u32 s58, s58, 11993088
  v_lshlrev_b32 v14, 4, v1
  s_waitcnt vmcnt(10)
  v_add_f32 v16, v16, v20
  v_add_f32 v24, v24, v28
  v_add_f32 v17, v17, v21
  v_add_f32 v25, v25, v29
  v_add_f32 v18, v18, v22
  v_add_f32 v26, v26, v30
  v_add_f32 v19, v19, v23
  v_add_f32 v27, v27, v31
  v_add_f32 v16, v16, v24
  v_add_f32 v17, v17, v25
  v_add_f32 v18, v18, v26
  v_add_f32 v19, v19, v27
  v_mul_f32 v16, 0x3ae38e39, v16
  v_mul_f32 v17, 0x3ae38e39, v17
  v_mul_f32 v18, 0x3ae38e39, v18
  v_mul_f32 v19, 0x3ae38e39, v19
  v_cvt_pk_bf16_f32 v20, v16, v16
  v_cvt_pk_bf16_f32 v21, v17, v17
  v_cvt_pk_bf16_f32 v22, v18, v18
  v_cvt_pk_bf16_f32 v23, v19, v19
  v_lshlrev_b32 v16, 16, v20
  v_lshlrev_b32 v17, 16, v21
  v_lshlrev_b32 v18, 16, v22
  v_lshlrev_b32 v19, 16, v23
  v_add_f32 v16, 0x3727c5ac, v16
  v_add_f32 v17, 0x3727c5ac, v17
  v_add_f32 v18, 0x3727c5ac, v18
  v_add_f32 v19, 0x3727c5ac, v19
  v_cvt_pk_bf16_f32 v20, v16, v16
  v_cvt_pk_bf16_f32 v21, v17, v17
  v_cvt_pk_bf16_f32 v22, v18, v18
  v_cvt_pk_bf16_f32 v23, v19, v19
  v_lshlrev_b32 v16, 16, v20
  v_lshlrev_b32 v17, 16, v21
  v_lshlrev_b32 v18, 16, v22
  v_lshlrev_b32 v19, 16, v23
  v_sqrt_f32 v16, v16
  v_sqrt_f32 v17, v17
  v_sqrt_f32 v18, v18
  v_sqrt_f32 v19, v19
  v_cvt_pk_bf16_f32 v20, v16, v16
  v_cvt_pk_bf16_f32 v21, v17, v17
  v_cvt_pk_bf16_f32 v22, v18, v18
  v_cvt_pk_bf16_f32 v23, v19, v19
  v_lshlrev_b32 v16, 16, v20
  v_lshlrev_b32 v17, 16, v21
  v_lshlrev_b32 v18, 16, v22
  v_lshlrev_b32 v19, 16, v23
  v_rcp_f32 v16, v16
  v_rcp_f32 v17, v17
  v_rcp_f32 v18, v18
  v_rcp_f32 v19, v19
  v_mul_f32 v16, 0x3a000000, v16
  v_mul_f32 v17, 0x3a000000, v17
  v_mul_f32 v18, 0x3a000000, v18
  v_mul_f32 v19, 0x3a000000, v19
  v_lshlrev_b32 v4, 4, v0
  ds_write_b128 v4, v[16:19]
  s_waitcnt lgkmcnt(0)
  s_barrier
  v_lshlrev_b32 v4, 2, v5
  ds_read_b32 v40, v4 offset:0
  ds_read_b32 v41, v4 offset:1024
  ds_read_b32 v42, v4 offset:2048
  ds_read_b32 v43, v4 offset:3072
  ds_read_b32 v44, v4 offset:4096
  ds_read_b32 v45, v4 offset:5120
  ds_read_b32 v46, v4 offset:6144
  ds_read_b32 v47, v4 offset:7168
  s_waitcnt vmcnt(2)
  v_lshlrev_b32 v186, 16, v32
  v_and_b32 v187, 0xffff0000, v32
  v_lshlrev_b32 v188, 16, v33
  v_and_b32 v189, 0xffff0000, v33
  v_lshlrev_b32 v190, 16, v34
  v_and_b32 v191, 0xffff0000, v34
  v_lshlrev_b32 v192, 16, v35
  v_and_b32 v193, 0xffff0000, v35
  v_lshlrev_b32 v194, 16, v36
  v_and_b32 v195, 0xffff0000, v36
  v_lshlrev_b32 v196, 16, v37
  v_and_b32 v197, 0xffff0000, v37
  v_lshlrev_b32 v198, 16, v38
  v_and_b32 v199, 0xffff0000, v38
  v_lshlrev_b32 v200, 16, v39
  v_and_b32 v201, 0xffff0000, v39
  s_waitcnt lgkmcnt(0)
  v_pk_mul_f32 v[16:17], v[186:187], v[40:41] op_sel:[0,0] op_sel_hi:[1,0]
  v_pk_mul_f32 v[18:19], v[188:189], v[40:41] op_sel:[0,1] op_sel_hi:[1,1]
  v_pk_mul_f32 v[20:21], v[190:191], v[42:43] op_sel:[0,0] op_sel_hi:[1,0]
  v_pk_mul_f32 v[22:23], v[192:193], v[42:43] op_sel:[0,1] op_sel_hi:[1,1]
  v_pk_mul_f32 v[24:25], v[194:195], v[44:45] op_sel:[0,0] op_sel_hi:[1,0]
  v_pk_mul_f32 v[26:27], v[196:197], v[44:45] op_sel:[0,1] op_sel_hi:[1,1]
  v_pk_mul_f32 v[28:29], v[198:199], v[46:47] op_sel:[0,0] op_sel_hi:[1,0]
  v_pk_mul_f32 v[30:31], v[200:201], v[46:47] op_sel:[0,1] op_sel_hi:[1,1]
  s_cmp_lg_u32 s55, 0
  s_cbranch_scc1 L_nomask_21
  v_pk_mul_f32 v[16:17], v[16:17], v[204:205]
  v_pk_mul_f32 v[18:19], v[18:19], v[204:205]
  v_pk_mul_f32 v[20:21], v[20:21], v[204:205]
  v_pk_mul_f32 v[22:23], v[22:23], v[204:205]
  v_pk_mul_f32 v[24:25], v[24:25], v[204:205]
  v_pk_mul_f32 v[26:27], v[26:27], v[204:205]
  v_pk_mul_f32 v[28:29], v[28:29], v[204:205]
  v_pk_mul_f32 v[30:31], v[30:31], v[204:205]
L_nomask_21:
  v_pk_add_f32 v[32:33], v[16:17], v[24:25]
  v_pk_add_f32 v[34:35], v[16:17], v[24:25] neg_lo:[0,1] neg_hi:[0,1]
  v_pk_add_f32 v[36:37], v[18:19], v[26:27]
  v_pk_add_f32 v[38:39], v[18:19], v[26:27] neg_lo:[0,1] neg_hi:[0,1]
  v_pk_add_f32 v[40:41], v[20:21], v[28:29]
  v_pk_add_f32 v[42:43], v[20:21], v[28:29] neg_lo:[0,1] neg_hi:[0,1]
  v_pk_add_f32 v[44:45], v[22:23], v[30:31]
  v_pk_add_f32 v[46:47], v[22:23], v[30:31] neg_lo:[0,1] neg_hi:[0,1]
  v_pk_add_f32 v[48:49], v[32:33], v[40:41]
  v_pk_add_f32 v[50:51], v[32:33], v[40:41] neg_lo:[0,1] neg_hi:[0,1]
  v_pk_add_f32 v[52:53], v[36:37], v[44:45]
  v_pk_add_f32 v[54:55], v[36:37], v[44:45] neg_lo:[0,1] neg_hi:[0,1]
  v_pk_add_f32 v[56:57], v[48:49], v[52:53]
  v_pk_add_f32 v[58:59], v[48:49], v[52:53] neg_lo:[0,1] neg_hi:[0,1]
  v_pk_add_f32 v[60:61], v[50:51], v[54:55] op_sel:[0,1] op_sel_hi:[1,0] neg_hi:[0,1]
  v_pk_add_f32 v[62:63], v[50:51], v[54:55] op_sel:[0,1] op_sel_hi:[1,0] neg_lo:[0,1]
  v_pk_add_f32 v[16:17], v[34:35], v[42:43] op_sel:[0,1] op_sel_hi:[1,0] neg_hi:[0,1]
  v_pk_add_f32 v[24:25], v[34:35], v[42:43] op_sel:[0,1] op_sel_hi:[1,0] neg_lo:[0,1]
  v_pk_add_f32 v[18:19], v[38:39], v[38:39] op_sel:[0,1] op_sel_hi:[1,0] neg_hi:[0,1]
  v_pk_add_f32 v[26:27], v[46:47], v[46:47] op_sel:[0,1] op_sel_hi:[1,0] neg_lo:[0,1]
  v_pk_add_f32 v[20:21], v[18:19], v[26:27] neg_lo:[0,1] neg_hi:[0,1]
  v_pk_add_f32 v[28:29], v[18:19], v[26:27]
  v_pk_fma_f32 v[22:23], v[20:21], v[202:203], v[16:17]
  v_pk_fma_f32 v[30:31], v[20:21], v[202:203], v[16:17] neg_lo:[1,0,0] neg_hi:[1,0,0]
  v_pk_fma_f32 v[32:33], v[28:29], v[202:203], v[24:25] op_sel:[1,0,0] op_sel_hi:[0,1,1] neg_hi:[1,0,0]
  v_pk_fma_f32 v[40:41], v[28:29], v[202:203], v[24:25] op_sel:[1,0,0] op_sel_hi:[0,1,1] neg_lo:[1,0,0]
  v_pk_mul_f32 v[36:37], v[22:23], v[136:137] op_sel:[0,0] op_sel_hi:[1,0]
  v_pk_fma_f32 v[36:37], v[22:23], v[136:137], v[36:37] op_sel:[1,1,0] op_sel_hi:[0,1,1] neg_lo:[1,0,0]
  v_pk_mul_f32 v[44:45], v[60:61], v[138:139] op_sel:[0,0] op_sel_hi:[1,0]
  v_pk_fma_f32 v[44:45], v[60:61], v[138:139], v[44:45] op_sel:[1,1,0] op_sel_hi:[0,1,1] neg_lo:[1,0,0]
  v_pk_mul_f32 v[48:49], v[32:33], v[140:141] op_sel:[0,0] op_sel_hi:[1,0]
  v_pk_fma_f32 v[48:49], v[32:33], v[140:141], v[48:49] op_sel:[1,1,0] op_sel_hi:[0,1,1] neg_lo:[1,0,0]
  v_pk_mul_f32 v[52:53], v[58:59], v[142:143] op_sel:[0,0] op_sel_hi:[1,0]
  v_pk_fma_f32 v[52:53], v[58:59], v[142:143], v[52:53] op_sel:[1,1,0] op_sel_hi:[0,1,1] neg_lo:[1,0,0]
  v_pk_mul_f32 v[50:51], v[30:31], v[144:145] op_sel:[0,0] op_sel_hi:[1,0]
  v_pk_fma_f32 v[50:51], v[30:31], v[144:145], v[50:51] op_sel:[1,1,0] op_sel_hi:[0,1,1] neg_lo:[1,0,0]
  v_pk_mul_f32 v[54:55], v[62:63], v[146:147] op_sel:[0,0] op_sel_hi:[1,0]
  v_pk_fma_f32 v[54:55], v[62:63], v[146:147], v[54:55] op_sel:[1,1,0] op_sel_hi:[0,1,1] neg_lo:[1,0,0]
  v_pk_mul_f32 v[34:35], v[40:41], v[148:149] op_sel:[0,0] op_sel_hi:[1,0]
  v_pk_fma_f32 v[34:35], v[40:41], v[148:149], v[34:35] op_sel:[1,1,0] op_sel_hi:[0,1,1] neg_lo:[1,0,0]
  ds_write_b64 v206, v[56:57] offset:0
  ds_write_b64 v206, v[36:37] offset:2304
  ds_write_b64 v206, v[44:45] offset:4608
  ds_write_b64 v206, v[48:49] offset:6912
  ds_write_b64 v206, v[52:53] offset:9216
  ds_write_b64 v206, v[50:51] offset:11520
  ds_write_b64 v206, v[54:55] offset:13824
  ds_write_b64 v206, v[34:35] offset:16128
  s_waitcnt lgkmcnt(0)
  s_barrier
  ds_read_b64 v[42:43], v207 offset:0
  ds_read_b64 v[38:39], v207 offset:256
  ds_read_b64 v[46:47], v207 offset:512
  ds_read_b64 v[18:19], v207 offset:768
  ds_read_b64 v[26:27], v207 offset:1024
  ds_read_b64 v[20:21], v207 offset:1280
  ds_read_b64 v[16:17], v207 offset:1536
  ds_read_b64 v[28:29], v207 offset:1792
  s_waitcnt lgkmcnt(0)
  v_pk_add_f32 v[24:25], v[42:43], v[26:27]
  v_pk_add_f32 v[22:23], v[42:43], v[26:27] neg_lo:[0,1] neg_hi:[0,1]
  v_pk_add_f32 v[60:61], v[38:39], v[20:21]
  v_pk_add_f32 v[32:33], v[38:39], v[20:21] neg_lo:[0,1] neg_hi:[0,1]
  v_pk_add_f32 v[58:59], v[46:47], v[16:17]
  v_pk_add_f32 v[30:31], v[46:47], v[16:17] neg_lo:[0,1] neg_hi:[0,1]
  v_pk_add_f32 v[62:63], v[18:19], v[28:29]
  v_pk_add_f32 v[40:41], v[18:19], v[28:29] neg_lo:[0,1] neg_hi:[0,1]
  v_pk_add_f32 v[56:57], v[24:25], v[58:59]
  v_pk_add_f32 v[36:37], v[24:25], v[58:59] neg_lo:[0,1] neg_hi:[0,1]
  v_pk_add_f32 v[44:45], v[60:61], v[62:63]
  v_pk_add_f32 v[48:49], v[60:61], v[62:63] neg_lo:[0,1] neg_hi:[0,1]
  v_pk_add_f32 v[52:53], v[56:57], v[44:45]
  v_pk_add_f32 v[50:51], v[56:57], v[44:45] neg_lo:[0,1] neg_hi:[0,1]
  v_pk_add_f32 v[54:55], v[36:37], v[48:49] op_sel:[0,1] op_sel_hi:[1,0] neg_hi:[0,1]
  v_pk_add_f32 v[34:35], v[36:37], v[48:49] op_sel:[0,1] op_sel_hi:[1,0] neg_lo:[0,1]
  v_pk_add_f32 v[42:43], v[22:23], v[30:31] op_sel:[0,1] op_sel_hi:[1,0] neg_hi:[0,1]
  v_pk_add_f32 v[26:27], v[22:23], v[30:31] op_sel:[0,1] op_sel_hi:[1,0] neg_lo:[0,1]
  v_pk_add_f32 v[38:39], v[32:33], v[32:33] op_sel:[0,1] op_sel_hi:[1,0] neg_hi:[0,1]
  v_pk_add_f32 v[20:21], v[40:41], v[40:41] op_sel:[0,1] op_sel_hi:[1,0] neg_lo:[0,1]
  v_pk_add_f32 v[46:47], v[38:39], v[20:21] neg_lo:[0,1] neg_hi:[0,1]
  v_pk_add_f32 v[16:17], v[38:39], v[20:21]
  v_pk_fma_f32 v[18:19], v[46:47], v[202:203], v[42:43]
  v_pk_fma_f32 v[28:29], v[46:47], v[202:203], v[42:43] neg_lo:[1,0,0] neg_hi:[1,0,0]
  v_pk_fma_f32 v[24:25], v[16:17], v[202:203], v[26:27] op_sel:[1,0,0] op_sel_hi:[0,1,1] neg_hi:[1,0,0]
  v_pk_fma_f32 v[58:59], v[16:17], v[202:203], v[26:27] op_sel:[1,0,0] op_sel_hi:[0,1,1] neg_lo:[1,0,0]
  v_pk_mul_f32 v[60:61], v[18:19], v[150:151] op_sel:[0,0] op_sel_hi:[1,0]
  v_pk_fma_f32 v[60:61], v[18:19], v[150:151], v[60:61] op_sel:[1,1,0] op_sel_hi:[0,1,1] neg_lo:[1,0,0]
  v_pk_mul_f32 v[62:63], v[54:55], v[152:153] op_sel:[0,0] op_sel_hi:[1,0]
  v_pk_fma_f32 v[62:63], v[54:55], v[152:153], v[62:63] op_sel:[1,1,0] op_sel_hi:[0,1,1] neg_lo:[1,0,0]
  v_pk_mul_f32 v[56:57], v[24:25], v[154:155] op_sel:[0,0] op_sel_hi:[1,0]
  v_pk_fma_f32 v[56:57], v[24:25], v[154:155], v[56:57] op_sel:[1,1,0] op_sel_hi:[0,1,1] neg_lo:[1,0,0]
  v_pk_mul_f32 v[44:45], v[50:51], v[156:157] op_sel:[0,0] op_sel_hi:[1,0]
  v_pk_fma_f32 v[44:45], v[50:51], v[156:157], v[44:45] op_sel:[1,1,0] op_sel_hi:[0,1,1] neg_lo:[1,0,0]
  v_pk_mul_f32 v[36:37], v[28:29], v[158:159] op_sel:[0,0] op_sel_hi:[1,0]
  v_pk_fma_f32 v[36:37], v[28:29], v[158:159], v[36:37] op_sel:[1,1,0] op_sel_hi:[0,1,1] neg_lo:[1,0,0]
  v_pk_mul_f32 v[48:49], v[34:35], v[160:161] op_sel:[0,0] op_sel_hi:[1,0]
  v_pk_fma_f32 v[48:49], v[34:35], v[160:161], v[48:49] op_sel:[1,1,0] op_sel_hi:[0,1,1] neg_lo:[1,0,0]
  v_pk_mul_f32 v[22:23], v[58:59], v[162:163] op_sel:[0,0] op_sel_hi:[1,0]
  v_pk_fma_f32 v[22:23], v[58:59], v[162:163], v[22:23] op_sel:[1,1,0] op_sel_hi:[0,1,1] neg_lo:[1,0,0]
  ds_write_b64 v207, v[52:53] offset:0
  ds_write_b64 v207, v[60:61] offset:288
  ds_write_b64 v207, v[62:63] offset:576
  ds_write_b64 v207, v[56:57] offset:864
  ds_write_b64 v207, v[44:45] offset:1152
  ds_write_b64 v207, v[36:37] offset:1440
  ds_write_b64 v207, v[48:49] offset:1728
  ds_write_b64 v207, v[22:23] offset:2016
  ds_read_b64 v[30:31], v208 offset:0
  ds_read_b64 v[32:33], v208 offset:32
  ds_read_b64 v[40:41], v208 offset:64
  ds_read_b64 v[38:39], v208 offset:96
  ds_read_b64 v[20:21], v208 offset:128
  ds_read_b64 v[46:47], v208 offset:160
  ds_read_b64 v[42:43], v208 offset:192
  ds_read_b64 v[16:17], v208 offset:224
  s_waitcnt lgkmcnt(0)
  v_pk_add_f32 v[26:27], v[30:31], v[20:21]
  v_pk_add_f32 v[18:19], v[30:31], v[20:21] neg_lo:[0,1] neg_hi:[0,1]
  v_pk_add_f32 v[54:55], v[32:33], v[46:47]
  v_pk_add_f32 v[24:25], v[32:33], v[46:47] neg_lo:[0,1] neg_hi:[0,1]
  v_pk_add_f32 v[50:51], v[40:41], v[42:43]
  v_pk_add_f32 v[28:29], v[40:41], v[42:43] neg_lo:[0,1] neg_hi:[0,1]
  v_pk_add_f32 v[34:35], v[38:39], v[16:17]
  v_pk_add_f32 v[58:59], v[38:39], v[16:17] neg_lo:[0,1] neg_hi:[0,1]
  v_pk_add_f32 v[52:53], v[26:27], v[50:51]
  v_pk_add_f32 v[60:61], v[26:27], v[50:51] neg_lo:[0,1] neg_hi:[0,1]
  v_pk_add_f32 v[62:63], v[54:55], v[34:35]
  v_pk_add_f32 v[56:57], v[54:55], v[34:35] neg_lo:[0,1] neg_hi:[0,1]
  v_pk_add_f32 v[44:45], v[52:53], v[62:63]
  v_pk_add_f32 v[36:37], v[52:53], v[62:63] neg_lo:[0,1] neg_hi:[0,1]
  v_pk_add_f32 v[48:49], v[60:61], v[56:57] op_sel:[0,1] op_sel_hi:[1,0] neg_hi:[0,1]
  v_pk_add_f32 v[22:23], v[60:61], v[56:57] op_sel:[0,1] op_sel_hi:[1,0] neg_lo:[0,1]
  v_pk_add_f32 v[30:31], v[18:19], v[28:29] op_sel:[0,1] op_sel_hi:[1,0] neg_hi:[0,1]
  v_pk_add_f32 v[20:21], v[18:19], v[28:29] op_sel:[0,1] op_sel_hi:[1,0] neg_lo:[0,1]
  v_pk_add_f32 v[32:33], v[24:25], v[24:25] op_sel:[0,1] op_sel_hi:[1,0] neg_hi:[0,1]
  v_pk_add_f32 v[46:47], v[58:59], v[58:59] op_sel:[0,1] op_sel_hi:[1,0] neg_lo:[0,1]
  v_pk_add_f32 v[40:41], v[32:33], v[46:47] neg_lo:[0,1] neg_hi:[0,1]
  v_pk_add_f32 v[42:43], v[32:33], v[46:47]
  v_pk_fma_f32 v[38:39], v[40:41], v[202:203], v[30:31]
  v_pk_fma_f32 v[16:17], v[40:41], v[202:203], v[30:31] neg_lo:[1,0,0] neg_hi:[1,0,0]
  v_pk_fma_f32 v[26:27], v[42:43], v[202:203], v[20:21] op_sel:[1,0,0] op_sel_hi:[0,1,1] neg_hi:[1,0,0]
  v_pk_fma_f32 v[50:51], v[42:43], v[202:203], v[20:21] op_sel:[1,0,0] op_sel_hi:[0,1,1] neg_lo:[1,0,0]
  v_pk_mul_f32 v[54:55], v[38:39], v[164:165] op_sel:[0,0] op_sel_hi:[1,0]
  v_pk_fma_f32 v[54:55], v[38:39], v[164:165], v[54:55] op_sel:[1,1,0] op_sel_hi:[0,1,1] neg_lo:[1,0,0]
  v_pk_mul_f32 v[34:35], v[48:49], v[166:167] op_sel:[0,0] op_sel_hi:[1,0]
  v_pk_fma_f32 v[34:35], v[48:49], v[166:167], v[34:35] op_sel:[1,1,0] op_sel_hi:[0,1,1] neg_lo:[1,0,0]
  v_pk_mul_f32 v[52:53], v[26:27], v[168:169] op_sel:[0,0] op_sel_hi:[1,0]
  v_pk_fma_f32 v[52:53], v[26:27], v[168:169], v[52:53] op_sel:[1,1,0] op_sel_hi:[0,1,1] neg_lo:[1,0,0]
  v_pk_mul_f32 v[62:63], v[36:37], v[170:171] op_sel:[0,0] op_sel_hi:[1,0]
  v_pk_fma_f32 v[62:63], v[36:37], v[170:171], v[62:63] op_sel:[1,1,0] op_sel_hi:[0,1,1] neg_lo:[1,0,0]
  v_pk_mul_f32 v[60:61], v[16:17], v[172:173] op_sel:[0,0] op_sel_hi:[1,0]
  v_pk_fma_f32 v[60:61], v[16:17], v[172:173], v[60:61] op_sel:[1,1,0] op_sel_hi:[0,1,1] neg_lo:[1,0,0]
  v_pk_mul_f32 v[56:57], v[22:23], v[174:175] op_sel:[0,0] op_sel_hi:[1,0]
  v_pk_fma_f32 v[56:57], v[22:23], v[174:175], v[56:57] op_sel:[1,1,0] op_sel_hi:[0,1,1] neg_lo:[1,0,0]
  v_pk_mul_f32 v[18:19], v[50:51], v[176:177] op_sel:[0,0] op_sel_hi:[1,0]
  v_pk_fma_f32 v[18:19], v[50:51], v[176:177], v[18:19] op_sel:[1,1,0] op_sel_hi:[0,1,1] neg_lo:[1,0,0]
  ds_write_b64 v208, v[44:45] offset:0
  ds_write_b64 v208, v[54:55] offset:32
  ds_write_b64 v208, v[34:35] offset:64
  ds_write_b64 v208, v[52:53] offset:96
  ds_write_b64 v208, v[62:63] offset:128
  ds_write_b64 v208, v[60:61] offset:160
  ds_write_b64 v208, v[56:57] offset:192
  ds_write_b64 v208, v[18:19] offset:224
  ds_read_b128 v[16:19], v209 offset:0
  ds_read_b128 v[20:23], v209 offset:16
  ds_read_b128 v[24:27], v209 offset:32
  ds_read_b128 v[28:31], v209 offset:48
  s_waitcnt lgkmcnt(0)
  v_pk_add_f32 v[58:59], v[16:17], v[20:21]
  v_pk_add_f32 v[32:33], v[16:17], v[20:21] neg_lo:[0,1] neg_hi:[0,1]
  v_pk_add_f32 v[46:47], v[18:19], v[22:23]
  v_pk_add_f32 v[40:41], v[18:19], v[22:23] neg_lo:[0,1] neg_hi:[0,1]
  v_pk_add_f32 v[42:43], v[58:59], v[46:47]
  v_pk_add_f32 v[38:39], v[58:59], v[46:47] neg_lo:[0,1] neg_hi:[0,1]
  v_pk_add_f32 v[48:49], v[32:33], v[40:41] op_sel:[0,1] op_sel_hi:[1,0] neg_hi:[0,1]
  v_pk_add_f32 v[36:37], v[32:33], v[40:41] op_sel:[0,1] op_sel_hi:[1,0] neg_lo:[0,1]
  v_pk_add_f32 v[50:51], v[24:25], v[28:29]
  v_pk_add_f32 v[44:45], v[24:25], v[28:29] neg_lo:[0,1] neg_hi:[0,1]
  v_pk_add_f32 v[54:55], v[26:27], v[30:31]
  v_pk_add_f32 v[34:35], v[26:27], v[30:31] neg_lo:[0,1] neg_hi:[0,1]
  v_pk_add_f32 v[52:53], v[50:51], v[54:55]
  v_pk_add_f32 v[62:63], v[50:51], v[54:55] neg_lo:[0,1] neg_hi:[0,1]
  v_pk_add_f32 v[60:61], v[44:45], v[34:35] op_sel:[0,1] op_sel_hi:[1,0] neg_hi:[0,1]
  v_pk_add_f32 v[56:57], v[44:45], v[34:35] op_sel:[0,1] op_sel_hi:[1,0] neg_lo:[0,1]
  s_waitcnt vmcnt(0)
  s_cmp_eq_u32 s45, 0
  s_cbranch_scc1 L_wqh_22
  s_add_u32 s49, s58, 0
  buffer_load_dwordx4 v[64:67], v14, s[28:31], s49 offen sc1
  s_add_u32 s49, s58, 1024
  buffer_load_dwordx4 v[68:71], v14, s[28:31], s49 offen sc1
  s_add_u32 s49, s58, 2048
  buffer_load_dwordx4 v[72:75], v14, s[28:31], s49 offen sc1
L_wqh_22:
  v_lshlrev_b32 v16, 16, v178
  v_and_b32 v17, 0xffff0000, v178
  v_pk_mul_f32 v[20:21], v[42:43], v[16:17] op_sel:[0,0] op_sel_hi:[1,0]
  v_pk_fma_f32 v[20:21], v[42:43], v[16:17], v[20:21] op_sel:[1,1,0] op_sel_hi:[0,1,1] neg_lo:[1,0,0]
  v_lshlrev_b32 v16, 16, v179
  v_and_b32 v17, 0xffff0000, v179
  v_pk_mul_f32 v[18:19], v[48:49], v[16:17] op_sel:[0,0] op_sel_hi:[1,0]
  v_pk_fma_f32 v[18:19], v[48:49], v[16:17], v[18:19] op_sel:[1,1,0] op_sel_hi:[0,1,1] neg_lo:[1,0,0]
  v_lshlrev_b32 v16, 16, v180
  v_and_b32 v17, 0xffff0000, v180
  v_pk_mul_f32 v[22:23], v[38:39], v[16:17] op_sel:[0,0] op_sel_hi:[1,0]
  v_pk_fma_f32 v[22:23], v[38:39], v[16:17], v[22:23] op_sel:[1,1,0] op_sel_hi:[0,1,1] neg_lo:[1,0,0]
  v_lshlrev_b32 v16, 16, v181
  v_and_b32 v17, 0xffff0000, v181
  v_pk_mul_f32 v[58:59], v[36:37], v[16:17] op_sel:[0,0] op_sel_hi:[1,0]
  v_pk_fma_f32 v[58:59], v[36:37], v[16:17], v[58:59] op_sel:[1,1,0] op_sel_hi:[0,1,1] neg_lo:[1,0,0]
  v_lshlrev_b32 v16, 16, v182
  v_and_b32 v17, 0xffff0000, v182
  v_pk_mul_f32 v[46:47], v[52:53], v[16:17] op_sel:[0,0] op_sel_hi:[1,0]
  v_pk_fma_f32 v[46:47], v[52:53], v[16:17], v[46:47] op_sel:[1,1,0] op_sel_hi:[0,1,1] neg_lo:[1,0,0]
  v_lshlrev_b32 v16, 16, v183
  v_and_b32 v17, 0xffff0000, v183
  v_pk_mul_f32 v[32:33], v[60:61], v[16:17] op_sel:[0,0] op_sel_hi:[1,0]
  v_pk_fma_f32 v[32:33], v[60:61], v[16:17], v[32:33] op_sel:[1,1,0] op_sel_hi:[0,1,1] neg_lo:[1,0,0]
  v_lshlrev_b32 v16, 16, v184
  v_and_b32 v17, 0xffff0000, v184
  v_pk_mul_f32 v[40:41], v[62:63], v[16:17] op_sel:[0,0] op_sel_hi:[1,0]
  v_pk_fma_f32 v[40:41], v[62:63], v[16:17], v[40:41] op_sel:[1,1,0] op_sel_hi:[0,1,1] neg_lo:[1,0,0]
  v_lshlrev_b32 v16, 16, v185
  v_and_b32 v17, 0xffff0000, v185
  v_pk_mul_f32 v[24:25], v[56:57], v[16:17] op_sel:[0,0] op_sel_hi:[1,0]
  v_pk_fma_f32 v[24:25], v[56:57], v[16:17], v[24:25] op_sel:[1,1,0] op_sel_hi:[0,1,1] neg_lo:[1,0,0]
  s_cmp_eq_u32 s45, 0
  s_cbranch_scc1 L_wqh_23
  s_add_u32 s49, s58, 3072
  buffer_load_dwordx4 v[76:79], v14, s[28:31], s49 offen sc1
  s_add_u32 s49, s58, 4096
  buffer_load_dwordx4 v[80:83], v14, s[28:31], s49 offen sc1
  s_add_u32 s49, s58, 5120
  buffer_load_dwordx4 v[84:87], v14, s[28:31], s49 offen sc1
L_wqh_23:
  v_pk_add_f32 v[28:29], v[20:21], v[22:23]
  v_pk_add_f32 v[26:27], v[20:21], v[22:23] neg_lo:[0,1] neg_hi:[0,1]
  v_pk_add_f32 v[30:31], v[18:19], v[58:59]
  v_pk_add_f32 v[50:51], v[18:19], v[58:59] neg_lo:[0,1] neg_hi:[0,1]
  v_pk_add_f32 v[16:17], v[28:29], v[30:31]
  v_pk_add_f32 v[20:21], v[28:29], v[30:31] neg_lo:[0,1] neg_hi:[0,1]
  v_pk_add_f32 v[18:19], v[26:27], v[50:51] op_sel:[0,1] op_sel_hi:[1,0] neg_lo:[0,1]
  v_pk_add_f32 v[22:23], v[26:27], v[50:51] op_sel:[0,1] op_sel_hi:[1,0] neg_hi:[0,1]
  v_pk_add_f32 v[54:55], v[46:47], v[40:41]
  v_pk_add_f32 v[44:45], v[46:47], v[40:41] neg_lo:[0,1] neg_hi:[0,1]
  v_pk_add_f32 v[34:35], v[32:33], v[24:25]
  v_pk_add_f32 v[42:43], v[32:33], v[24:25] neg_lo:[0,1] neg_hi:[0,1]
  v_pk_add_f32 v[24:25], v[54:55], v[34:35]
  v_pk_add_f32 v[28:29], v[54:55], v[34:35] neg_lo:[0,1] neg_hi:[0,1]
  v_pk_add_f32 v[26:27], v[44:45], v[42:43] op_sel:[0,1] op_sel_hi:[1,0] neg_lo:[0,1]
  v_pk_add_f32 v[30:31], v[44:45], v[42:43] op_sel:[0,1] op_sel_hi:[1,0] neg_hi:[0,1]
  ds_write_b128 v209, v[16:19] offset:0
  ds_write_b128 v209, v[20:23] offset:16
  ds_write_b128 v209, v[24:27] offset:32
  ds_write_b128 v209, v[28:31] offset:48
  ds_read_b64 v[48:49], v208 offset:0
  ds_read_b64 v[38:39], v208 offset:32
  ds_read_b64 v[36:37], v208 offset:64
  ds_read_b64 v[52:53], v208 offset:96
  ds_read_b64 v[60:61], v208 offset:128
  ds_read_b64 v[62:63], v208 offset:160
  ds_read_b64 v[56:57], v208 offset:192
  ds_read_b64 v[58:59], v208 offset:224
  s_waitcnt lgkmcnt(0)
  s_cmp_eq_u32 s45, 0
  s_cbranch_scc1 L_wqh_24
  s_add_u32 s49, s58, 6144
  buffer_load_dwordx4 v[88:91], v14, s[28:31], s49 offen sc1
  s_add_u32 s49, s58, 7168
  buffer_load_dwordx4 v[92:95], v14, s[28:31], s49 offen sc1
  s_add_u32 s49, s58, 8192
  buffer_load_dwordx4 v[96:99], v14, s[28:31], s49 offen sc1
L_wqh_24:
  v_pk_mul_f32 v[50:51], v[38:39], v[164:165] op_sel:[0,0] op_sel_hi:[1,0]
  v_pk_fma_f32 v[50:51], v[38:39], v[164:165], v[50:51] op_sel:[1,1,0] op_sel_hi:[0,1,1] neg_hi:[1,0,0]
  v_pk_mul_f32 v[46:47], v[36:37], v[166:167] op_sel:[0,0] op_sel_hi:[1,0]
  v_pk_fma_f32 v[46:47], v[36:37], v[166:167], v[46:47] op_sel:[1,1,0] op_sel_hi:[0,1,1] neg_hi:[1,0,0]
  v_pk_mul_f32 v[40:41], v[52:53], v[168:169] op_sel:[0,0] op_sel_hi:[1,0]
  v_pk_fma_f32 v[40:41], v[52:53], v[168:169], v[40:41] op_sel:[1,1,0] op_sel_hi:[0,1,1] neg_hi:[1,0,0]
  v_pk_mul_f32 v[32:33], v[60:61], v[170:171] op_sel:[0,0] op_sel_hi:[1,0]
  v_pk_fma_f32 v[32:33], v[60:61], v[170:171], v[32:33] op_sel:[1,1,0] op_sel_hi:[0,1,1] neg_hi:[1,0,0]
  v_pk_mul_f32 v[54:55], v[62:63], v[172:173] op_sel:[0,0] op_sel_hi:[1,0]
  v_pk_fma_f32 v[54:55], v[62:63], v[172:173], v[54:55] op_sel:[1,1,0] op_sel_hi:[0,1,1] neg_hi:[1,0,0]
  v_pk_mul_f32 v[34:35], v[56:57], v[174:175] op_sel:[0,0] op_sel_hi:[1,0]
  v_pk_fma_f32 v[34:35], v[56:57], v[174:175], v[34:35] op_sel:[1,1,0] op_sel_hi:[0,1,1] neg_hi:[1,0,0]
  v_pk_mul_f32 v[44:45], v[58:59], v[176:177] op_sel:[0,0] op_sel_hi:[1,0]
  v_pk_fma_f32 v[44:45], v[58:59], v[176:177], v[44:45] op_sel:[1,1,0] op_sel_hi:[0,1,1] neg_hi:[1,0,0]
  v_pk_add_f32 v[42:43], v[48:49], v[32:33]
  v_pk_add_f32 v[16:17], v[48:49], v[32:33] neg_lo:[0,1] neg_hi:[0,1]
  v_pk_add_f32 v[18:19], v[50:51], v[54:55]
  v_pk_add_f32 v[20:21], v[50:51], v[54:55] neg_lo:[0,1] neg_hi:[0,1]
  v_pk_add_f32 v[22:23], v[46:47], v[34:35]
  v_pk_add_f32 v[24:25], v[46:47], v[34:35] neg_lo:[0,1] neg_hi:[0,1]
  v_pk_add_f32 v[26:27], v[40:41], v[44:45]
  v_pk_add_f32 v[28:29], v[40:41], v[44:45] neg_lo:[0,1] neg_hi:[0,1]
  v_pk_add_f32 v[30:31], v[42:43], v[22:23]
  v_pk_add_f32 v[38:39], v[42:43], v[22:23] neg_lo:[0,1] neg_hi:[0,1]
  v_pk_add_f32 v[36:37], v[18:19], v[26:27]
  v_pk_add_f32 v[52:53], v[18:19], v[26:27] neg_lo:[0,1] neg_hi:[0,1]
  v_pk_add_f32 v[60:61], v[30:31], v[36:37]
  v_pk_add_f32 v[62:63], v[30:31], v[36:37] neg_lo:[0,1] neg_hi:[0,1]
  v_pk_add_f32 v[56:57], v[38:39], v[52:53] op_sel:[0,1] op_sel_hi:[1,0] neg_lo:[0,1]
  v_pk_add_f32 v[58:59], v[38:39], v[52:53] op_sel:[0,1] op_sel_hi:[1,0] neg_hi:[0,1]
  v_pk_add_f32 v[48:49], v[16:17], v[24:25] op_sel:[0,1] op_sel_hi:[1,0] neg_lo:[0,1]
  v_pk_add_f32 v[32:33], v[16:17], v[24:25] op_sel:[0,1] op_sel_hi:[1,0] neg_hi:[0,1]
  v_pk_add_f32 v[50:51], v[20:21], v[20:21] op_sel:[0,1] op_sel_hi:[1,0] neg_lo:[0,1]
  v_pk_add_f32 v[54:55], v[28:29], v[28:29] op_sel:[0,1] op_sel_hi:[1,0] neg_hi:[0,1]
  v_pk_add_f32 v[46:47], v[50:51], v[54:55] neg_lo:[0,1] neg_hi:[0,1]
  v_pk_add_f32 v[34:35], v[50:51], v[54:55]
  v_pk_fma_f32 v[40:41], v[46:47], v[202:203], v[48:49]
  v_pk_fma_f32 v[44:45], v[46:47], v[202:203], v[48:49] neg_lo:[1,0,0] neg_hi:[1,0,0]
  v_pk_fma_f32 v[42:43], v[34:35], v[202:203], v[32:33] op_sel:[1,0,0] op_sel_hi:[0,1,1] neg_lo:[1,0,0]
  v_pk_fma_f32 v[22:23], v[34:35], v[202:203], v[32:33] op_sel:[1,0,0] op_sel_hi:[0,1,1] neg_hi:[1,0,0]
  ds_write_b64 v208, v[60:61] offset:0
  ds_write_b64 v208, v[40:41] offset:32
  ds_write_b64 v208, v[56:57] offset:64
  ds_write_b64 v208, v[42:43] offset:96
  ds_write_b64 v208, v[62:63] offset:128
  ds_write_b64 v208, v[44:45] offset:160
  ds_write_b64 v208, v[58:59] offset:192
  ds_write_b64 v208, v[22:23] offset:224
  ds_read_b64 v[18:19], v207 offset:0
  ds_read_b64 v[26:27], v207 offset:288
  ds_read_b64 v[30:31], v207 offset:576
  ds_read_b64 v[36:37], v207 offset:864
  ds_read_b64 v[38:39], v207 offset:1152
  ds_read_b64 v[52:53], v207 offset:1440
  ds_read_b64 v[16:17], v207 offset:1728
  ds_read_b64 v[24:25], v207 offset:2016
  s_waitcnt lgkmcnt(0)
  s_cmp_eq_u32 s45, 0
  s_cbranch_scc1 L_wqh_25
  s_add_u32 s49, s58, 9216
  buffer_load_dwordx4 v[100:103], v14, s[28:31], s49 offen sc1
  s_add_u32 s49, s58, 10240
  buffer_load_dwordx4 v[104:107], v14, s[28:31], s49 offen sc1
  s_add_u32 s49, s58, 11264
  buffer_load_dwordx4 v[108:111], v14, s[28:31], s49 offen sc1
L_wqh_25:
  v_pk_mul_f32 v[20:21], v[26:27], v[150:151] op_sel:[0,0] op_sel_hi:[1,0]
  v_pk_fma_f32 v[20:21], v[26:27], v[150:151], v[20:21] op_sel:[1,1,0] op_sel_hi:[0,1,1] neg_hi:[1,0,0]
  v_pk_mul_f32 v[28:29], v[30:31], v[152:153] op_sel:[0,0] op_sel_hi:[1,0]
  v_pk_fma_f32 v[28:29], v[30:31], v[152:153], v[28:29] op_sel:[1,1,0] op_sel_hi:[0,1,1] neg_hi:[1,0,0]
  v_pk_mul_f32 v[50:51], v[36:37], v[154:155] op_sel:[0,0] op_sel_hi:[1,0]
  v_pk_fma_f32 v[50:51], v[36:37], v[154:155], v[50:51] op_sel:[1,1,0] op_sel_hi:[0,1,1] neg_hi:[1,0,0]
  v_pk_mul_f32 v[54:55], v[38:39], v[156:157] op_sel:[0,0] op_sel_hi:[1,0]
  v_pk_fma_f32 v[54:55], v[38:39], v[156:157], v[54:55] op_sel:[1,1,0] op_sel_hi:[0,1,1] neg_hi:[1,0,0]
  v_pk_mul_f32 v[46:47], v[52:53], v[158:159] op_sel:[0,0] op_sel_hi:[1,0]
  v_pk_fma_f32 v[46:47], v[52:53], v[158:159], v[46:47] op_sel:[1,1,0] op_sel_hi:[0,1,1] neg_hi:[1,0,0]
  v_pk_mul_f32 v[48:49], v[16:17], v[160:161] op_sel:[0,0] op_sel_hi:[1,0]
  v_pk_fma_f32 v[48:49], v[16:17], v[160:161], v[48:49] op_sel:[1,1,0] op_sel_hi:[0,1,1] neg_hi:[1,0,0]
  v_pk_mul_f32 v[34:35], v[24:25], v[162:163] op_sel:[0,0] op_sel_hi:[1,0]
  v_pk_fma_f32 v[34:35], v[24:25], v[162:163], v[34:35] op_sel:[1,1,0] op_sel_hi:[0,1,1] neg_hi:[1,0,0]
  v_pk_add_f32 v[32:33], v[18:19], v[54:55]
  v_pk_add_f32 v[60:61], v[18:19], v[54:55] neg_lo:[0,1] neg_hi:[0,1]
  v_pk_add_f32 v[40:41], v[20:21], v[46:47]
  v_pk_add_f32 v[56:57], v[20:21], v[46:47] neg_lo:[0,1] neg_hi:[0,1]
  v_pk_add_f32 v[42:43], v[28:29], v[48:49]
  v_pk_add_f32 v[62:63], v[28:29], v[48:49] neg_lo:[0,1] neg_hi:[0,1]
  v_pk_add_f32 v[44:45], v[50:51], v[34:35]
  v_pk_add_f32 v[58:59], v[50:51], v[34:35] neg_lo:[0,1] neg_hi:[0,1]
  v_pk_add_f32 v[22:23], v[32:33], v[42:43]
  v_pk_add_f32 v[26:27], v[32:33], v[42:43] neg_lo:[0,1] neg_hi:[0,1]
  v_pk_add_f32 v[30:31], v[40:41], v[44:45]
  v_pk_add_f32 v[36:37], v[40:41], v[44:45] neg_lo:[0,1] neg_hi:[0,1]
  v_pk_add_f32 v[38:39], v[22:23], v[30:31]
  v_pk_add_f32 v[52:53], v[22:23], v[30:31] neg_lo:[0,1] neg_hi:[0,1]
  v_pk_add_f32 v[16:17], v[26:27], v[36:37] op_sel:[0,1] op_sel_hi:[1,0] neg_lo:[0,1]
  v_pk_add_f32 v[24:25], v[26:27], v[36:37] op_sel:[0,1] op_sel_hi:[1,0] neg_hi:[0,1]
  v_pk_add_f32 v[18:19], v[60:61], v[62:63] op_sel:[0,1] op_sel_hi:[1,0] neg_lo:[0,1]
  v_pk_add_f32 v[54:55], v[60:61], v[62:63] op_sel:[0,1] op_sel_hi:[1,0] neg_hi:[0,1]
  v_pk_add_f32 v[20:21], v[56:57], v[56:57] op_sel:[0,1] op_sel_hi:[1,0] neg_lo:[0,1]
  v_pk_add_f32 v[46:47], v[58:59], v[58:59] op_sel:[0,1] op_sel_hi:[1,0] neg_hi:[0,1]
  v_pk_add_f32 v[28:29], v[20:21], v[46:47] neg_lo:[0,1] neg_hi:[0,1]
  v_pk_add_f32 v[48:49], v[20:21], v[46:47]
  v_pk_fma_f32 v[50:51], v[28:29], v[202:203], v[18:19]
  v_pk_fma_f32 v[34:35], v[28:29], v[202:203], v[18:19] neg_lo:[1,0,0] neg_hi:[1,0,0]
  v_pk_fma_f32 v[32:33], v[48:49], v[202:203], v[54:55] op_sel:[1,0,0] op_sel_hi:[0,1,1] neg_lo:[1,0,0]
  v_pk_fma_f32 v[42:43], v[48:49], v[202:203], v[54:55] op_sel:[1,0,0] op_sel_hi:[0,1,1] neg_hi:[1,0,0]
  s_cmp_eq_u32 s45, 0
  s_cbranch_scc1 L_wqh_26
  s_add_u32 s49, s58, 12288
  buffer_load_dwordx4 v[112:115], v14, s[28:31], s49 offen sc1
  s_add_u32 s49, s58, 13312
  buffer_load_dwordx4 v[116:119], v14, s[28:31], s49 offen sc1
  s_add_u32 s49, s58, 14336
  buffer_load_dwordx4 v[120:123], v14, s[28:31], s49 offen sc1
L_wqh_26:
  ds_write_b64 v207, v[38:39] offset:0
  ds_write_b64 v207, v[50:51] offset:256
  ds_write_b64 v207, v[16:17] offset:512
  ds_write_b64 v207, v[32:33] offset:768
  ds_write_b64 v207, v[52:53] offset:1024
  ds_write_b64 v207, v[34:35] offset:1280
  ds_write_b64 v207, v[24:25] offset:1536
  ds_write_b64 v207, v[42:43] offset:1792
  s_waitcnt lgkmcnt(0)
  s_barrier
  ds_read_b64 v[40:41], v206 offset:0
  ds_read_b64 v[44:45], v206 offset:2304
  ds_read_b64 v[22:23], v206 offset:4608
  ds_read_b64 v[30:31], v206 offset:6912
  ds_read_b64 v[26:27], v206 offset:9216
  ds_read_b64 v[36:37], v206 offset:11520
  ds_read_b64 v[60:61], v206 offset:13824
  ds_read_b64 v[62:63], v206 offset:16128
  s_waitcnt lgkmcnt(0)
  s_cmp_eq_u32 s45, 0
  s_cbranch_scc1 L_wqh_27
  s_add_u32 s49, s58, 15360
  buffer_load_dwordx4 v[124:127], v14, s[28:31], s49 offen sc1
  s_add_u32 s49, s58, 16384
  buffer_load_dwordx4 v[128:131], v14, s[28:31], s49 offen sc1
  s_add_u32 s49, s58, 17408
  buffer_load_dwordx4 v[132:135], v14, s[28:31], s49 offen sc1
L_wqh_27:
  v_pk_mul_f32 v[56:57], v[44:45], v[136:137] op_sel:[0,0] op_sel_hi:[1,0]
  v_pk_fma_f32 v[56:57], v[44:45], v[136:137], v[56:57] op_sel:[1,1,0] op_sel_hi:[0,1,1] neg_hi:[1,0,0]
  v_pk_mul_f32 v[58:59], v[22:23], v[138:139] op_sel:[0,0] op_sel_hi:[1,0]
  v_pk_fma_f32 v[58:59], v[22:23], v[138:139], v[58:59] op_sel:[1,1,0] op_sel_hi:[0,1,1] neg_hi:[1,0,0]
  v_pk_mul_f32 v[20:21], v[30:31], v[140:141] op_sel:[0,0] op_sel_hi:[1,0]
  v_pk_fma_f32 v[20:21], v[30:31], v[140:141], v[20:21] op_sel:[1,1,0] op_sel_hi:[0,1,1] neg_hi:[1,0,0]
  v_pk_mul_f32 v[46:47], v[26:27], v[142:143] op_sel:[0,0] op_sel_hi:[1,0]
  v_pk_fma_f32 v[46:47], v[26:27], v[142:143], v[46:47] op_sel:[1,1,0] op_sel_hi:[0,1,1] neg_hi:[1,0,0]
  v_pk_mul_f32 v[28:29], v[36:37], v[144:145] op_sel:[0,0] op_sel_hi:[1,0]
  v_pk_fma_f32 v[28:29], v[36:37], v[144:145], v[28:29] op_sel:[1,1,0] op_sel_hi:[0,1,1] neg_hi:[1,0,0]
  v_pk_mul_f32 v[18:19], v[60:61], v[146:147] op_sel:[0,0] op_sel_hi:[1,0]
  v_pk_fma_f32 v[18:19], v[60:61], v[146:147], v[18:19] op_sel:[1,1,0] op_sel_hi:[0,1,1] neg_hi:[1,0,0]
  v_pk_mul_f32 v[48:49], v[62:63], v[148:149] op_sel:[0,0] op_sel_hi:[1,0]
  v_pk_fma_f32 v[48:49], v[62:63], v[148:149], v[48:49] op_sel:[1,1,0] op_sel_hi:[0,1,1] neg_hi:[1,0,0]
  v_pk_add_f32 v[54:55], v[40:41], v[46:47]
  v_pk_add_f32 v[38:39], v[40:41], v[46:47] neg_lo:[0,1] neg_hi:[0,1]
  v_pk_add_f32 v[50:51], v[56:57], v[28:29]
  v_pk_add_f32 v[16:17], v[56:57], v[28:29] neg_lo:[0,1] neg_hi:[0,1]
  v_pk_add_f32 v[32:33], v[58:59], v[18:19]
  v_pk_add_f32 v[52:53], v[58:59], v[18:19] neg_lo:[0,1] neg_hi:[0,1]
  v_pk_add_f32 v[34:35], v[20:21], v[48:49]
  v_pk_add_f32 v[24:25], v[20:21], v[48:49] neg_lo:[0,1] neg_hi:[0,1]
  v_pk_add_f32 v[42:43], v[54:55], v[32:33]
  v_pk_add_f32 v[44:45], v[54:55], v[32:33] neg_lo:[0,1] neg_hi:[0,1]
  v_pk_add_f32 v[22:23], v[50:51], v[34:35]
  v_pk_add_f32 v[30:31], v[50:51], v[34:35] neg_lo:[0,1] neg_hi:[0,1]
  v_pk_add_f32 v[26:27], v[42:43], v[22:23]
  v_pk_add_f32 v[36:37], v[42:43], v[22:23] neg_lo:[0,1] neg_hi:[0,1]
  v_pk_add_f32 v[60:61], v[44:45], v[30:31] op_sel:[0,1] op_sel_hi:[1,0] neg_lo:[0,1]
  v_pk_add_f32 v[62:63], v[44:45], v[30:31] op_sel:[0,1] op_sel_hi:[1,0] neg_hi:[0,1]
  v_pk_add_f32 v[40:41], v[38:39], v[52:53] op_sel:[0,1] op_sel_hi:[1,0] neg_lo:[0,1]
  v_pk_add_f32 v[46:47], v[38:39], v[52:53] op_sel:[0,1] op_sel_hi:[1,0] neg_hi:[0,1]
  v_pk_add_f32 v[56:57], v[16:17], v[16:17] op_sel:[0,1] op_sel_hi:[1,0] neg_lo:[0,1]
  v_pk_add_f32 v[28:29], v[24:25], v[24:25] op_sel:[0,1] op_sel_hi:[1,0] neg_hi:[0,1]
  v_pk_add_f32 v[58:59], v[56:57], v[28:29] neg_lo:[0,1] neg_hi:[0,1]
  v_pk_add_f32 v[18:19], v[56:57], v[28:29]
  v_pk_fma_f32 v[20:21], v[58:59], v[202:203], v[40:41]
  v_pk_fma_f32 v[48:49], v[58:59], v[202:203], v[40:41] neg_lo:[1,0,0] neg_hi:[1,0,0]
  v_pk_fma_f32 v[54:55], v[18:19], v[202:203], v[46:47] op_sel:[1,0,0] op_sel_hi:[0,1,1] neg_lo:[1,0,0]
  v_pk_fma_f32 v[32:33], v[18:19], v[202:203], v[46:47] op_sel:[1,0,0] op_sel_hi:[0,1,1] neg_hi:[1,0,0]
  s_mov_b32 s79, s45
  v_lshlrev_b32 v4, 3, v5
  s_lshl_b32 s54, s51, 2
  s_add_u32 s54, s54, 45056
  v_add_u32 v4, s54, v4
  v_pk_fma_f32 v[26:27], v[26:27], v[204:205], v[186:187]
  v_cvt_pk_bf16_f32 v26, v26, v27
  ds_write_b32 v4, v26 offset:0
  v_pk_fma_f32 v[20:21], v[20:21], v[204:205], v[188:189]
  v_cvt_pk_bf16_f32 v20, v20, v21
  ds_write_b32 v4, v20 offset:2048
  v_pk_fma_f32 v[60:61], v[60:61], v[204:205], v[190:191]
  v_cvt_pk_bf16_f32 v60, v60, v61
  ds_write_b32 v4, v60 offset:4096
  v_pk_fma_f32 v[54:55], v[54:55], v[204:205], v[192:193]
  v_cvt_pk_bf16_f32 v54, v54, v55
  ds_write_b32 v4, v54 offset:6144
  v_pk_fma_f32 v[36:37], v[36:37], v[204:205], v[194:195]
  v_cvt_pk_bf16_f32 v36, v36, v37
  ds_write_b32 v4, v36 offset:8192
  v_pk_fma_f32 v[48:49], v[48:49], v[204:205], v[196:197]
  v_cvt_pk_bf16_f32 v48, v48, v49
  ds_write_b32 v4, v48 offset:10240
  v_pk_fma_f32 v[62:63], v[62:63], v[204:205], v[198:199]
  v_cvt_pk_bf16_f32 v62, v62, v63
  ds_write_b32 v4, v62 offset:12288
  v_pk_fma_f32 v[32:33], v[32:33], v[204:205], v[200:201]
  v_cvt_pk_bf16_f32 v32, v32, v33
  ds_write_b32 v4, v32 offset:14336
  s_waitcnt lgkmcnt(0)
  s_barrier
  v_lshlrev_b32 v4, 4, v0
  ds_read_b128 v[16:19], v4 offset:45056
  ds_read_b128 v[20:23], v4 offset:53248
  v_lshrrev_b32 v6, 4, v0
  v_mul_u32_u24 v6, 36864, v6
  v_lshrrev_b32 v7, 3, v0
  v_and_b32 v7, 1, v7
  v_xor_b32 v7, s52, v7
  v_lshl_add_u32 v6, v7, 7, v6
  v_and_b32 v7, 7, v0
  v_lshl_add_u32 v6, v7, 4, v6
  s_lshl_b32 s53, s2, 8
  s_add_u32 s53, s53, s73
  s_add_u32 s50, s53, 1179648
  s_waitcnt lgkmcnt(0)
  buffer_store_dwordx4 v[16:19], v6, s[28:31], s53 offen sc1
  buffer_store_dwordx4 v[20:23], v6, s[28:31], s50 offen sc1
  s_branch L_sdone_17
L_nofft_16:
  s_waitcnt vmcnt(0)
  s_cmp_lg_u32 s45, 0
  s_cbranch_scc1 L_prep5_18
  s_and_b32 s62, s2, 7
  s_sub_u32 s63, s2, 144
  s_lshr_b32 s63, s63, 3
  s_cmp_ge_u32 s62, 5
  s_cbranch_scc1 L_prephi_31
  s_cmp_ge_u32 s63, 10
  s_cbranch_scc1 L_prepo4_32
  s_mov_b32 s60, s62
  s_mov_b32 s61, s63
  s_and_b32 s56, s26, 1
  v_lshrrev_b32 v4, 3, v1
  v_bfe_u32 v5, v4, 1, 1
  s_lshl_b32 s55, s56, 1
  v_or_b32 v5, s55, v5
  v_bfe_u32 v6, v1, 1, 2
  v_xor_b32 v5, v5, v6
  v_and_b32 v6, 1, v1
  v_lshlrev_b32 v6, 4, v6
  s_cmp_eq_u32 s61, 9
  s_cbranch_scc1 L_kvjob_34
  s_mov_b32 s32, s12
  s_mov_b32 s33, s13
  s_mov_b32 s34, 663552
  s_mov_b32 s35, 0x20000
  v_mul_u32_u24 v7, 1152, v4
  v_lshl_add_u32 v7, v5, 5, v7
  v_add_u32 v7, v7, v6
  s_lshl_b32 s54, s61, 7
  s_add_u32 s50, s26, 0
  s_mul_i32 s52, s50, 9216
  s_add_u32 s52, s52, s54
  s_lshl_b32 m0, s50, 10
  s_nop 0
  buffer_load_dwordx4 v7, s[32:35], s52 offen lds
  s_add_u32 s50, s26, 8
  s_mul_i32 s52, s50, 9216
  s_add_u32 s52, s52, s54
  s_lshl_b32 m0, s50, 10
  s_nop 0
  buffer_load_dwordx4 v7, s[32:35], s52 offen lds
  s_add_u32 s50, s26, 16
  s_mul_i32 s52, s50, 9216
  s_add_u32 s52, s52, s54
  s_lshl_b32 m0, s50, 10
  s_nop 0
  buffer_load_dwordx4 v7, s[32:35], s52 offen lds
  s_add_u32 s50, s26, 24
  s_mul_i32 s52, s50, 9216
  s_add_u32 s52, s52, s54
  s_lshl_b32 m0, s50, 10
  s_nop 0
  buffer_load_dwordx4 v7, s[32:35], s52 offen lds
  s_add_u32 s50, s26, 32
  s_mul_i32 s52, s50, 9216
  s_add_u32 s52, s52, s54
  s_lshl_b32 m0, s50, 10
  s_nop 0
  buffer_load_dwordx4 v7, s[32:35], s52 offen lds
  s_add_u32 s50, s26, 40
  s_mul_i32 s52, s50, 9216
  s_add_u32 s52, s52, s54
  s_lshl_b32 m0, s50, 10
  s_nop 0
  buffer_load_dwordx4 v7, s[32:35], s52 offen lds
  s_add_u32 s50, s26, 48
  s_mul_i32 s52, s50, 9216
  s_add_u32 s52, s52, s54
  s_lshl_b32 m0, s50, 10
  s_nop 0
  buffer_load_dwordx4 v7, s[32:35], s52 offen lds
  s_add_u32 s50, s26, 56
  s_mul_i32 s52, s50, 9216
  s_add_u32 s52, s52, s54
  s_lshl_b32 m0, s50, 10
  s_nop 0
  buffer_load_dwordx4 v7, s[32:35], s52 offen lds
  s_add_u32 s50, s26, 64
  s_mul_i32 s52, s50, 9216
  s_add_u32 s52, s52, s54
  s_lshl_b32 m0, s50, 10
  s_nop 0
  buffer_load_dwordx4 v7, s[32:35], s52 offen lds
  s_branch L_staged_35
L_kvjob_34:
  s_mov_b32 s32, s14
  s_mov_b32 s33, s15
  s_mov_b32 s34, 20736
  s_mov_b32 s35, 0x20000
  s_mov_b32 s36, s16
  s_mov_b32 s37, s17
  s_mov_b32 s38, 20736
  s_mov_b32 s39, 0x20000
  v_mul_u32_u24 v7, 36, v4
  v_lshrrev_b32 v13, 1, v5
  v_lshl_add_u32 v7, v13, 5, v7
  v_add_u32 v7, v7, v6
  v_and_b32 v13, 1, v5
  v_cmp_eq_u32 s[62:63], 0, v13
  s_add_u32 s50, s26, 0
  s_mul_i32 s52, s50, 288
  v_add_u32 v14, s52, v7
  s_lshl_b32 m0, s50, 10
  s_mov_b64 exec, s[62:63]
  buffer_load_dwordx4 v14, s[32:35], 0 offen lds
  s_not_b64 exec, s[62:63]
  buffer_load_dwordx4 v14, s[36:39], 0 offen lds
  s_mov_b64 exec, -1
  s_add_u32 s50, s26, 8
  s_mul_i32 s52, s50, 288
  v_add_u32 v14, s52, v7
  s_lshl_b32 m0, s50, 10
  s_mov_b64 exec, s[62:63]
  buffer_load_dwordx4 v14, s[32:35], 0 offen lds
  s_not_b64 exec, s[62:63]
  buffer_load_dwordx4 v14, s[36:39], 0 offen lds
  s_mov_b64 exec, -1
  s_add_u32 s50, s26, 16
  s_mul_i32 s52, s50, 288
  v_add_u32 v14, s52, v7
  s_lshl_b32 m0, s50, 10
  s_mov_b64 exec, s[62:63]
  buffer_load_dwordx4 v14, s[32:35], 0 offen lds
  s_not_b64 exec, s[62:63]
  buffer_load_dwordx4 v14, s[36:39], 0 offen lds
  s_mov_b64 exec, -1
  s_add_u32 s50, s26, 24
  s_mul_i32 s52, s50, 288
  v_add_u32 v14, s52, v7
  s_lshl_b32 m0, s50, 10
  s_mov_b64 exec, s[62:63]
  buffer_load_dwordx4 v14, s[32:35], 0 offen lds
  s_not_b64 exec, s[62:63]
  buffer_load_dwordx4 v14, s[36:39], 0 offen lds
  s_mov_b64 exec, -1
  s_add_u32 s50, s26, 32
  s_mul_i32 s52, s50, 288
  v_add_u32 v14, s52, v7
  s_lshl_b32 m0, s50, 10
  s_mov_b64 exec, s[62:63]
  buffer_load_dwordx4 v14, s[32:35], 0 offen lds
  s_not_b64 exec, s[62:63]
  buffer_load_dwordx4 v14, s[36:39], 0 offen lds
  s_mov_b64 exec, -1
  s_add_u32 s50, s26, 40
  s_mul_i32 s52, s50, 288
  v_add_u32 v14, s52, v7
  s_lshl_b32 m0, s50, 10
  s_mov_b64 exec, s[62:63]
  buffer_load_dwordx4 v14, s[32:35], 0 offen lds
  s_not_b64 exec, s[62:63]
  buffer_load_dwordx4 v14, s[36:39], 0 offen lds
  s_mov_b64 exec, -1
  s_add_u32 s50, s26, 48
  s_mul_i32 s52, s50, 288
  v_add_u32 v14, s52, v7
  s_lshl_b32 m0, s50, 10
  s_mov_b64 exec, s[62:63]
  buffer_load_dwordx4 v14, s[32:35], 0 offen lds
  s_not_b64 exec, s[62:63]
  buffer_load_dwordx4 v14, s[36:39], 0 offen lds
  s_mov_b64 exec, -1
  s_add_u32 s50, s26, 56
  s_mul_i32 s52, s50, 288
  v_add_u32 v14, s52, v7
  s_lshl_b32 m0, s50, 10
  s_mov_b64 exec, s[62:63]
  buffer_load_dwordx4 v14, s[32:35], 0 offen lds
  s_not_b64 exec, s[62:63]
  buffer_load_dwordx4 v14, s[36:39], 0 offen lds
  s_mov_b64 exec, -1
  s_add_u32 s50, s26, 64
  s_mul_i32 s52, s50, 288
  v_add_u32 v14, s52, v7
  s_lshl_b32 m0, s50, 10
  s_mov_b64 exec, s[62:63]
  buffer_load_dwordx4 v14, s[32:35], 0 offen lds
  s_not_b64 exec, s[62:63]
  buffer_load_dwordx4 v14, s[36:39], 0 offen lds
  s_mov_b64 exec, -1
L_staged_35:
  s_lshl_b32 s57, s60, 3
  s_add_u32 s57, s57, s26
  s_cmp_ge_u32 s57, 36
  s_cbranch_scc1 L_ft_backq
  s_mov_b32 s59, 0
L_ft_prep:
  s_lshl_b32 s50, s57, 4
  v_add_u32 v4, s50, v2
  v_lshrrev_b32 v5, 1, v4
  v_and_b32 v6, 1, v4
  v_mul_u32_u24 v6, 144, v6
  v_mov_b32 v7, 0x3d715bef
  s_cmp_lg_u32 s57, 0
  s_cbranch_scc1 L_ftsp_36
  v_cmp_gt_u32 vcc, 2, v4
  v_mov_b32 v8, 0x3d2aaaab
  s_nop 0
  v_cndmask_b32 v7, v7, v8, vcc
  v_mov_b32 v8, 0
  v_cndmask_b32 v6, v6, v8, vcc
  v_cmp_eq_u32 vcc, 0, v4
  v_mov_b32 v8, 288
  s_nop 0
  v_cndmask_b32 v5, v5, v8, vcc
L_ftsp_36:
  s_mov_b32 s51, 7456541
  v_lshlrev_b32 v10, 3, v3
  v_mul_u32_u24 v10, v5, v10
  v_add_u32 v10, v10, v6
  v_mul_hi_u32 v9, v10, s51
  v_mul_u32_u24 v9, 576, v9
  v_sub_u32 v10, v10, v9
  v_lshlrev_b32 v11, 5, v5
  v_mul_hi_u32 v9, v11, s51
  v_mul_u32_u24 v9, 576, v9
  v_sub_u32 v11, v11, v9
  v_add_u32 v9, v11, v11
  v_subrev_u32 v8, 576, v9
  v_min_u32 v12, v9, v8
  v_sub_u32 v13, 576, v11
  v_sub_u32 v14, 576, v12
  v_mov_b32 v16, v10
  v_add_u32 v9, v10, v11
  v_subrev_u32 v8, 576, v9
  v_min_u32 v17, v9, v8
  v_add_u32 v9, v10, v5
  v_subrev_u32 v8, 576, v9
  v_min_u32 v18, v9, v8
  v_add_u32 v9, v17, v5
  v_subrev_u32 v8, 576, v9
  v_min_u32 v19, v9, v8
  v_add_u32 v9, v10, v14
  v_subrev_u32 v8, 576, v9
  v_min_u32 v20, v9, v8
  v_add_u32 v9, v10, v13
  v_subrev_u32 v8, 576, v9
  v_min_u32 v21, v9, v8
  v_add_u32 v9, v20, v5
  v_subrev_u32 v8, 576, v9
  v_min_u32 v22, v9, v8
  v_add_u32 v9, v21, v5
  v_subrev_u32 v8, 576, v9
  v_min_u32 v23, v9, v8
  v_mov_b32 v24, v5
  v_mov_b32 v25, v12
  v_cvt_f32_u32 v16, v16
  v_cvt_f32_u32 v17, v17
  v_cvt_f32_u32 v18, v18
  v_cvt_f32_u32 v19, v19
  v_cvt_f32_u32 v20, v20
  v_cvt_f32_u32 v21, v21
  v_cvt_f32_u32 v22, v22
  v_cvt_f32_u32 v23, v23
  v_cvt_f32_u32 v24, v24
  v_cvt_f32_u32 v25, v25
  v_mul_f32 v16, 0x3ae38e39, v16
  v_mul_f32 v17, 0x3ae38e39, v17
  v_mul_f32 v18, 0x3ae38e39, v18
  v_mul_f32 v19, 0x3ae38e39, v19
  v_mul_f32 v20, 0x3ae38e39, v20
  v_mul_f32 v21, 0x3ae38e39, v21
  v_mul_f32 v22, 0x3ae38e39, v22
  v_mul_f32 v23, 0x3ae38e39, v23
  v_mul_f32 v24, 0x3ae38e39, v24
  v_mul_f32 v25, 0x3ae38e39, v25
  v_cos_f32 v16, v16
  v_cos_f32 v17, v17
  v_cos_f32 v18, v18
  v_cos_f32 v19, v19
  v_cos_f32 v20, v20
  v_cos_f32 v21, v21
  v_cos_f32 v22, v22
  v_cos_f32 v23, v23
  v_cos_f32 v24, v24
  v_cos_f32 v25, v25
  v_mul_f32 v16, v16, v7
  v_mul_f32 v17, v17, v7
  v_mul_f32 v18, v18, v7
  v_mul_f32 v19, v19, v7
  v_mul_f32 v20, v20, v7
  v_mul_f32 v21, v21, v7
  v_mul_f32 v22, v22, v7
  v_mul_f32 v23, v23, v7
  v_add_f32 v24, v24, v24
  v_add_f32 v25, v25, v25
  v_pk_fma_f32 v[30:31], v[24:25], v[18:19], v[16:17] op_sel:[0,0,0] op_sel_hi:[0,1,1] neg_lo:[0,0,1] neg_hi:[0,0,1]
  v_pk_fma_f32 v[26:27], v[24:25], v[16:17], v[20:21] op_sel:[1,0,0] op_sel_hi:[1,1,1] neg_lo:[0,0,1] neg_hi:[0,0,1]
  v_cvt_pk_bf16_f32 v64, v16, v18
  v_pk_fma_f32 v[32:33], v[24:25], v[30:31], v[18:19] op_sel:[0,0,0] op_sel_hi:[0,1,1] neg_lo:[0,0,1] neg_hi:[0,0,1]
  v_pk_fma_f32 v[28:29], v[24:25], v[18:19], v[22:23] op_sel:[1,0,0] op_sel_hi:[1,1,1] neg_lo:[0,0,1] neg_hi:[0,0,1]
  v_cvt_pk_bf16_f32 v68, v17, v19
  v_pk_fma_f32 v[34:35], v[24:25], v[32:33], v[30:31] op_sel:[0,0,0] op_sel_hi:[0,1,1] neg_lo:[0,0,1] neg_hi:[0,0,1]
  v_pk_fma_f32 v[36:37], v[24:25], v[34:35], v[32:33] op_sel:[0,0,0] op_sel_hi:[0,1,1] neg_lo:[0,0,1] neg_hi:[0,0,1]
  v_cvt_pk_bf16_f32 v65, v30, v32
  v_cvt_pk_bf16_f32 v69, v31, v33
  v_pk_fma_f32 v[38:39], v[24:25], v[36:37], v[34:35] op_sel:[0,0,0] op_sel_hi:[0,1,1] neg_lo:[0,0,1] neg_hi:[0,0,1]
  v_cvt_pk_bf16_f32 v66, v34, v36
  v_pk_fma_f32 v[40:41], v[24:25], v[38:39], v[36:37] op_sel:[0,0,0] op_sel_hi:[0,1,1] neg_lo:[0,0,1] neg_hi:[0,0,1]
  v_cvt_pk_bf16_f32 v70, v35, v37
  v_cvt_pk_bf16_f32 v67, v38, v40
  v_cvt_pk_bf16_f32 v71, v39, v41
  v_pk_fma_f32 v[30:31], v[24:25], v[28:29], v[26:27] op_sel:[0,0,0] op_sel_hi:[0,1,1] neg_lo:[0,0,1] neg_hi:[0,0,1]
  v_pk_fma_f32 v[20:21], v[24:25], v[26:27], v[16:17] op_sel:[1,0,0] op_sel_hi:[1,1,1] neg_lo:[0,0,1] neg_hi:[0,0,1]
  v_cvt_pk_bf16_f32 v72, v26, v28
  v_pk_fma_f32 v[32:33], v[24:25], v[30:31], v[28:29] op_sel:[0,0,0] op_sel_hi:[0,1,1] neg_lo:[0,0,1] neg_hi:[0,0,1]
  v_pk_fma_f32 v[22:23], v[24:25], v[28:29], v[18:19] op_sel:[1,0,0] op_sel_hi:[1,1,1] neg_lo:[0,0,1] neg_hi:[0,0,1]
  v_cvt_pk_bf16_f32 v76, v27, v29
  v_pk_fma_f32 v[34:35], v[24:25], v[32:33], v[30:31] op_sel:[0,0,0] op_sel_hi:[0,1,1] neg_lo:[0,0,1] neg_hi:[0,0,1]
  v_pk_fma_f32 v[36:37], v[24:25], v[34:35], v[32:33] op_sel:[0,0,0] op_sel_hi:[0,1,1] neg_lo:[0,0,1] neg_hi:[0,0,1]
  v_cvt_pk_bf16_f32 v73, v30, v32
  v_cvt_pk_bf16_f32 v77, v31, v33
  v_pk_fma_f32 v[38:39], v[24:25], v[36:37], v[34:35] op_sel:[0,0,0] op_sel_hi:[0,1,1] neg_lo:[0,0,1] neg_hi:[0,0,1]
  v_cvt_pk_bf16_f32 v74, v34, v36
  v_pk_fma_f32 v[40:41], v[24:25], v[38:39], v[36:37] op_sel:[0,0,0] op_sel_hi:[0,1,1] neg_lo:[0,0,1] neg_hi:[0,0,1]
  v_cvt_pk_bf16_f32 v78, v35, v37
  v_cvt_pk_bf16_f32 v75, v38, v40
  v_cvt_pk_bf16_f32 v79, v39, v41
  v_pk_fma_f32 v[30:31], v[24:25], v[22:23], v[20:21] op_sel:[0,0,0] op_sel_hi:[0,1,1] neg_lo:[0,0,1] neg_hi:[0,0,1]
  v_pk_fma_f32 v[16:17], v[24:25], v[20:21], v[26:27] op_sel:[1,0,0] op_sel_hi:[1,1,1] neg_lo:[0,0,1] neg_hi:[0,0,1]
  v_cvt_pk_bf16_f32 v80, v20, v22
  v_pk_fma_f32 v[32:33], v[24:25], v[30:31], v[22:23] op_sel:[0,0,0] op_sel_hi:[0,1,1] neg_lo:[0,0,1] neg_hi:[0,0,1]
  v_pk_fma_f32 v[18:19], v[24:25], v[22:23], v[28:29] op_sel:[1,0,0] op_sel_hi:[1,1,1] neg_lo:[0,0,1] neg_hi:[0,0,1]
  v_cvt_pk_bf16_f32 v84, v21, v23
  v_pk_fma_f32 v[34:35], v[24:25], v[32:33], v[30:31] op_sel:[0,0,0] op_sel_hi:[0,1,1] neg_lo:[0,0,1] neg_hi:[0,0,1]
  v_pk_fma_f32 v[36:37], v[24:25], v[34:35], v[32:33] op_sel:[0,0,0] op_sel_hi:[0,1,1] neg_lo:[0,0,1] neg_hi:[0,0,1]
  v_cvt_pk_bf16_f32 v81, v30, v32
  v_cvt_pk_bf16_f32 v85, v31, v33
  v_pk_fma_f32 v[38:39], v[24:25], v[36:37], v[34:35] op_sel:[0,0,0] op_sel_hi:[0,1,1] neg_lo:[0,0,1] neg_hi:[0,0,1]
  v_cvt_pk_bf16_f32 v82, v34, v36
  v_pk_fma_f32 v[40:41], v[24:25], v[38:39], v[36:37] op_sel:[0,0,0] op_sel_hi:[0,1,1] neg_lo:[0,0,1] neg_hi:[0,0,1]
  v_cvt_pk_bf16_f32 v86, v35, v37
  v_cvt_pk_bf16_f32 v83, v38, v40
  v_cvt_pk_bf16_f32 v87, v39, v41
  v_pk_fma_f32 v[30:31], v[24:25], v[18:19], v[16:17] op_sel:[0,0,0] op_sel_hi:[0,1,1] neg_lo:[0,0,1] neg_hi:[0,0,1]
  v_pk_fma_f32 v[26:27], v[24:25], v[16:17], v[20:21] op_sel:[1,0,0] op_sel_hi:[1,1,1] neg_lo:[0,0,1] neg_hi:[0,0,1]
  v_cvt_pk_bf16_f32 v88, v16, v18
  v_pk_fma_f32 v[32:33], v[24:25], v[30:31], v[18:19] op_sel:[0,0,0] op_sel_hi:[0,1,1] neg_lo:[0,0,1] neg_hi:[0,0,1]
  v_pk_fma_f32 v[28:29], v[24:25], v[18:19], v[22:23] op_sel:[1,0,0] op_sel_hi:[1,1,1] neg_lo:[0,0,1] neg_hi:[0,0,1]
  v_cvt_pk_bf16_f32 v92, v17, v19
  v_pk_fma_f32 v[34:35], v[24:25], v[32:33], v[30:31] op_sel:[0,0,0] op_sel_hi:[0,1,1] neg_lo:[0,0,1] neg_hi:[0,0,1]
  v_pk_fma_f32 v[36:37], v[24:25], v[34:35], v[32:33] op_sel:[0,0,0] op_sel_hi:[0,1,1] neg_lo:[0,0,1] neg_hi:[0,0,1]
  v_cvt_pk_bf16_f32 v89, v30, v32
  v_cvt_pk_bf16_f32 v93, v31, v33
  v_pk_fma_f32 v[38:39], v[24:25], v[36:37], v[34:35] op_sel:[0,0,0] op_sel_hi:[0,1,1] neg_lo:[0,0,1] neg_hi:[0,0,1]
  v_cvt_pk_bf16_f32 v90, v34, v36
  v_pk_fma_f32 v[40:41], v[24:25], v[38:39], v[36:37] op_sel:[0,0,0] op_sel_hi:[0,1,1] neg_lo:[0,0,1] neg_hi:[0,0,1]
  v_cvt_pk_bf16_f32 v94, v35, v37
  v_cvt_pk_bf16_f32 v91, v38, v40
  v_cvt_pk_bf16_f32 v95, v39, v41
  v_pk_fma_f32 v[30:31], v[24:25], v[28:29], v[26:27] op_sel:[0,0,0] op_sel_hi:[0,1,1] neg_lo:[0,0,1] neg_hi:[0,0,1]
  v_pk_fma_f32 v[20:21], v[24:25], v[26:27], v[16:17] op_sel:[1,0,0] op_sel_hi:[1,1,1] neg_lo:[0,0,1] neg_hi:[0,0,1]
  v_cvt_pk_bf16_f32 v96, v26, v28
  v_pk_fma_f32 v[32:33], v[24:25], v[30:31], v[28:29] op_sel:[0,0,0] op_sel_hi:[0,1,1] neg_lo:[0,0,1] neg_hi:[0,0,1]
  v_pk_fma_f32 v[22:23], v[24:25], v[28:29], v[18:19] op_sel:[1,0,0] op_sel_hi:[1,1,1] neg_lo:[0,0,1] neg_hi:[0,0,1]
  v_cvt_pk_bf16_f32 v100, v27, v29
  v_pk_fma_f32 v[34:35], v[24:25], v[32:33], v[30:31] op_sel:[0,0,0] op_sel_hi:[0,1,1] neg_lo:[0,0,1] neg_hi:[0,0,1]
  v_pk_fma_f32 v[36:37], v[24:25], v[34:35], v[32:33] op_sel:[0,0,0] op_sel_hi:[0,1,1] neg_lo:[0,0,1] neg_hi:[0,0,1]
  v_cvt_pk_bf16_f32 v97, v30, v32
  v_cvt_pk_bf16_f32 v101, v31, v33
  v_pk_fma_f32 v[38:39], v[24:25], v[36:37], v[34:35] op_sel:[0,0,0] op_sel_hi:[0,1,1] neg_lo:[0,0,1] neg_hi:[0,0,1]
  v_cvt_pk_bf16_f32 v98, v34, v36
  v_pk_fma_f32 v[40:41], v[24:25], v[38:39], v[36:37] op_sel:[0,0,0] op_sel_hi:[0,1,1] neg_lo:[0,0,1] neg_hi:[0,0,1]
  v_cvt_pk_bf16_f32 v102, v35, v37
  v_cvt_pk_bf16_f32 v99, v38, v40
  v_cvt_pk_bf16_f32 v103, v39, v41
  v_pk_fma_f32 v[30:31], v[24:25], v[22:23], v[20:21] op_sel:[0,0,0] op_sel_hi:[0,1,1] neg_lo:[0,0,1] neg_hi:[0,0,1]
  v_pk_fma_f32 v[16:17], v[24:25], v[20:21], v[26:27] op_sel:[1,0,0] op_sel_hi:[1,1,1] neg_lo:[0,0,1] neg_hi:[0,0,1]
  v_cvt_pk_bf16_f32 v104, v20, v22
  v_pk_fma_f32 v[32:33], v[24:25], v[30:31], v[22:23] op_sel:[0,0,0] op_sel_hi:[0,1,1] neg_lo:[0,0,1] neg_hi:[0,0,1]
  v_pk_fma_f32 v[18:19], v[24:25], v[22:23], v[28:29] op_sel:[1,0,0] op_sel_hi:[1,1,1] neg_lo:[0,0,1] neg_hi:[0,0,1]
  v_cvt_pk_bf16_f32 v108, v21, v23
  v_pk_fma_f32 v[34:35], v[24:25], v[32:33], v[30:31] op_sel:[0,0,0] op_sel_hi:[0,1,1] neg_lo:[0,0,1] neg_hi:[0,0,1]
  v_pk_fma_f32 v[36:37], v[24:25], v[34:35], v[32:33] op_sel:[0,0,0] op_sel_hi:[0,1,1] neg_lo:[0,0,1] neg_hi:[0,0,1]
  v_cvt_pk_bf16_f32 v105, v30, v32
  v_cvt_pk_bf16_f32 v109, v31, v33
  v_pk_fma_f32 v[38:39], v[24:25], v[36:37], v[34:35] op_sel:[0,0,0] op_sel_hi:[0,1,1] neg_lo:[0,0,1] neg_hi:[0,0,1]
  v_cvt_pk_bf16_f32 v106, v34, v36
  v_pk_fma_f32 v[40:41], v[24:25], v[38:39], v[36:37] op_sel:[0,0,0] op_sel_hi:[0,1,1] neg_lo:[0,0,1] neg_hi:[0,0,1]
  v_cvt_pk_bf16_f32 v110, v35, v37
  v_cvt_pk_bf16_f32 v107, v38, v40
  v_cvt_pk_bf16_f32 v111, v39, v41
  v_pk_fma_f32 v[30:31], v[24:25], v[18:19], v[16:17] op_sel:[0,0,0] op_sel_hi:[0,1,1] neg_lo:[0,0,1] neg_hi:[0,0,1]
  v_pk_fma_f32 v[26:27], v[24:25], v[16:17], v[20:21] op_sel:[1,0,0] op_sel_hi:[1,1,1] neg_lo:[0,0,1] neg_hi:[0,0,1]
  v_cvt_pk_bf16_f32 v112, v16, v18
  v_pk_fma_f32 v[32:33], v[24:25], v[30:31], v[18:19] op_sel:[0,0,0] op_sel_hi:[0,1,1] neg_lo:[0,0,1] neg_hi:[0,0,1]
  v_pk_fma_f32 v[28:29], v[24:25], v[18:19], v[22:23] op_sel:[1,0,0] op_sel_hi:[1,1,1] neg_lo:[0,0,1] neg_hi:[0,0,1]
  v_cvt_pk_bf16_f32 v116, v17, v19
  v_pk_fma_f32 v[34:35], v[24:25], v[32:33], v[30:31] op_sel:[0,0,0] op_sel_hi:[0,1,1] neg_lo:[0,0,1] neg_hi:[0,0,1]
  v_pk_fma_f32 v[36:37], v[24:25], v[34:35], v[32:33] op_sel:[0,0,0] op_sel_hi:[0,1,1] neg_lo:[0,0,1] neg_hi:[0,0,1]
  v_cvt_pk_bf16_f32 v113, v30, v32
  v_cvt_pk_bf16_f32 v117, v31, v33
  v_pk_fma_f32 v[38:39], v[24:25], v[36:37], v[34:35] op_sel:[0,0,0] op_sel_hi:[0,1,1] neg_lo:[0,0,1] neg_hi:[0,0,1]
  v_cvt_pk_bf16_f32 v114, v34, v36
  v_pk_fma_f32 v[40:41], v[24:25], v[38:39], v[36:37] op_sel:[0,0,0] op_sel_hi:[0,1,1] neg_lo:[0,0,1] neg_hi:[0,0,1]
  v_cvt_pk_bf16_f32 v118, v35, v37
  v_cvt_pk_bf16_f32 v115, v38, v40
  v_cvt_pk_bf16_f32 v119, v39, v41
  v_pk_fma_f32 v[30:31], v[24:25], v[28:29], v[26:27] op_sel:[0,0,0] op_sel_hi:[0,1,1] neg_lo:[0,0,1] neg_hi:[0,0,1]
  v_pk_fma_f32 v[20:21], v[24:25], v[26:27], v[16:17] op_sel:[1,0,0] op_sel_hi:[1,1,1] neg_lo:[0,0,1] neg_hi:[0,0,1]
  v_cvt_pk_bf16_f32 v120, v26, v28
  v_pk_fma_f32 v[32:33], v[24:25], v[30:31], v[28:29] op_sel:[0,0,0] op_sel_hi:[0,1,1] neg_lo:[0,0,1] neg_hi:[0,0,1]
  v_pk_fma_f32 v[22:23], v[24:25], v[28:29], v[18:19] op_sel:[1,0,0] op_sel_hi:[1,1,1] neg_lo:[0,0,1] neg_hi:[0,0,1]
  v_cvt_pk_bf16_f32 v124, v27, v29
  v_pk_fma_f32 v[34:35], v[24:25], v[32:33], v[30:31] op_sel:[0,0,0] op_sel_hi:[0,1,1] neg_lo:[0,0,1] neg_hi:[0,0,1]
  v_pk_fma_f32 v[36:37], v[24:25], v[34:35], v[32:33] op_sel:[0,0,0] op_sel_hi:[0,1,1] neg_lo:[0,0,1] neg_hi:[0,0,1]
  v_cvt_pk_bf16_f32 v121, v30, v32
  v_cvt_pk_bf16_f32 v125, v31, v33
  v_pk_fma_f32 v[38:39], v[24:25], v[36:37], v[34:35] op_sel:[0,0,0] op_sel_hi:[0,1,1] neg_lo:[0,0,1] neg_hi:[0,0,1]
  v_cvt_pk_bf16_f32 v122, v34, v36
  v_pk_fma_f32 v[40:41], v[24:25], v[38:39], v[36:37] op_sel:[0,0,0] op_sel_hi:[0,1,1] neg_lo:[0,0,1] neg_hi:[0,0,1]
  v_cvt_pk_bf16_f32 v126, v35, v37
  v_cvt_pk_bf16_f32 v123, v38, v40
  v_cvt_pk_bf16_f32 v127, v39, v41
  v_pk_fma_f32 v[30:31], v[24:25], v[22:23], v[20:21] op_sel:[0,0,0] op_sel_hi:[0,1,1] neg_lo:[0,0,1] neg_hi:[0,0,1]
  v_cvt_pk_bf16_f32 v128, v20, v22
  v_pk_fma_f32 v[32:33], v[24:25], v[30:31], v[22:23] op_sel:[0,0,0] op_sel_hi:[0,1,1] neg_lo:[0,0,1] neg_hi:[0,0,1]
  v_cvt_pk_bf16_f32 v132, v21, v23
  v_pk_fma_f32 v[34:35], v[24:25], v[32:33], v[30:31] op_sel:[0,0,0] op_sel_hi:[0,1,1] neg_lo:[0,0,1] neg_hi:[0,0,1]
  v_pk_fma_f32 v[36:37], v[24:25], v[34:35], v[32:33] op_sel:[0,0,0] op_sel_hi:[0,1,1] neg_lo:[0,0,1] neg_hi:[0,0,1]
  v_cvt_pk_bf16_f32 v129, v30, v32
  v_cvt_pk_bf16_f32 v133, v31, v33
  v_pk_fma_f32 v[38:39], v[24:25], v[36:37], v[34:35] op_sel:[0,0,0] op_sel_hi:[0,1,1] neg_lo:[0,0,1] neg_hi:[0,0,1]
  v_cvt_pk_bf16_f32 v130, v34, v36
  v_pk_fma_f32 v[40:41], v[24:25], v[38:39], v[36:37] op_sel:[0,0,0] op_sel_hi:[0,1,1] neg_lo:[0,0,1] neg_hi:[0,0,1]
  v_cvt_pk_bf16_f32 v134, v35, v37
  v_cvt_pk_bf16_f32 v131, v38, v40
  v_cvt_pk_bf16_f32 v135, v39, v41
  s_cmp_lg_u32 s59, 0
  s_cbranch_scc1 L_ft_backo
L_ft_backq:
  s_waitcnt vmcnt(0)
  s_barrier
  s_cmp_ge_u32 s57, 36
  s_cbranch_scc1 L_pq_fin_37
  s_cmp_lg_u32 s57, 0
  s_cbranch_scc1 L_pq_nodc_38
  v_cmp_eq_u32 vcc, 1, v2
  v_mov_b32 v13, 0
  s_nop 0
  v_cndmask_b32 v64, v64, v13, vcc
  v_cndmask_b32 v65, v65, v13, vcc
  v_cndmask_b32 v66, v66, v13, vcc
  v_cndmask_b32 v67, v67, v13, vcc
  v_cndmask_b32 v68, v68, v13, vcc
  v_cndmask_b32 v69, v69, v13, vcc
  v_cndmask_b32 v70, v70, v13, vcc
  v_cndmask_b32 v71, v71, v13, vcc
  v_cndmask_b32 v72, v72, v13, vcc
  v_cndmask_b32 v73, v73, v13, vcc
  v_cndmask_b32 v74, v74, v13, vcc
  v_cndmask_b32 v75, v75, v13, vcc
  v_cndmask_b32 v76, v76, v13, vcc
  v_cndmask_b32 v77, v77, v13, vcc
  v_cndmask_b32 v78, v78, v13, vcc
  v_cndmask_b32 v79, v79, v13, vcc
  v_cndmask_b32 v80, v80, v13, vcc
  v_cndmask_b32 v81, v81, v13, vcc
  v_cndmask_b32 v82, v82, v13, vcc
  v_cndmask_b32 v83, v83, v13, vcc
  v_cndmask_b32 v84, v84, v13, vcc
  v_cndmask_b32 v85, v85, v13, vcc
  v_cndmask_b32 v86, v86, v13, vcc
  v_cndmask_b32 v87, v87, v13, vcc
  v_cndmask_b32 v88, v88, v13, vcc
  v_cndmask_b32 v89, v89, v13, vcc
  v_cndmask_b32 v90, v90, v13, vcc
  v_cndmask_b32 v91, v91, v13, vcc
  v_cndmask_b32 v92, v92, v13, vcc
  v_cndmask_b32 v93, v93, v13, vcc
  v_cndmask_b32 v94, v94, v13, vcc
  v_cndmask_b32 v95, v95, v13, vcc
  v_cndmask_b32 v96, v96, v13, vcc
  v_cndmask_b32 v97, v97, v13, vcc
  v_cndmask_b32 v98, v98, v13, vcc
  v_cndmask_b32 v99, v99, v13, vcc
  v_cndmask_b32 v100, v100, v13, vcc
  v_cndmask_b32 v101, v101, v13, vcc
  v_cndmask_b32 v102, v102, v13, vcc
  v_cndmask_b32 v103, v103, v13, vcc
  v_cndmask_b32 v104, v104, v13, vcc
  v_cndmask_b32 v105, v105, v13, vcc
  v_cndmask_b32 v106, v106, v13, vcc
  v_cndmask_b32 v107, v107, v13, vcc
  v_cndmask_b32 v108, v108, v13, vcc
  v_cndmask_b32 v109, v109, v13, vcc
  v_cndmask_b32 v110, v110, v13, vcc
  v_cndmask_b32 v111, v111, v13, vcc
  v_cndmask_b32 v112, v112, v13, vcc
  v_cndmask_b32 v113, v113, v13, vcc
  v_cndmask_b32 v114, v114, v13, vcc
  v_cndmask_b32 v115, v115, v13, vcc
  v_cndmask_b32 v116, v116, v13, vcc
  v_cndmask_b32 v117, v117, v13, vcc
  v_cndmask_b32 v118, v118, v13, vcc
  v_cndmask_b32 v119, v119, v13, vcc
  v_cndmask_b32 v120, v120, v13, vcc
  v_cndmask_b32 v121, v121, v13, vcc
  v_cndmask_b32 v122, v122, v13, vcc
  v_cndmask_b32 v123, v123, v13, vcc
  v_cndmask_b32 v124, v124, v13, vcc
  v_cndmask_b32 v125, v125, v13, vcc
  v_cndmask_b32 v126, v126, v13, vcc
  v_cndmask_b32 v127, v127, v13, vcc
  v_cndmask_b32 v128, v128, v13, vcc
  v_cndmask_b32 v129, v129, v13, vcc
  v_cndmask_b32 v130, v130, v13, vcc
  v_cndmask_b32 v131, v131, v13, vcc
  v_cndmask_b32 v132, v132, v13, vcc
  v_cndmask_b32 v133, v133, v13, vcc
  v_cndmask_b32 v134, v134, v13, vcc
  v_cndmask_b32 v135, v135, v13, vcc
L_pq_nodc_38:
  v_lshrrev_b32 v4, 2, v2
  v_and_b32 v5, 3, v2
  v_lshl_add_u32 v7, v3, 3, v4
  v_lshlrev_b32 v7, 7, v7
  v_lshl_add_u32 v7, v5, 3, v7
  v_bfe_u32 v6, v4, 1, 1
  v_and_b32 v5, 1, v3
  v_lshl_or_b32 v6, v5, 1, v6
  v_lshl_add_u32 v8, v6, 5, v7
  v_xor_b32 v9, 32, v8
  v_xor_b32 v10, 64, v8
  v_xor_b32 v11, 96, v8
  ds_read_b64_tr_b16 v[16:17], v8 offset:0
  ds_read_b64_tr_b16 v[18:19], v8 offset:512
  ds_read_b64_tr_b16 v[20:21], v9 offset:0
  ds_read_b64_tr_b16 v[22:23], v9 offset:512
  ds_read_b64_tr_b16 v[24:25], v10 offset:0
  ds_read_b64_tr_b16 v[26:27], v10 offset:512
  ds_read_b64_tr_b16 v[28:29], v11 offset:0
  ds_read_b64_tr_b16 v[30:31], v11 offset:512
  ds_read_b64_tr_b16 v[32:33], v8 offset:4096
  ds_read_b64_tr_b16 v[34:35], v8 offset:4608
  ds_read_b64_tr_b16 v[36:37], v9 offset:4096
  ds_read_b64_tr_b16 v[38:39], v9 offset:4608
  ds_read_b64_tr_b16 v[40:41], v10 offset:4096
  ds_read_b64_tr_b16 v[42:43], v10 offset:4608
  ds_read_b64_tr_b16 v[44:45], v11 offset:4096
  ds_read_b64_tr_b16 v[46:47], v11 offset:4608
  s_waitcnt lgkmcnt(8)
  v_mfma_f32_16x16x32_bf16 v[140:143], v[64:67], v[16:19], 0
  v_mfma_f32_16x16x32_bf16 v[144:147], v[64:67], v[20:23], 0
  v_mfma_f32_16x16x32_bf16 v[148:151], v[64:67], v[24:27], 0
  v_mfma_f32_16x16x32_bf16 v[152:155], v[64:67], v[28:31], 0
  ds_read_b64_tr_b16 v[48:49], v8 offset:8192
  ds_read_b64_tr_b16 v[50:51], v8 offset:8704
  ds_read_b64_tr_b16 v[52:53], v9 offset:8192
  ds_read_b64_tr_b16 v[54:55], v9 offset:8704
  ds_read_b64_tr_b16 v[56:57], v10 offset:8192
  ds_read_b64_tr_b16 v[58:59], v10 offset:8704
  ds_read_b64_tr_b16 v[60:61], v11 offset:8192
  ds_read_b64_tr_b16 v[62:63], v11 offset:8704
  s_waitcnt lgkmcnt(8)
  v_mfma_f32_16x16x32_bf16 v[140:143], v[68:71], v[32:35], v[140:143]
  v_mfma_f32_16x16x32_bf16 v[144:147], v[68:71], v[36:39], v[144:147]
  v_mfma_f32_16x16x32_bf16 v[148:151], v[68:71], v[40:43], v[148:151]
  v_mfma_f32_16x16x32_bf16 v[152:155], v[68:71], v[44:47], v[152:155]
  ds_read_b64_tr_b16 v[16:17], v8 offset:12288
  ds_read_b64_tr_b16 v[18:19], v8 offset:12800
  ds_read_b64_tr_b16 v[20:21], v9 offset:12288
  ds_read_b64_tr_b16 v[22:23], v9 offset:12800
  ds_read_b64_tr_b16 v[24:25], v10 offset:12288
  ds_read_b64_tr_b16 v[26:27], v10 offset:12800
  ds_read_b64_tr_b16 v[28:29], v11 offset:12288
  ds_read_b64_tr_b16 v[30:31], v11 offset:12800
  s_waitcnt lgkmcnt(8)
  v_mfma_f32_16x16x32_bf16 v[140:143], v[72:75], v[48:51], v[140:143]
  v_mfma_f32_16x16x32_bf16 v[144:147], v[72:75], v[52:55], v[144:147]
  v_mfma_f32_16x16x32_bf16 v[148:151], v[72:75], v[56:59], v[148:151]
  v_mfma_f32_16x16x32_bf16 v[152:155], v[72:75], v[60:63], v[152:155]
  ds_read_b64_tr_b16 v[32:33], v8 offset:16384
  ds_read_b64_tr_b16 v[34:35], v8 offset:16896
  ds_read_b64_tr_b16 v[36:37], v9 offset:16384
  ds_read_b64_tr_b16 v[38:39], v9 offset:16896
  ds_read_b64_tr_b16 v[40:41], v10 offset:16384
  ds_read_b64_tr_b16 v[42:43], v10 offset:16896
  ds_read_b64_tr_b16 v[44:45], v11 offset:16384
  ds_read_b64_tr_b16 v[46:47], v11 offset:16896
  s_waitcnt lgkmcnt(8)
  v_mfma_f32_16x16x32_bf16 v[140:143], v[76:79], v[16:19], v[140:143]
  v_mfma_f32_16x16x32_bf16 v[144:147], v[76:79], v[20:23], v[144:147]
  v_mfma_f32_16x16x32_bf16 v[148:151], v[76:79], v[24:27], v[148:151]
  v_mfma_f32_16x16x32_bf16 v[152:155], v[76:79], v[28:31], v[152:155]
  ds_read_b64_tr_b16 v[48:49], v8 offset:20480
  ds_read_b64_tr_b16 v[50:51], v8 offset:20992
  ds_read_b64_tr_b16 v[52:53], v9 offset:20480
  ds_read_b64_tr_b16 v[54:55], v9 offset:20992
  ds_read_b64_tr_b16 v[56:57], v10 offset:20480
  ds_read_b64_tr_b16 v[58:59], v10 offset:20992
  ds_read_b64_tr_b16 v[60:61], v11 offset:20480
  ds_read_b64_tr_b16 v[62:63], v11 offset:20992
  s_waitcnt lgkmcnt(8)
  v_mfma_f32_16x16x32_bf16 v[140:143], v[80:83], v[32:35], v[140:143]
  v_mfma_f32_16x16x32_bf16 v[144:147], v[80:83], v[36:39], v[144:147]
  v_mfma_f32_16x16x32_bf16 v[148:151], v[80:83], v[40:43], v[148:151]
  v_mfma_f32_16x16x32_bf16 v[152:155], v[80:83], v[44:47], v[152:155]
  ds_read_b64_tr_b16 v[16:17], v8 offset:24576
  ds_read_b64_tr_b16 v[18:19], v8 offset:25088
  ds_read_b64_tr_b16 v[20:21], v9 offset:24576
  ds_read_b64_tr_b16 v[22:23], v9 offset:25088
  ds_read_b64_tr_b16 v[24:25], v10 offset:24576
  ds_read_b64_tr_b16 v[26:27], v10 offset:25088
  ds_read_b64_tr_b16 v[28:29], v11 offset:24576
  ds_read_b64_tr_b16 v[30:31], v11 offset:25088
  s_waitcnt lgkmcnt(8)
  v_mfma_f32_16x16x32_bf16 v[140:143], v[84:87], v[48:51], v[140:143]
  v_mfma_f32_16x16x32_bf16 v[144:147], v[84:87], v[52:55], v[144:147]
  v_mfma_f32_16x16x32_bf16 v[148:151], v[84:87], v[56:59], v[148:151]
  v_mfma_f32_16x16x32_bf16 v[152:155], v[84:87], v[60:63], v[152:155]
  ds_read_b64_tr_b16 v[32:33], v8 offset:28672
  ds_read_b64_tr_b16 v[34:35], v8 offset:29184
  ds_read_b64_tr_b16 v[36:37], v9 offset:28672
  ds_read_b64_tr_b16 v[38:39], v9 offset:29184
  ds_read_b64_tr_b16 v[40:41], v10 offset:28672
  ds_read_b64_tr_b16 v[42:43], v10 offset:29184
  ds_read_b64_tr_b16 v[44:45], v11 offset:28672
  ds_read_b64_tr_b16 v[46:47], v11 offset:29184
  s_waitcnt lgkmcnt(8)
  v_mfma_f32_16x16x32_bf16 v[140:143], v[88:91], v[16:19], v[140:143]
  v_mfma_f32_16x16x32_bf16 v[144:147], v[88:91], v[20:23], v[144:147]
  v_mfma_f32_16x16x32_bf16 v[148:151], v[88:91], v[24:27], v[148:151]
  v_mfma_f32_16x16x32_bf16 v[152:155], v[88:91], v[28:31], v[152:155]
  ds_read_b64_tr_b16 v[48:49], v8 offset:32768
  ds_read_b64_tr_b16 v[50:51], v8 offset:33280
  ds_read_b64_tr_b16 v[52:53], v9 offset:32768
  ds_read_b64_tr_b16 v[54:55], v9 offset:33280
  ds_read_b64_tr_b16 v[56:57], v10 offset:32768
  ds_read_b64_tr_b16 v[58:59], v10 offset:33280
  ds_read_b64_tr_b16 v[60:61], v11 offset:32768
  ds_read_b64_tr_b16 v[62:63], v11 offset:33280
  s_waitcnt lgkmcnt(8)
  v_mfma_f32_16x16x32_bf16 v[140:143], v[92:95], v[32:35], v[140:143]
  v_mfma_f32_16x16x32_bf16 v[144:147], v[92:95], v[36:39], v[144:147]
  v_mfma_f32_16x16x32_bf16 v[148:151], v[92:95], v[40:43], v[148:151]
  v_mfma_f32_16x16x32_bf16 v[152:155], v[92:95], v[44:47], v[152:155]
  ds_read_b64_tr_b16 v[16:17], v8 offset:36864
  ds_read_b64_tr_b16 v[18:19], v8 offset:37376
  ds_read_b64_tr_b16 v[20:21], v9 offset:36864
  ds_read_b64_tr_b16 v[22:23], v9 offset:37376
  ds_read_b64_tr_b16 v[24:25], v10 offset:36864
  ds_read_b64_tr_b16 v[26:27], v10 offset:37376
  ds_read_b64_tr_b16 v[28:29], v11 offset:36864
  ds_read_b64_tr_b16 v[30:31], v11 offset:37376
  s_waitcnt lgkmcnt(8)
  v_mfma_f32_16x16x32_bf16 v[140:143], v[96:99], v[48:51], v[140:143]
  v_mfma_f32_16x16x32_bf16 v[144:147], v[96:99], v[52:55], v[144:147]
  v_mfma_f32_16x16x32_bf16 v[148:151], v[96:99], v[56:59], v[148:151]
  v_mfma_f32_16x16x32_bf16 v[152:155], v[96:99], v[60:63], v[152:155]
  ds_read_b64_tr_b16 v[32:33], v8 offset:40960
  ds_read_b64_tr_b16 v[34:35], v8 offset:41472
  ds_read_b64_tr_b16 v[36:37], v9 offset:40960
  ds_read_b64_tr_b16 v[38:39], v9 offset:41472
  ds_read_b64_tr_b16 v[40:41], v10 offset:40960
  ds_read_b64_tr_b16 v[42:43], v10 offset:41472
  ds_read_b64_tr_b16 v[44:45], v11 offset:40960
  ds_read_b64_tr_b16 v[46:47], v11 offset:41472
  s_waitcnt lgkmcnt(8)
  v_mfma_f32_16x16x32_bf16 v[140:143], v[100:103], v[16:19], v[140:143]
  v_mfma_f32_16x16x32_bf16 v[144:147], v[100:103], v[20:23], v[144:147]
  v_mfma_f32_16x16x32_bf16 v[148:151], v[100:103], v[24:27], v[148:151]
  v_mfma_f32_16x16x32_bf16 v[152:155], v[100:103], v[28:31], v[152:155]
  ds_read_b64_tr_b16 v[48:49], v8 offset:45056
  ds_read_b64_tr_b16 v[50:51], v8 offset:45568
  ds_read_b64_tr_b16 v[52:53], v9 offset:45056
  ds_read_b64_tr_b16 v[54:55], v9 offset:45568
  ds_read_b64_tr_b16 v[56:57], v10 offset:45056
  ds_read_b64_tr_b16 v[58:59], v10 offset:45568
  ds_read_b64_tr_b16 v[60:61], v11 offset:45056
  ds_read_b64_tr_b16 v[62:63], v11 offset:45568
  s_waitcnt lgkmcnt(8)
  v_mfma_f32_16x16x32_bf16 v[140:143], v[104:107], v[32:35], v[140:143]
  v_mfma_f32_16x16x32_bf16 v[144:147], v[104:107], v[36:39], v[144:147]
  v_mfma_f32_16x16x32_bf16 v[148:151], v[104:107], v[40:43], v[148:151]
  v_mfma_f32_16x16x32_bf16 v[152:155], v[104:107], v[44:47], v[152:155]
  ds_read_b64_tr_b16 v[16:17], v8 offset:49152
  ds_read_b64_tr_b16 v[18:19], v8 offset:49664
  ds_read_b64_tr_b16 v[20:21], v9 offset:49152
  ds_read_b64_tr_b16 v[22:23], v9 offset:49664
  ds_read_b64_tr_b16 v[24:25], v10 offset:49152
  ds_read_b64_tr_b16 v[26:27], v10 offset:49664
  ds_read_b64_tr_b16 v[28:29], v11 offset:49152
  ds_read_b64_tr_b16 v[30:31], v11 offset:49664
  s_waitcnt lgkmcnt(8)
  v_mfma_f32_16x16x32_bf16 v[140:143], v[108:111], v[48:51], v[140:143]
  v_mfma_f32_16x16x32_bf16 v[144:147], v[108:111], v[52:55], v[144:147]
  v_mfma_f32_16x16x32_bf16 v[148:151], v[108:111], v[56:59], v[148:151]
  v_mfma_f32_16x16x32_bf16 v[152:155], v[108:111], v[60:63], v[152:155]
  ds_read_b64_tr_b16 v[32:33], v8 offset:53248
  ds_read_b64_tr_b16 v[34:35], v8 offset:53760
  ds_read_b64_tr_b16 v[36:37], v9 offset:53248
  ds_read_b64_tr_b16 v[38:39], v9 offset:53760
  ds_read_b64_tr_b16 v[40:41], v10 offset:53248
  ds_read_b64_tr_b16 v[42:43], v10 offset:53760
  ds_read_b64_tr_b16 v[44:45], v11 offset:53248
  ds_read_b64_tr_b16 v[46:47], v11 offset:53760
  s_waitcnt lgkmcnt(8)
  v_mfma_f32_16x16x32_bf16 v[140:143], v[112:115], v[16:19], v[140:143]
  v_mfma_f32_16x16x32_bf16 v[144:147], v[112:115], v[20:23], v[144:147]
  v_mfma_f32_16x16x32_bf16 v[148:151], v[112:115], v[24:27], v[148:151]
  v_mfma_f32_16x16x32_bf16 v[152:155], v[112:115], v[28:31], v[152:155]
  ds_read_b64_tr_b16 v[48:49], v8 offset:57344
  ds_read_b64_tr_b16 v[50:51], v8 offset:57856
  ds_read_b64_tr_b16 v[52:53], v9 offset:57344
  ds_read_b64_tr_b16 v[54:55], v9 offset:57856
  ds_read_b64_tr_b16 v[56:57], v10 offset:57344
  ds_read_b64_tr_b16 v[58:59], v10 offset:57856
  ds_read_b64_tr_b16 v[60:61], v11 offset:57344
  ds_read_b64_tr_b16 v[62:63], v11 offset:57856
  s_waitcnt lgkmcnt(8)
  v_mfma_f32_16x16x32_bf16 v[140:143], v[116:119], v[32:35], v[140:143]
  v_mfma_f32_16x16x32_bf16 v[144:147], v[116:119], v[36:39], v[144:147]
  v_mfma_f32_16x16x32_bf16 v[148:151], v[116:119], v[40:43], v[148:151]
  v_mfma_f32_16x16x32_bf16 v[152:155], v[116:119], v[44:47], v[152:155]
  ds_read_b64_tr_b16 v[16:17], v8 offset:61440
  ds_read_b64_tr_b16 v[18:19], v8 offset:61952
  ds_read_b64_tr_b16 v[20:21], v9 offset:61440
  ds_read_b64_tr_b16 v[22:23], v9 offset:61952
  ds_read_b64_tr_b16 v[24:25], v10 offset:61440
  ds_read_b64_tr_b16 v[26:27], v10 offset:61952
  ds_read_b64_tr_b16 v[28:29], v11 offset:61440
  ds_read_b64_tr_b16 v[30:31], v11 offset:61952
  s_waitcnt lgkmcnt(8)
  v_mfma_f32_16x16x32_bf16 v[140:143], v[120:123], v[48:51], v[140:143]
  v_mfma_f32_16x16x32_bf16 v[144:147], v[120:123], v[52:55], v[144:147]
  v_mfma_f32_16x16x32_bf16 v[148:151], v[120:123], v[56:59], v[148:151]
  v_mfma_f32_16x16x32_bf16 v[152:155], v[120:123], v[60:63], v[152:155]
  v_add_u32 v8, 65536, v8
  v_add_u32 v9, 65536, v9
  v_add_u32 v10, 65536, v10
  v_add_u32 v11, 65536, v11
  ds_read_b64_tr_b16 v[32:33], v8 offset:0
  ds_read_b64_tr_b16 v[34:35], v8 offset:512
  ds_read_b64_tr_b16 v[36:37], v9 offset:0
  ds_read_b64_tr_b16 v[38:39], v9 offset:512
  ds_read_b64_tr_b16 v[40:41], v10 offset:0
  ds_read_b64_tr_b16 v[42:43], v10 offset:512
  ds_read_b64_tr_b16 v[44:45], v11 offset:0
  ds_read_b64_tr_b16 v[46:47], v11 offset:512
  s_waitcnt lgkmcnt(8)
  v_mfma_f32_16x16x32_bf16 v[140:143], v[124:127], v[16:19], v[140:143]
  v_mfma_f32_16x16x32_bf16 v[144:147], v[124:127], v[20:23], v[144:147]
  v_mfma_f32_16x16x32_bf16 v[148:151], v[124:127], v[24:27], v[148:151]
  v_mfma_f32_16x16x32_bf16 v[152:155], v[124:127], v[28:31], v[152:155]
  ds_read_b64_tr_b16 v[48:49], v8 offset:4096
  ds_read_b64_tr_b16 v[50:51], v8 offset:4608
  ds_read_b64_tr_b16 v[52:53], v9 offset:4096
  ds_read_b64_tr_b16 v[54:55], v9 offset:4608
  ds_read_b64_tr_b16 v[56:57], v10 offset:4096
  ds_read_b64_tr_b16 v[58:59], v10 offset:4608
  ds_read_b64_tr_b16 v[60:61], v11 offset:4096
  ds_read_b64_tr_b16 v[62:63], v11 offset:4608
  s_waitcnt lgkmcnt(8)
  v_mfma_f32_16x16x32_bf16 v[140:143], v[128:131], v[32:35], v[140:143]
  v_mfma_f32_16x16x32_bf16 v[144:147], v[128:131], v[36:39], v[144:147]
  v_mfma_f32_16x16x32_bf16 v[148:151], v[128:131], v[40:43], v[148:151]
  v_mfma_f32_16x16x32_bf16 v[152:155], v[128:131], v[44:47], v[152:155]
  s_waitcnt lgkmcnt(0)
  v_mfma_f32_16x16x32_bf16 v[140:143], v[132:135], v[48:51], v[140:143]
  v_mfma_f32_16x16x32_bf16 v[144:147], v[132:135], v[52:55], v[144:147]
  v_mfma_f32_16x16x32_bf16 v[148:151], v[132:135], v[56:59], v[148:151]
  v_mfma_f32_16x16x32_bf16 v[152:155], v[132:135], v[60:63], v[152:155]
  s_nop 4
  v_cvt_pk_bf16_f32 v140, v140, v141
  v_cvt_pk_bf16_f32 v141, v142, v143
  v_cvt_pk_bf16_f32 v144, v144, v145
  v_cvt_pk_bf16_f32 v145, v146, v147
  v_cvt_pk_bf16_f32 v148, v148, v149
  v_cvt_pk_bf16_f32 v149, v150, v151
  v_cvt_pk_bf16_f32 v152, v152, v153
  v_cvt_pk_bf16_f32 v153, v154, v155
  s_lshr_b32 s50, s26, 1
  s_lshl_b32 s50, s50, 12
  s_add_u32 s50, s50, 81920
  s_lshl_b32 s51, s56, 9
  s_add_u32 s50, s50, s51
  v_lshrrev_b32 v4, 1, v3
  v_lshl_add_u32 v4, v4, 4, v2
  v_lshlrev_b32 v4, 4, v4
  v_and_b32 v5, 1, v3
  v_lshl_add_u32 v4, v5, 3, v4
  v_add_u32 v4, s50, v4
  ds_write_b64 v4, v[140:141] offset:0
  ds_write_b64 v4, v[144:145] offset:1024
  ds_write_b64 v4, v[148:149] offset:2048
  ds_write_b64 v4, v[152:153] offset:3072
L_pq_fin_37:
  s_waitcnt lgkmcnt(0)
  s_barrier
  s_cmp_ge_u32 s57, 36
  s_cbranch_scc1 L_pq_fin2_39
  s_lshr_b32 s50, s26, 1
  s_lshl_b32 s50, s50, 12
  s_lshl_b32 s51, s56, 11
  s_add_u32 s50, s50, s51
  s_add_u32 s50, s50, 81920
  v_lshlrev_b32 v4, 4, v1
  v_add_u32 v5, s50, v4
  ds_read_b128 v[16:19], v5
  ds_read_b128 v[20:23], v5 offset:1024
  s_lshl_b32 s54, s61, 2
  s_lshl_b32 s55, s56, 1
  s_add_u32 s54, s54, s55
  s_mul_i32 s54, s54, 18
  s_lshr_b32 s55, s57, 1
  s_add_u32 s54, s54, s55
  s_lshl_b32 s54, s54, 10
  s_add_u32 s54, s54, 11993088
  s_waitcnt lgkmcnt(0)
  buffer_store_dwordx4 v[16:19], v4, s[28:31], s54 offen sc1
  s_add_u32 s54, s54, 18432
  buffer_store_dwordx4 v[20:23], v4, s[28:31], s54 offen sc1
L_pq_fin2_39:
  s_branch L_prepdone_30
L_prepo4_32:
  s_cmp_eq_u32 s63, 12
  s_cselect_b32 s61, s62, 99
  s_cbranch_scc1 L_prept_29
  s_cmp_ge_u32 s63, 12
  s_cbranch_scc1 L_prepdone_30
  s_lshl_b32 s61, s62, 1
  s_add_u32 s61, s61, s63
  s_sub_u32 s61, s61, 10
  s_cmp_ge_u32 s61, 9
  s_cbranch_scc1 L_prepdone_30
  s_mov_b32 s60, 4
  s_branch L_prepo_28
L_prephi_31:
  s_cmp_eq_u32 s63, 12
  s_cselect_b32 s61, s62, 99
  s_cbranch_scc1 L_prept_29
  s_cmp_eq_u32 s2, 253
  s_cselect_b32 s61, 8, 99
  s_cbranch_scc1 L_prept_29
  s_cmp_ge_u32 s63, 12
  s_cbranch_scc1 L_prepdone_30
  s_cmp_ge_u32 s63, 9
  s_cbranch_scc1 L_prepo3_33
  s_sub_u32 s60, s62, 5
  s_mov_b32 s61, s63
  s_branch L_prepo_28
L_prepo3_33:
  s_sub_u32 s61, s62, 5
  s_mul_i32 s61, s61, 3
  s_add_u32 s61, s61, s63
  s_sub_u32 s61, s61, 9
  s_mov_b32 s60, 3
L_prepo_28:
  s_mov_b32 s32, s18
  s_mov_b32 s33, s19
  s_mov_b32 s34, 663552
  s_mov_b32 s35, 0x20000
  s_lshr_b32 s50, s26, 2
  s_lshl_b32 s51, s61, 1
  s_add_u32 s51, s51, s50
  s_and_b32 s50, s26, 3
  s_lshl_b32 s50, s50, 3
  v_lshrrev_b32 v4, 3, v1
  v_add_u32 v12, s50, v4
  s_cmp_ge_u32 s51, 16
  s_cbranch_scc0 L_jlo_40
  s_sub_u32 s58, s51, 16
  s_lshl_b32 s58, s58, 4
  v_lshrrev_b32 v13, 1, v12
  v_add_u32 v13, s58, v13
  v_mul_u32_u24 v13, 18, v13
  v_and_b32 v14, 1, v12
  v_add3_u32 v15, v13, v14, 16
  s_branch L_jdone_41
L_jlo_40:
  s_lshl_b32 s58, s51, 1
  v_lshrrev_b32 v13, 4, v12
  v_add_u32 v13, s58, v13
  v_mul_u32_u24 v13, 18, v13
  v_bfe_u32 v14, v12, 2, 1
  v_lshl_add_u32 v13, v14, 3, v13
  v_bfe_u32 v14, v12, 3, 1
  v_lshl_add_u32 v13, v14, 2, v13
  v_and_b32 v14, 3, v12
  v_add_u32 v15, v13, v14
L_jdone_41:
  v_mul_u32_u24 v7, 1152, v15
  v_and_b32 v5, 7, v1
  v_xor_b32 v5, v5, v4
  v_lshl_add_u32 v7, v5, 4, v7
  s_mul_i32 s52, s26, 9216
  s_add_u32 m0, s52, 0
  s_mov_b32 s53, 0
  buffer_load_dwordx4 v7, s[32:35], s53 offen lds
  s_add_u32 m0, s52, 1024
  s_mov_b32 s53, 128
  buffer_load_dwordx4 v7, s[32:35], s53 offen lds
  s_add_u32 m0, s52, 2048
  s_mov_b32 s53, 256
  buffer_load_dwordx4 v7, s[32:35], s53 offen lds
  s_add_u32 m0, s52, 3072
  s_mov_b32 s53, 384
  buffer_load_dwordx4 v7, s[32:35], s53 offen lds
  s_add_u32 m0, s52, 4096
  s_mov_b32 s53, 512
  buffer_load_dwordx4 v7, s[32:35], s53 offen lds
  s_add_u32 m0, s52, 5120
  s_mov_b32 s53, 640
  buffer_load_dwordx4 v7, s[32:35], s53 offen lds
  s_add_u32 m0, s52, 6144
  s_mov_b32 s53, 768
  buffer_load_dwordx4 v7, s[32:35], s53 offen lds
  s_add_u32 m0, s52, 7168
  s_mov_b32 s53, 896
  buffer_load_dwordx4 v7, s[32:35], s53 offen lds
  s_add_u32 m0, s52, 8192
  s_mov_b32 s53, 1024
  buffer_load_dwordx4 v7, s[32:35], s53 offen lds
  s_lshl_b32 s57, s60, 3
  s_add_u32 s57, s57, s26
  s_cmp_ge_u32 s57, 36
  s_cbranch_scc1 L_ft_backo
  s_mov_b32 s59, 1
  s_branch L_ft_prep
L_ft_backo:
  s_waitcnt vmcnt(0)
  s_barrier
  s_cmp_ge_u32 s57, 36
  s_cbranch_scc1 L_po_fin_42
  v_and_b32 v4, 7, v2
  v_xor_b32 v5, v4, v3
  v_lshlrev_b32 v5, 4, v5
  v_lshl_add_u32 v5, v4, 7, v5
  v_lshrrev_b32 v6, 3, v2
  v_mul_u32_u24 v6, 9216, v6
  v_add_u32 v8, v5, v6
  v_xor_b32 v9, 64, v8
  ds_read_b128 v[16:19], v8 offset:0
  ds_read_b128 v[20:23], v8 offset:18432
  ds_read_b128 v[24:27], v8 offset:36864
  ds_read_b128 v[28:31], v8 offset:55296
  ds_read_b128 v[32:35], v9 offset:0
  ds_read_b128 v[36:39], v9 offset:18432
  ds_read_b128 v[40:43], v9 offset:36864
  ds_read_b128 v[44:47], v9 offset:55296
  s_waitcnt lgkmcnt(4)
  v_mfma_f32_16x16x32_bf16 v[140:143], v[64:67], v[16:19], 0
  v_mfma_f32_16x16x32_bf16 v[144:147], v[64:67], v[20:23], 0
  v_mfma_f32_16x16x32_bf16 v[148:151], v[64:67], v[24:27], 0
  v_mfma_f32_16x16x32_bf16 v[152:155], v[64:67], v[28:31], 0
  ds_read_b128 v[48:51], v8 offset:1024
  ds_read_b128 v[52:55], v8 offset:19456
  ds_read_b128 v[56:59], v8 offset:37888
  ds_read_b128 v[60:63], v8 offset:56320
  s_waitcnt lgkmcnt(4)
  v_mfma_f32_16x16x32_bf16 v[140:143], v[68:71], v[32:35], v[140:143]
  v_mfma_f32_16x16x32_bf16 v[144:147], v[68:71], v[36:39], v[144:147]
  v_mfma_f32_16x16x32_bf16 v[148:151], v[68:71], v[40:43], v[148:151]
  v_mfma_f32_16x16x32_bf16 v[152:155], v[68:71], v[44:47], v[152:155]
  ds_read_b128 v[16:19], v9 offset:1024
  ds_read_b128 v[20:23], v9 offset:19456
  ds_read_b128 v[24:27], v9 offset:37888
  ds_read_b128 v[28:31], v9 offset:56320
  s_waitcnt lgkmcnt(4)
  v_mfma_f32_16x16x32_bf16 v[140:143], v[72:75], v[48:51], v[140:143]
  v_mfma_f32_16x16x32_bf16 v[144:147], v[72:75], v[52:55], v[144:147]
  v_mfma_f32_16x16x32_bf16 v[148:151], v[72:75], v[56:59], v[148:151]
  v_mfma_f32_16x16x32_bf16 v[152:155], v[72:75], v[60:63], v[152:155]
  ds_read_b128 v[32:35], v8 offset:2048
  ds_read_b128 v[36:39], v8 offset:20480
  ds_read_b128 v[40:43], v8 offset:38912
  ds_read_b128 v[44:47], v8 offset:57344
  s_waitcnt lgkmcnt(4)
  v_mfma_f32_16x16x32_bf16 v[140:143], v[76:79], v[16:19], v[140:143]
  v_mfma_f32_16x16x32_bf16 v[144:147], v[76:79], v[20:23], v[144:147]
  v_mfma_f32_16x16x32_bf16 v[148:151], v[76:79], v[24:27], v[148:151]
  v_mfma_f32_16x16x32_bf16 v[152:155], v[76:79], v[28:31], v[152:155]
  ds_read_b128 v[48:51], v9 offset:2048
  ds_read_b128 v[52:55], v9 offset:20480
  ds_read_b128 v[56:59], v9 offset:38912
  ds_read_b128 v[60:63], v9 offset:57344
  s_waitcnt lgkmcnt(4)
  v_mfma_f32_16x16x32_bf16 v[140:143], v[80:83], v[32:35], v[140:143]
  v_mfma_f32_16x16x32_bf16 v[144:147], v[80:83], v[36:39], v[144:147]
  v_mfma_f32_16x16x32_bf16 v[148:151], v[80:83], v[40:43], v[148:151]
  v_mfma_f32_16x16x32_bf16 v[152:155], v[80:83], v[44:47], v[152:155]
  ds_read_b128 v[16:19], v8 offset:3072
  ds_read_b128 v[20:23], v8 offset:21504
  ds_read_b128 v[24:27], v8 offset:39936
  ds_read_b128 v[28:31], v8 offset:58368
  s_waitcnt lgkmcnt(4)
  v_mfma_f32_16x16x32_bf16 v[140:143], v[84:87], v[48:51], v[140:143]
  v_mfma_f32_16x16x32_bf16 v[144:147], v[84:87], v[52:55], v[144:147]
  v_mfma_f32_16x16x32_bf16 v[148:151], v[84:87], v[56:59], v[148:151]
  v_mfma_f32_16x16x32_bf16 v[152:155], v[84:87], v[60:63], v[152:155]
  ds_read_b128 v[32:35], v9 offset:3072
  ds_read_b128 v[36:39], v9 offset:21504
  ds_read_b128 v[40:43], v9 offset:39936
  ds_read_b128 v[44:47], v9 offset:58368
  s_waitcnt lgkmcnt(4)
  v_mfma_f32_16x16x32_bf16 v[140:143], v[88:91], v[16:19], v[140:143]
  v_mfma_f32_16x16x32_bf16 v[144:147], v[88:91], v[20:23], v[144:147]
  v_mfma_f32_16x16x32_bf16 v[148:151], v[88:91], v[24:27], v[148:151]
  v_mfma_f32_16x16x32_bf16 v[152:155], v[88:91], v[28:31], v[152:155]
  ds_read_b128 v[48:51], v8 offset:4096
  ds_read_b128 v[52:55], v8 offset:22528
  ds_read_b128 v[56:59], v8 offset:40960
  ds_read_b128 v[60:63], v8 offset:59392
  s_waitcnt lgkmcnt(4)
  v_mfma_f32_16x16x32_bf16 v[140:143], v[92:95], v[32:35], v[140:143]
  v_mfma_f32_16x16x32_bf16 v[144:147], v[92:95], v[36:39], v[144:147]
  v_mfma_f32_16x16x32_bf16 v[148:151], v[92:95], v[40:43], v[148:151]
  v_mfma_f32_16x16x32_bf16 v[152:155], v[92:95], v[44:47], v[152:155]
  ds_read_b128 v[16:19], v9 offset:4096
  ds_read_b128 v[20:23], v9 offset:22528
  ds_read_b128 v[24:27], v9 offset:40960
  ds_read_b128 v[28:31], v9 offset:59392
  s_waitcnt lgkmcnt(4)
  v_mfma_f32_16x16x32_bf16 v[140:143], v[96:99], v[48:51], v[140:143]
  v_mfma_f32_16x16x32_bf16 v[144:147], v[96:99], v[52:55], v[144:147]
  v_mfma_f32_16x16x32_bf16 v[148:151], v[96:99], v[56:59], v[148:151]
  v_mfma_f32_16x16x32_bf16 v[152:155], v[96:99], v[60:63], v[152:155]
  ds_read_b128 v[32:35], v8 offset:5120
  ds_read_b128 v[36:39], v8 offset:23552
  ds_read_b128 v[40:43], v8 offset:41984
  ds_read_b128 v[44:47], v8 offset:60416
  s_waitcnt lgkmcnt(4)
  v_mfma_f32_16x16x32_bf16 v[140:143], v[100:103], v[16:19], v[140:143]
  v_mfma_f32_16x16x32_bf16 v[144:147], v[100:103], v[20:23], v[144:147]
  v_mfma_f32_16x16x32_bf16 v[148:151], v[100:103], v[24:27], v[148:151]
  v_mfma_f32_16x16x32_bf16 v[152:155], v[100:103], v[28:31], v[152:155]
  ds_read_b128 v[48:51], v9 offset:5120
  ds_read_b128 v[52:55], v9 offset:23552
  ds_read_b128 v[56:59], v9 offset:41984
  ds_read_b128 v[60:63], v9 offset:60416
  s_waitcnt lgkmcnt(4)
  v_mfma_f32_16x16x32_bf16 v[140:143], v[104:107], v[32:35], v[140:143]
  v_mfma_f32_16x16x32_bf16 v[144:147], v[104:107], v[36:39], v[144:147]
  v_mfma_f32_16x16x32_bf16 v[148:151], v[104:107], v[40:43], v[148:151]
  v_mfma_f32_16x16x32_bf16 v[152:155], v[104:107], v[44:47], v[152:155]
  ds_read_b128 v[16:19], v8 offset:6144
  ds_read_b128 v[20:23], v8 offset:24576
  ds_read_b128 v[24:27], v8 offset:43008
  ds_read_b128 v[28:31], v8 offset:61440
  s_waitcnt lgkmcnt(4)
  v_mfma_f32_16x16x32_bf16 v[140:143], v[108:111], v[48:51], v[140:143]
  v_mfma_f32_16x16x32_bf16 v[144:147], v[108:111], v[52:55], v[144:147]
  v_mfma_f32_16x16x32_bf16 v[148:151], v[108:111], v[56:59], v[148:151]
  v_mfma_f32_16x16x32_bf16 v[152:155], v[108:111], v[60:63], v[152:155]
  ds_read_b128 v[32:35], v9 offset:6144
  ds_read_b128 v[36:39], v9 offset:24576
  ds_read_b128 v[40:43], v9 offset:43008
  ds_read_b128 v[44:47], v9 offset:61440
  s_waitcnt lgkmcnt(4)
  v_mfma_f32_16x16x32_bf16 v[140:143], v[112:115], v[16:19], v[140:143]
  v_mfma_f32_16x16x32_bf16 v[144:147], v[112:115], v[20:23], v[144:147]
  v_mfma_f32_16x16x32_bf16 v[148:151], v[112:115], v[24:27], v[148:151]
  v_mfma_f32_16x16x32_bf16 v[152:155], v[112:115], v[28:31], v[152:155]
  ds_read_b128 v[48:51], v8 offset:7168
  ds_read_b128 v[52:55], v8 offset:25600
  ds_read_b128 v[56:59], v8 offset:44032
  ds_read_b128 v[60:63], v8 offset:62464
  s_waitcnt lgkmcnt(4)
  v_mfma_f32_16x16x32_bf16 v[140:143], v[116:119], v[32:35], v[140:143]
  v_mfma_f32_16x16x32_bf16 v[144:147], v[116:119], v[36:39], v[144:147]
  v_mfma_f32_16x16x32_bf16 v[148:151], v[116:119], v[40:43], v[148:151]
  v_mfma_f32_16x16x32_bf16 v[152:155], v[116:119], v[44:47], v[152:155]
  ds_read_b128 v[16:19], v9 offset:7168
  ds_read_b128 v[20:23], v9 offset:25600
  ds_read_b128 v[24:27], v9 offset:44032
  ds_read_b128 v[28:31], v9 offset:62464
  s_waitcnt lgkmcnt(4)
  v_mfma_f32_16x16x32_bf16 v[140:143], v[120:123], v[48:51], v[140:143]
  v_mfma_f32_16x16x32_bf16 v[144:147], v[120:123], v[52:55], v[144:147]
  v_mfma_f32_16x16x32_bf16 v[148:151], v[120:123], v[56:59], v[148:151]
  v_mfma_f32_16x16x32_bf16 v[152:155], v[120:123], v[60:63], v[152:155]
  ds_read_b128 v[32:35], v8 offset:8192
  ds_read_b128 v[36:39], v8 offset:26624
  ds_read_b128 v[40:43], v8 offset:45056
  ds_read_b128 v[44:47], v8 offset:63488
  s_waitcnt lgkmcnt(4)
  v_mfma_f32_16x16x32_bf16 v[140:143], v[124:127], v[16:19], v[140:143]
  v_mfma_f32_16x16x32_bf16 v[144:147], v[124:127], v[20:23], v[144:147]
  v_mfma_f32_16x16x32_bf16 v[148:151], v[124:127], v[24:27], v[148:151]
  v_mfma_f32_16x16x32_bf16 v[152:155], v[124:127], v[28:31], v[152:155]
  ds_read_b128 v[48:51], v9 offset:8192
  ds_read_b128 v[52:55], v9 offset:26624
  ds_read_b128 v[56:59], v9 offset:45056
  ds_read_b128 v[60:63], v9 offset:63488
  s_waitcnt lgkmcnt(4)
  v_mfma_f32_16x16x32_bf16 v[140:143], v[128:131], v[32:35], v[140:143]
  v_mfma_f32_16x16x32_bf16 v[144:147], v[128:131], v[36:39], v[144:147]
  v_mfma_f32_16x16x32_bf16 v[148:151], v[128:131], v[40:43], v[148:151]
  v_mfma_f32_16x16x32_bf16 v[152:155], v[128:131], v[44:47], v[152:155]
  s_waitcnt lgkmcnt(0)
  v_mfma_f32_16x16x32_bf16 v[140:143], v[132:135], v[48:51], v[140:143]
  v_mfma_f32_16x16x32_bf16 v[144:147], v[132:135], v[52:55], v[144:147]
  v_mfma_f32_16x16x32_bf16 v[148:151], v[132:135], v[56:59], v[148:151]
  v_mfma_f32_16x16x32_bf16 v[152:155], v[132:135], v[60:63], v[152:155]
  s_nop 4
  v_cvt_pk_bf16_f32 v140, v140, v141
  v_cvt_pk_bf16_f32 v141, v142, v143
  v_cvt_pk_bf16_f32 v144, v144, v145
  v_cvt_pk_bf16_f32 v145, v146, v147
  v_cvt_pk_bf16_f32 v148, v148, v149
  v_cvt_pk_bf16_f32 v149, v150, v151
  v_cvt_pk_bf16_f32 v152, v152, v153
  v_cvt_pk_bf16_f32 v153, v154, v155
  s_lshl_b32 s50, s26, 11
  s_add_u32 s50, s50, 81920
  v_lshlrev_b32 v4, 5, v2
  v_lshl_add_u32 v4, v3, 3, v4
  v_add_u32 v4, s50, v4
  ds_write_b64 v4, v[140:141] offset:0
  ds_write_b64 v4, v[144:145] offset:512
  ds_write_b64 v4, v[148:149] offset:1024
  ds_write_b64 v4, v[152:153] offset:1536
  v_lshrrev_b32 v5, 2, v2
  v_lshl_add_u32 v5, v3, 3, v5
  v_lshlrev_b32 v5, 5, v5
  v_and_b32 v6, 3, v2
  v_lshl_add_u32 v5, v6, 3, v5
  v_add_u32 v5, s50, v5
  s_waitcnt lgkmcnt(0)
  ds_read_b64_tr_b16 v[16:17], v5 offset:0
  ds_read_b64_tr_b16 v[18:19], v5 offset:128
  ds_read_b64_tr_b16 v[20:21], v5 offset:1024
  ds_read_b64_tr_b16 v[22:23], v5 offset:1152
  v_lshlrev_b32 v4, 4, v1
  s_mul_i32 s54, s57, 18
  s_lshl_b32 s55, s61, 1
  s_add_u32 s54, s54, s55
  s_lshl_b32 s54, s54, 10
  s_add_u32 s54, s54, 12730368
  s_waitcnt lgkmcnt(0)
  buffer_store_dwordx4 v[16:19], v4, s[28:31], s54 offen sc1
  buffer_store_dwordx4 v[20:23], v4, s[28:31], s54 offen offset:1024 sc1
L_po_fin_42:
  s_branch L_prepdone_30
L_prept_29:
  s_mov_b32 s32, s18
  s_mov_b32 s33, s19
  s_mov_b32 s34, 663552
  s_mov_b32 s35, 0x20000
  s_lshr_b32 s50, s26, 2
  s_lshl_b32 s51, s61, 1
  s_add_u32 s51, s51, s50
  s_and_b32 s50, s26, 3
  s_lshl_b32 s50, s50, 3
  v_lshrrev_b32 v4, 3, v1
  v_add_u32 v12, s50, v4
  s_cmp_ge_u32 s51, 16
  s_cbranch_scc0 L_jlo_43
  s_sub_u32 s58, s51, 16
  s_lshl_b32 s58, s58, 4
  v_lshrrev_b32 v13, 1, v12
  v_add_u32 v13, s58, v13
  v_mul_u32_u24 v13, 18, v13
  v_and_b32 v14, 1, v12
  v_add3_u32 v15, v13, v14, 16
  s_branch L_jdone_44
L_jlo_43:
  s_lshl_b32 s58, s51, 1
  v_lshrrev_b32 v13, 4, v12
  v_add_u32 v13, s58, v13
  v_mul_u32_u24 v13, 18, v13
  v_bfe_u32 v14, v12, 2, 1
  v_lshl_add_u32 v13, v14, 3, v13
  v_bfe_u32 v14, v12, 3, 1
  v_lshl_add_u32 v13, v14, 2, v13
  v_and_b32 v14, 3, v12
  v_add_u32 v15, v13, v14
L_jdone_44:
  v_mul_u32_u24 v7, 1152, v15
  v_and_b32 v5, 7, v1
  v_xor_b32 v5, v5, v4
  v_lshl_add_u32 v7, v5, 4, v7
  s_mul_i32 s52, s26, 9216
  s_add_u32 m0, s52, 0
  s_mov_b32 s53, 0
  buffer_load_dwordx4 v7, s[32:35], s53 offen lds
  s_add_u32 m0, s52, 1024
  s_mov_b32 s53, 128
  buffer_load_dwordx4 v7, s[32:35], s53 offen lds
  s_add_u32 m0, s52, 2048
  s_mov_b32 s53, 256
  buffer_load_dwordx4 v7, s[32:35], s53 offen lds
  s_add_u32 m0, s52, 3072
  s_mov_b32 s53, 384
  buffer_load_dwordx4 v7, s[32:35], s53 offen lds
  s_add_u32 m0, s52, 4096
  s_mov_b32 s53, 512
  buffer_load_dwordx4 v7, s[32:35], s53 offen lds
  s_add_u32 m0, s52, 5120
  s_mov_b32 s53, 640
  buffer_load_dwordx4 v7, s[32:35], s53 offen lds
  s_add_u32 m0, s52, 6144
  s_mov_b32 s53, 768
  buffer_load_dwordx4 v7, s[32:35], s53 offen lds
  s_add_u32 m0, s52, 7168
  s_mov_b32 s53, 896
  buffer_load_dwordx4 v7, s[32:35], s53 offen lds
  s_add_u32 m0, s52, 8192
  s_mov_b32 s53, 1024
  buffer_load_dwordx4 v7, s[32:35], s53 offen lds
  s_waitcnt vmcnt(0)
  s_barrier
  v_lshrrev_b32 v4, 2, v2
  v_and_b32 v5, 3, v2
  v_mul_u32_u24 v6, 9216, v3
  v_lshrrev_b32 v7, 1, v5
  v_and_b32 v5, 1, v5
  v_lshl_add_u32 v6, v5, 3, v6
  v_lshlrev_b32 v12, 4, v1
  s_and_b32 s50, s26, 3
  s_lshl_b32 s50, s50, 1
  v_add_u32 v7, s50, v7
  v_add_u32 v8, 0, v4
  v_xor_b32 v9, v7, v8
  v_lshlrev_b32 v9, 4, v9
  v_lshl_add_u32 v9, v8, 7, v9
  v_add_u32 v10, v9, v6
  v_add_u32 v8, 4, v4
  v_xor_b32 v9, v7, v8
  v_lshlrev_b32 v9, 4, v9
  v_lshl_add_u32 v9, v8, 7, v9
  v_add_u32 v11, v9, v6
  s_add_u32 s51, s26, 0
  s_lshr_b32 s52, s51, 2
  s_lshl_b32 s52, s52, 10
  v_add_u32 v13, s52, v10
  v_add_u32 v14, s52, v11
  ds_read_b64_tr_b16 v[16:17], v13 offset:0
  ds_read_b64_tr_b16 v[18:19], v14 offset:0
  ds_read_b64_tr_b16 v[20:21], v13 offset:36864
  ds_read_b64_tr_b16 v[22:23], v14 offset:36864
  s_mul_i32 s54, s51, 18
  s_lshl_b32 s55, s61, 1
  s_add_u32 s54, s54, s55
  s_lshl_b32 s54, s54, 10
  s_add_u32 s54, s54, 13393920
  s_waitcnt lgkmcnt(0)
  buffer_store_dwordx4 v[16:19], v12, s[28:31], s54 offen sc1
  buffer_store_dwordx4 v[20:23], v12, s[28:31], s54 offen offset:1024 sc1
  s_nop 1
  s_add_u32 s51, s26, 8
  s_lshr_b32 s52, s51, 2
  s_lshl_b32 s52, s52, 10
  v_add_u32 v13, s52, v10
  v_add_u32 v14, s52, v11
  ds_read_b64_tr_b16 v[16:17], v13 offset:0
  ds_read_b64_tr_b16 v[18:19], v14 offset:0
  ds_read_b64_tr_b16 v[20:21], v13 offset:36864
  ds_read_b64_tr_b16 v[22:23], v14 offset:36864
  s_mul_i32 s54, s51, 18
  s_lshl_b32 s55, s61, 1
  s_add_u32 s54, s54, s55
  s_lshl_b32 s54, s54, 10
  s_add_u32 s54, s54, 13393920
  s_waitcnt lgkmcnt(0)
  buffer_store_dwordx4 v[16:19], v12, s[28:31], s54 offen sc1
  buffer_store_dwordx4 v[20:23], v12, s[28:31], s54 offen offset:1024 sc1
  s_nop 1
  s_add_u32 s51, s26, 16
  s_lshr_b32 s52, s51, 2
  s_lshl_b32 s52, s52, 10
  v_add_u32 v13, s52, v10
  v_add_u32 v14, s52, v11
  ds_read_b64_tr_b16 v[16:17], v13 offset:0
  ds_read_b64_tr_b16 v[18:19], v14 offset:0
  ds_read_b64_tr_b16 v[20:21], v13 offset:36864
  ds_read_b64_tr_b16 v[22:23], v14 offset:36864
  s_mul_i32 s54, s51, 18
  s_lshl_b32 s55, s61, 1
  s_add_u32 s54, s54, s55
  s_lshl_b32 s54, s54, 10
  s_add_u32 s54, s54, 13393920
  s_waitcnt lgkmcnt(0)
  buffer_store_dwordx4 v[16:19], v12, s[28:31], s54 offen sc1
  buffer_store_dwordx4 v[20:23], v12, s[28:31], s54 offen offset:1024 sc1
  s_nop 1
  s_add_u32 s51, s26, 24
  s_lshr_b32 s52, s51, 2
  s_lshl_b32 s52, s52, 10
  v_add_u32 v13, s52, v10
  v_add_u32 v14, s52, v11
  ds_read_b64_tr_b16 v[16:17], v13 offset:0
  ds_read_b64_tr_b16 v[18:19], v14 offset:0
  ds_read_b64_tr_b16 v[20:21], v13 offset:36864
  ds_read_b64_tr_b16 v[22:23], v14 offset:36864
  s_mul_i32 s54, s51, 18
  s_lshl_b32 s55, s61, 1
  s_add_u32 s54, s54, s55
  s_lshl_b32 s54, s54, 10
  s_add_u32 s54, s54, 13393920
  s_waitcnt lgkmcnt(0)
  buffer_store_dwordx4 v[16:19], v12, s[28:31], s54 offen sc1
  buffer_store_dwordx4 v[20:23], v12, s[28:31], s54 offen offset:1024 sc1
  s_nop 1
  s_cmp_ge_u32 s26, 4
  s_cbranch_scc1 L_pt_skip_45
  s_add_u32 s51, s26, 32
  s_lshr_b32 s52, s51, 2
  s_lshl_b32 s52, s52, 10
  v_add_u32 v13, s52, v10
  v_add_u32 v14, s52, v11
  ds_read_b64_tr_b16 v[16:17], v13 offset:0
  ds_read_b64_tr_b16 v[18:19], v14 offset:0
  ds_read_b64_tr_b16 v[20:21], v13 offset:36864
  ds_read_b64_tr_b16 v[22:23], v14 offset:36864
  s_mul_i32 s54, s51, 18
  s_lshl_b32 s55, s61, 1
  s_add_u32 s54, s54, s55
  s_lshl_b32 s54, s54, 10
  s_add_u32 s54, s54, 13393920
  s_waitcnt lgkmcnt(0)
  buffer_store_dwordx4 v[16:19], v12, s[28:31], s54 offen sc1
  buffer_store_dwordx4 v[20:23], v12, s[28:31], s54 offen offset:1024 sc1
  s_nop 1
L_pt_skip_45:
L_prepdone_30:
  s_branch L_sdone_17
L_prep5_18:
  v_lshlrev_b32 v60, 4, v1
  s_mul_i32 s57, s44, 9
  s_add_u32 s57, s57, s26
  s_mul_i32 s57, s57, 18432
  s_add_u32 s57, s57, 11993088
  s_add_u32 s49, s57, 0
  buffer_load_dwordx4 v[64:67], v60, s[28:31], s49 offen sc1
  buffer_load_dwordx4 v[68:71], v60, s[28:31], s49 offen offset:1024 sc1
  buffer_load_dwordx4 v[72:75], v60, s[28:31], s49 offen offset:2048 sc1
  buffer_load_dwordx4 v[76:79], v60, s[28:31], s49 offen offset:3072 sc1
  s_add_u32 s49, s57, 4096
  buffer_load_dwordx4 v[80:83], v60, s[28:31], s49 offen sc1
  buffer_load_dwordx4 v[84:87], v60, s[28:31], s49 offen offset:1024 sc1
  buffer_load_dwordx4 v[88:91], v60, s[28:31], s49 offen offset:2048 sc1
  buffer_load_dwordx4 v[92:95], v60, s[28:31], s49 offen offset:3072 sc1
  s_add_u32 s49, s57, 8192
  buffer_load_dwordx4 v[96:99], v60, s[28:31], s49 offen sc1
  buffer_load_dwordx4 v[100:103], v60, s[28:31], s49 offen offset:1024 sc1
  buffer_load_dwordx4 v[104:107], v60, s[28:31], s49 offen offset:2048 sc1
  buffer_load_dwordx4 v[108:111], v60, s[28:31], s49 offen offset:3072 sc1
  s_add_u32 s49, s57, 12288
  buffer_load_dwordx4 v[112:115], v60, s[28:31], s49 offen sc1
  buffer_load_dwordx4 v[116:119], v60, s[28:31], s49 offen offset:1024 sc1
  buffer_load_dwordx4 v[120:123], v60, s[28:31], s49 offen offset:2048 sc1
  buffer_load_dwordx4 v[124:127], v60, s[28:31], s49 offen offset:3072 sc1
  s_add_u32 s49, s57, 16384
  buffer_load_dwordx4 v[128:131], v60, s[28:31], s49 offen sc1
  buffer_load_dwordx4 v[132:135], v60, s[28:31], s49 offen offset:1024 sc1
  s_mov_b32 s79, 1
L_sdone_17:
  s_waitcnt vmcnt(0) lgkmcnt(0)
  s_barrier
  s_cmp_lg_u32 s26, 0
  s_cbranch_scc1 L_arr_46
  s_mul_i32 s48, s45, 24576
  s_add_u32 s48, s48, 8192
  s_and_b32 s49, s2, 31
  s_lshl_b32 s49, s49, 8
  s_add_u32 s48, s48, s49
  v_mov_b32 v4, s48
  v_mov_b32 v5, 1
  s_mov_b64 exec, 1
  buffer_atomic_add v5, v4, s[28:31], 0 offen sc1
  s_mov_b64 exec, -1
L_arr_46:
  s_cmp_lg_u32 s26, 7
  s_cbranch_scc1 L_wdone_47
  s_mul_i32 s48, s45, 24576
  s_add_u32 s48, s48, 8192
  v_and_b32 v4, 31, v1
  v_lshlrev_b32 v4, 8, v4
  v_add_u32 v4, s48, v4
  s_mov_b32 s48, 0
  s_setprio 3
  s_sleep 28
L_poll_48:
  buffer_load_dword v5, v4, s[28:31], 0 offen sc1
  s_waitcnt vmcnt(0)
  v_cmp_gt_u32 vcc, 8, v5
  s_add_u32 s48, s48, 1
  s_cmp_gt_u32 s48, 60000
  s_cbranch_scc1 L_wdone_47
  s_nop 1
  s_cbranch_vccz L_wdone_47
  s_sleep 4
  s_branch L_poll_48
L_wdone_47:
  s_setprio 0
  s_barrier
  s_cmp_eq_u32 s45, 0
  s_mov_b32 s72, 7208960
  s_cselect_b32 s72, 2490368, s72
  s_mov_b32 s73, 14209024
  s_cselect_b32 s73, 14057472, s73
  s_mov_b32 s74, 16719872
  s_cselect_b32 s74, 14360576, s74
  v_lshlrev_b32 v60, 4, v1
  s_mul_i32 s54, s27, 36864
  s_add_u32 s54, s54, s72
  s_add_u32 s50, s26, 0
  s_lshl_b32 s50, s50, 10
  s_add_u32 m0, s50, 113664
  s_add_u32 s50, s50, s54
  buffer_load_dwordx4 v60, s[28:31], s50 offen sc1 lds
  s_add_u32 s50, s26, 8
  s_lshl_b32 s50, s50, 10
  s_add_u32 m0, s50, 113664
  s_add_u32 s50, s50, s54
  buffer_load_dwordx4 v60, s[28:31], s50 offen sc1 lds
  s_add_u32 s50, s26, 16
  s_lshl_b32 s50, s50, 10
  s_add_u32 m0, s50, 113664
  s_add_u32 s50, s50, s54
  buffer_load_dwordx4 v60, s[28:31], s50 offen sc1 lds
  s_add_u32 s50, s26, 24
  s_lshl_b32 s50, s50, 10
  s_add_u32 m0, s50, 113664
  s_add_u32 s50, s50, s54
  buffer_load_dwordx4 v60, s[28:31], s50 offen sc1 lds
  s_cmp_ge_u32 s26, 4
  s_cbranch_scc1 L_tdma_49
  s_add_u32 s50, s26, 32
  s_lshl_b32 s50, s50, 10
  s_add_u32 m0, s50, 113664
  s_add_u32 s50, s50, s54
  buffer_load_dwordx4 v60, s[28:31], s50 offen sc1 lds
L_tdma_49:
  s_cmp_lt_u32 s26, 6
  s_cbranch_scc1 L_p2nk_50
  s_add_u32 s57, s44, 36
  s_mul_i32 s57, s57, 18432
  s_add_u32 s57, s57, 11993088
  s_add_u32 s49, s57, 0
  buffer_load_dwordx4 v[136:139], v60, s[28:31], s49 offen sc1
  buffer_load_dwordx4 v[140:143], v60, s[28:31], s49 offen offset:1024 sc1
  buffer_load_dwordx4 v[144:147], v60, s[28:31], s49 offen offset:2048 sc1
  buffer_load_dwordx4 v[148:151], v60, s[28:31], s49 offen offset:3072 sc1
  s_add_u32 s49, s57, 4096
  buffer_load_dwordx4 v[152:155], v60, s[28:31], s49 offen sc1
  buffer_load_dwordx4 v[156:159], v60, s[28:31], s49 offen offset:1024 sc1
  buffer_load_dwordx4 v[160:163], v60, s[28:31], s49 offen offset:2048 sc1
  buffer_load_dwordx4 v[164:167], v60, s[28:31], s49 offen offset:3072 sc1
  s_add_u32 s49, s57, 8192
  buffer_load_dwordx4 v[168:171], v60, s[28:31], s49 offen sc1
  buffer_load_dwordx4 v[172:175], v60, s[28:31], s49 offen offset:1024 sc1
  buffer_load_dwordx4 v[176:179], v60, s[28:31], s49 offen offset:2048 sc1
  buffer_load_dwordx4 v[180:183], v60, s[28:31], s49 offen offset:3072 sc1
  s_add_u32 s49, s57, 12288
  buffer_load_dwordx4 v[184:187], v60, s[28:31], s49 offen sc1
  buffer_load_dwordx4 v[188:191], v60, s[28:31], s49 offen offset:1024 sc1
  buffer_load_dwordx4 v[192:195], v60, s[28:31], s49 offen offset:2048 sc1
  buffer_load_dwordx4 v[196:199], v60, s[28:31], s49 offen offset:3072 sc1
  s_add_u32 s49, s57, 16384
  buffer_load_dwordx4 v[200:203], v60, s[28:31], s49 offen sc1
  buffer_load_dwordx4 v[204:207], v60, s[28:31], s49 offen offset:1024 sc1
L_p2nk_50:
  v_mov_b32 v4, 161920
  v_mov_b32 v5, 0
  ds_write_b32 v4, v5
  s_and_b32 s50, s26, 1
  v_and_b32 v4, 1, v3
  v_xor_b32 v4, s50, v4
  v_lshlrev_b32 v5, 9, v3
  v_lshl_add_u32 v5, v4, 7, v5
  v_lshl_add_u32 v5, v2, 3, v5
  v_add_u32 v56, 113664, v5
  v_xor_b32 v57, 128, v56
  s_cmp_ge_u32 s26, 6
  s_cbranch_scc1 L_p2kv_51
  s_waitcnt vmcnt(0) lgkmcnt(0)
  s_barrier
  s_branch L_p2wd_52
L_p2kv_51:
  s_setprio 3
  s_and_b32 s64, s26, 1
  s_lshl_b32 s50, s64, 6
  s_add_u32 s50, s50, 161792
  v_lshlrev_b32 v62, 2, v2
  v_add_u32 v62, s50, v62
  s_lshl_b32 s50, s64, 9
  s_add_u32 s50, s50, 0
  v_lshlrev_b32 v63, 5, v2
  v_lshl_add_u32 v63, v3, 3, v63
  v_add_u32 v63, s50, v63
  v_lshrrev_b32 v54, 2, v2
  v_lshl_add_u32 v54, v3, 2, v54
  v_lshlrev_b32 v54, 5, v54
  v_and_b32 v6, 3, v2
  v_lshl_add_u32 v54, v6, 3, v54
  v_add_u32 v54, s50, v54
  s_and_b32 s51, s27, 31
  s_lshr_b32 s52, s51, 2
  s_mul_i32 s52, s52, 18944
  s_and_b32 s51, s51, 3
  s_lshr_b32 s53, s27, 5
  s_lshl_b32 s53, s53, 2
  s_add_u32 s51, s51, s53
  s_add_u32 s52, s52, s73
  s_mov_b64 s[80:81], -1
  s_mov_b64 s[82:83], 0
  s_bitcmp1_b32 s44, 0
  s_cbranch_scc1 L_kva1_53
  s_cmp_eq_u32 s44, 2
  s_cbranch_scc1 L_kva2_54
  s_lshl_b32 s62, s51, 10
  s_add_u32 s62, s62, s52
  s_lshl_b32 s50, s64, 8
  s_add_u32 s62, s62, s50
  v_lshrrev_b32 v4, 1, v3
  v_lshlrev_b32 v4, 9, v4
  v_lshl_add_u32 v4, v2, 4, v4
  v_and_b32 v5, 1, v3
  v_lshl_add_u32 v61, v5, 3, v4
  s_branch L_kvad_55
L_kva2_54:
  s_lshl_b32 s62, s51, 7
  s_add_u32 s62, s62, s52
  s_add_u32 s62, s62, 8192
  s_lshl_b32 s50, s64, 6
  s_add_u32 s62, s62, s50
  v_lshlrev_b32 v61, 2, v2
  s_mov_b64 s[80:81], 0xffff
  s_branch L_kvad_55
L_kva1_53:
  s_mul_i32 s62, s51, 1216
  s_add_u32 s62, s62, s52
  s_add_u32 s62, s62, 9216
  s_mul_i32 s50, s64, 608
  s_add_u32 s62, s62, s50
  v_and_b32 v5, 1, v3
  v_mul_u32_u24 v4, 304, v5
  v_lshl_add_u32 v4, v2, 4, v4
  v_lshrrev_b32 v5, 1, v3
  v_lshl_add_u32 v61, v5, 3, v4
  s_cmp_lg_u32 s44, 3
  s_cbranch_scc1 L_kvad_55
  s_add_u32 s62, s62, 256
  v_cmp_gt_u32 s[80:81], 3, v2
  v_cmp_eq_u32 s[82:83], 2, v2
L_kvad_55:
  s_mul_i32 s48, s45, 24576
  s_add_u32 s48, s48, 16384
  s_and_b32 s49, s2, 31
  s_lshl_b32 s49, s49, 8
  s_add_u32 s48, s48, s49
  v_mov_b32 v55, s48
  s_waitcnt vmcnt(18) lgkmcnt(0)
  s_barrier
  v_mov_b32 v6, 0
  v_mov_b32 v7, 0
  v_mov_b32 v8, 0
  v_mov_b32 v9, 0
  ds_read_b64 v[16:17], v56 offset:0
  ds_read_b64 v[18:19], v56 offset:256
  ds_read_b64 v[20:21], v56 offset:2048
  ds_read_b64 v[22:23], v56 offset:2304
  ds_read_b64 v[24:25], v56 offset:4096
  ds_read_b64 v[26:27], v56 offset:4352
  s_waitcnt vmcnt(17) lgkmcnt(4)
  v_mfma_f32_16x16x32_bf16 v[10:13], v[136:139], v[16:19], 0
  v_and_b32 v15, 0xffff, v16
  v_cmp_eq_u32 vcc, 0, v3
  s_nop 1
  v_cndmask_b32 v14, v16, v15, vcc
  v_dot2c_f32_bf16 v6, v14, v14
  v_dot2c_f32_bf16 v7, v17, v17
  v_dot2c_f32_bf16 v8, v18, v18
  v_dot2c_f32_bf16 v9, v19, v19
  ds_read_b64 v[16:17], v56 offset:6144
  ds_read_b64 v[18:19], v56 offset:6400
  s_waitcnt vmcnt(16) lgkmcnt(4)
  v_mfma_f32_16x16x32_bf16 v[10:13], v[140:143], v[20:23], v[10:13]
  v_dot2c_f32_bf16 v6, v20, v20
  v_dot2c_f32_bf16 v7, v21, v21
  v_dot2c_f32_bf16 v8, v22, v22
  v_dot2c_f32_bf16 v9, v23, v23
  ds_read_b64 v[20:21], v56 offset:8192
  ds_read_b64 v[22:23], v56 offset:8448
  s_waitcnt vmcnt(15) lgkmcnt(4)
  v_mfma_f32_16x16x32_bf16 v[10:13], v[144:147], v[24:27], v[10:13]
  v_dot2c_f32_bf16 v6, v24, v24
  v_dot2c_f32_bf16 v7, v25, v25
  v_dot2c_f32_bf16 v8, v26, v26
  v_dot2c_f32_bf16 v9, v27, v27
  ds_read_b64 v[24:25], v56 offset:10240
  ds_read_b64 v[26:27], v56 offset:10496
  s_waitcnt vmcnt(14) lgkmcnt(4)
  v_mfma_f32_16x16x32_bf16 v[10:13], v[148:151], v[16:19], v[10:13]
  v_dot2c_f32_bf16 v6, v16, v16
  v_dot2c_f32_bf16 v7, v17, v17
  v_dot2c_f32_bf16 v8, v18, v18
  v_dot2c_f32_bf16 v9, v19, v19
  ds_read_b64 v[16:17], v56 offset:12288
  ds_read_b64 v[18:19], v56 offset:12544
  s_waitcnt vmcnt(13) lgkmcnt(4)
  v_mfma_f32_16x16x32_bf16 v[10:13], v[152:155], v[20:23], v[10:13]
  v_dot2c_f32_bf16 v6, v20, v20
  v_dot2c_f32_bf16 v7, v21, v21
  v_dot2c_f32_bf16 v8, v22, v22
  v_dot2c_f32_bf16 v9, v23, v23
  ds_read_b64 v[20:21], v56 offset:14336
  ds_read_b64 v[22:23], v56 offset:14592
  s_waitcnt vmcnt(12) lgkmcnt(4)
  v_mfma_f32_16x16x32_bf16 v[10:13], v[156:159], v[24:27], v[10:13]
  v_dot2c_f32_bf16 v6, v24, v24
  v_dot2c_f32_bf16 v7, v25, v25
  v_dot2c_f32_bf16 v8, v26, v26
  v_dot2c_f32_bf16 v9, v27, v27
  ds_read_b64 v[24:25], v56 offset:16384
  ds_read_b64 v[26:27], v56 offset:16640
  s_waitcnt vmcnt(11) lgkmcnt(4)
  v_mfma_f32_16x16x32_bf16 v[10:13], v[160:163], v[16:19], v[10:13]
  v_dot2c_f32_bf16 v6, v16, v16
  v_dot2c_f32_bf16 v7, v17, v17
  v_dot2c_f32_bf16 v8, v18, v18
  v_dot2c_f32_bf16 v9, v19, v19
  ds_read_b64 v[16:17], v56 offset:18432
  ds_read_b64 v[18:19], v56 offset:18688
  s_waitcnt vmcnt(10) lgkmcnt(4)
  v_mfma_f32_16x16x32_bf16 v[10:13], v[164:167], v[20:23], v[10:13]
  v_dot2c_f32_bf16 v6, v20, v20
  v_dot2c_f32_bf16 v7, v21, v21
  v_dot2c_f32_bf16 v8, v22, v22
  v_dot2c_f32_bf16 v9, v23, v23
  ds_read_b64 v[20:21], v56 offset:20480
  ds_read_b64 v[22:23], v56 offset:20736
  s_waitcnt vmcnt(9) lgkmcnt(4)
  v_mfma_f32_16x16x32_bf16 v[10:13], v[168:171], v[24:27], v[10:13]
  v_dot2c_f32_bf16 v6, v24, v24
  v_dot2c_f32_bf16 v7, v25, v25
  v_dot2c_f32_bf16 v8, v26, v26
  v_dot2c_f32_bf16 v9, v27, v27
  ds_read_b64 v[24:25], v56 offset:22528
  ds_read_b64 v[26:27], v56 offset:22784
  s_waitcnt vmcnt(8) lgkmcnt(4)
  v_mfma_f32_16x16x32_bf16 v[10:13], v[172:175], v[16:19], v[10:13]
  v_dot2c_f32_bf16 v6, v16, v16
  v_dot2c_f32_bf16 v7, v17, v17
  v_dot2c_f32_bf16 v8, v18, v18
  v_dot2c_f32_bf16 v9, v19, v19
  ds_read_b64 v[16:17], v56 offset:24576
  ds_read_b64 v[18:19], v56 offset:24832
  s_waitcnt vmcnt(7) lgkmcnt(4)
  v_mfma_f32_16x16x32_bf16 v[10:13], v[176:179], v[20:23], v[10:13]
  v_dot2c_f32_bf16 v6, v20, v20
  v_dot2c_f32_bf16 v7, v21, v21
  v_dot2c_f32_bf16 v8, v22, v22
  v_dot2c_f32_bf16 v9, v23, v23
  ds_read_b64 v[20:21], v56 offset:26624
  ds_read_b64 v[22:23], v56 offset:26880
  s_waitcnt vmcnt(6) lgkmcnt(4)
  v_mfma_f32_16x16x32_bf16 v[10:13], v[180:183], v[24:27], v[10:13]
  v_dot2c_f32_bf16 v6, v24, v24
  v_dot2c_f32_bf16 v7, v25, v25
  v_dot2c_f32_bf16 v8, v26, v26
  v_dot2c_f32_bf16 v9, v27, v27
  ds_read_b64 v[24:25], v56 offset:28672
  ds_read_b64 v[26:27], v56 offset:28928
  s_waitcnt vmcnt(5) lgkmcnt(4)
  v_mfma_f32_16x16x32_bf16 v[10:13], v[184:187], v[16:19], v[10:13]
  v_dot2c_f32_bf16 v6, v16, v16
  v_dot2c_f32_bf16 v7, v17, v17
  v_dot2c_f32_bf16 v8, v18, v18
  v_dot2c_f32_bf16 v9, v19, v19
  ds_read_b64 v[16:17], v56 offset:30720
  ds_read_b64 v[18:19], v56 offset:30976
  s_waitcnt vmcnt(4) lgkmcnt(4)
  v_mfma_f32_16x16x32_bf16 v[10:13], v[188:191], v[20:23], v[10:13]
  v_dot2c_f32_bf16 v6, v20, v20
  v_dot2c_f32_bf16 v7, v21, v21
  v_dot2c_f32_bf16 v8, v22, v22
  v_dot2c_f32_bf16 v9, v23, v23
  ds_read_b64 v[20:21], v56 offset:32768
  ds_read_b64 v[22:23], v56 offset:33024
  s_waitcnt vmcnt(3) lgkmcnt(4)
  v_mfma_f32_16x16x32_bf16 v[10:13], v[192:195], v[24:27], v[10:13]
  v_dot2c_f32_bf16 v6, v24, v24
  v_dot2c_f32_bf16 v7, v25, v25
  v_dot2c_f32_bf16 v8, v26, v26
  v_dot2c_f32_bf16 v9, v27, v27
  ds_read_b64 v[24:25], v56 offset:34816
  ds_read_b64 v[26:27], v56 offset:35072
  s_waitcnt vmcnt(2) lgkmcnt(4)
  v_mfma_f32_16x16x32_bf16 v[10:13], v[196:199], v[16:19], v[10:13]
  v_dot2c_f32_bf16 v6, v16, v16
  v_dot2c_f32_bf16 v7, v17, v17
  v_dot2c_f32_bf16 v8, v18, v18
  v_dot2c_f32_bf16 v9, v19, v19
  s_waitcnt vmcnt(1) lgkmcnt(2)
  v_mfma_f32_16x16x32_bf16 v[10:13], v[200:203], v[20:23], v[10:13]
  v_dot2c_f32_bf16 v6, v20, v20
  v_dot2c_f32_bf16 v7, v21, v21
  v_dot2c_f32_bf16 v8, v22, v22
  v_dot2c_f32_bf16 v9, v23, v23
  s_waitcnt vmcnt(0) lgkmcnt(0)
  v_mfma_f32_16x16x32_bf16 v[10:13], v[204:207], v[24:27], v[10:13]
  v_dot2c_f32_bf16 v6, v24, v24
  v_dot2c_f32_bf16 v7, v25, v25
  v_dot2c_f32_bf16 v8, v26, v26
  v_dot2c_f32_bf16 v9, v27, v27
  s_cmp_eq_u32 s45, 0
  s_cbranch_scc1 L_kvnb_56
  s_barrier
L_kvnb_56:
  v_add_f32 v6, v6, v7
  v_add_f32 v9, v8, v9
  v_add_f32 v9, v6, v9
  v_mov_b32 v14, v9
  s_nop 1
  v_permlane16_swap_b32 v14, v9
  v_add_f32 v9, v9, v14
  v_mov_b32 v14, v9
  s_nop 1
  v_permlane32_swap_b32 v14, v9
  v_add_f32 v9, v9, v14
  v_mul_f32 v9, 0x3ae38e39, v9
  v_cvt_pk_bf16_f32 v14, v9, v9
  v_lshlrev_b32 v9, 16, v14
  v_add_f32 v9, 0x3727c5ac, v9
  v_cvt_pk_bf16_f32 v14, v9, v9
  v_lshlrev_b32 v9, 16, v14
  v_sqrt_f32 v9, v9
  s_nop 0
  v_cvt_pk_bf16_f32 v14, v9, v9
  v_lshlrev_b32 v9, 16, v14
  v_rcp_f32 v9, v9
  ds_write_b32 v62, v9
  v_mul_f32 v10, v10, v9
  v_mul_f32 v11, v11, v9
  v_mul_f32 v12, v12, v9
  v_mul_f32 v13, v13, v9
  v_cvt_pk_bf16_f32 v52, v10, v11
  v_cvt_pk_bf16_f32 v53, v12, v13
  s_bitcmp0_b32 s44, 0
  s_cbranch_scc1 L_kv_nv_57
  ds_write_b64 v63, v[52:53]
  s_waitcnt lgkmcnt(0)
  ds_read_b64_tr_b16 v[52:53], v54
  v_mov_b32 v6, 0x3f803f80
  s_waitcnt lgkmcnt(0)
  v_cndmask_b32 v52, v52, v6, s[82:83]
  v_cndmask_b32 v53, v53, v6, s[82:83]
L_kv_nv_57:
  s_mov_b64 exec, s[80:81]
  s_cmp_eq_u32 s44, 2
  s_cbranch_scc1 L_kvs2_58
  buffer_store_dwordx2 v[52:53], v61, s[28:31], s62 offen sc1
  s_branch L_kvsd_59
L_kvs2_58:
  buffer_store_dword v52, v61, s[28:31], s62 offen sc1
L_kvsd_59:
  v_mov_b32 v5, 1
  s_waitcnt vmcnt(0)
  s_mov_b64 exec, 1
  buffer_atomic_add v5, v55, s[28:31], 0 offen sc1
  s_mov_b64 exec, -1
  s_setprio 0
L_p2wd_52:
  s_cmp_lg_u32 s79, 0
  s_cbranch_scc1 L_havewq_60
  v_lshlrev_b32 v60, 4, v1
  s_mul_i32 s57, s44, 9
  s_add_u32 s57, s57, s26
  s_mul_i32 s57, s57, 18432
  s_add_u32 s57, s57, 11993088
  s_add_u32 s49, s57, 0
  buffer_load_dwordx4 v[64:67], v60, s[28:31], s49 offen sc1
  buffer_load_dwordx4 v[68:71], v60, s[28:31], s49 offen offset:1024 sc1
  buffer_load_dwordx4 v[72:75], v60, s[28:31], s49 offen offset:2048 sc1
  buffer_load_dwordx4 v[76:79], v60, s[28:31], s49 offen offset:3072 sc1
  s_add_u32 s49, s57, 4096
  buffer_load_dwordx4 v[80:83], v60, s[28:31], s49 offen sc1
  buffer_load_dwordx4 v[84:87], v60, s[28:31], s49 offen offset:1024 sc1
  buffer_load_dwordx4 v[88:91], v60, s[28:31], s49 offen offset:2048 sc1
  buffer_load_dwordx4 v[92:95], v60, s[28:31], s49 offen offset:3072 sc1
  s_add_u32 s49, s57, 8192
  buffer_load_dwordx4 v[96:99], v60, s[28:31], s49 offen sc1
  buffer_load_dwordx4 v[100:103], v60, s[28:31], s49 offen offset:1024 sc1
  buffer_load_dwordx4 v[104:107], v60, s[28:31], s49 offen offset:2048 sc1
  buffer_load_dwordx4 v[108:111], v60, s[28:31], s49 offen offset:3072 sc1
  s_add_u32 s49, s57, 12288
  buffer_load_dwordx4 v[112:115], v60, s[28:31], s49 offen sc1
  buffer_load_dwordx4 v[116:119], v60, s[28:31], s49 offen offset:1024 sc1
  buffer_load_dwordx4 v[120:123], v60, s[28:31], s49 offen offset:2048 sc1
  buffer_load_dwordx4 v[124:127], v60, s[28:31], s49 offen offset:3072 sc1
  s_add_u32 s49, s57, 16384
  buffer_load_dwordx4 v[128:131], v60, s[28:31], s49 offen sc1
  buffer_load_dwordx4 v[132:135], v60, s[28:31], s49 offen offset:1024 sc1
L_havewq_60:
  s_cmp_ge_u32 s26, 2
  s_cbranch_scc1 L_wqnx_61
  v_lshlrev_b32 v60, 4, v1
  s_mul_i32 s57, s44, 9
  s_add_u32 s57, s57, 8
  s_mul_i32 s57, s57, 18432
  s_add_u32 s57, s57, 11993088
  s_add_u32 s49, s57, 0
  buffer_load_dwordx4 v[136:139], v60, s[28:31], s49 offen sc1
  buffer_load_dwordx4 v[140:143], v60, s[28:31], s49 offen offset:1024 sc1
  buffer_load_dwordx4 v[144:147], v60, s[28:31], s49 offen offset:2048 sc1
  buffer_load_dwordx4 v[148:151], v60, s[28:31], s49 offen offset:3072 sc1
  s_add_u32 s49, s57, 4096
  buffer_load_dwordx4 v[152:155], v60, s[28:31], s49 offen sc1
  buffer_load_dwordx4 v[156:159], v60, s[28:31], s49 offen offset:1024 sc1
  buffer_load_dwordx4 v[160:163], v60, s[28:31], s49 offen offset:2048 sc1
  buffer_load_dwordx4 v[164:167], v60, s[28:31], s49 offen offset:3072 sc1
  s_add_u32 s49, s57, 8192
  buffer_load_dwordx4 v[168:171], v60, s[28:31], s49 offen sc1
  buffer_load_dwordx4 v[172:175], v60, s[28:31], s49 offen offset:1024 sc1
  buffer_load_dwordx4 v[176:179], v60, s[28:31], s49 offen offset:2048 sc1
  buffer_load_dwordx4 v[180:183], v60, s[28:31], s49 offen offset:3072 sc1
  s_add_u32 s49, s57, 12288
  buffer_load_dwordx4 v[184:187], v60, s[28:31], s49 offen sc1
  buffer_load_dwordx4 v[188:191], v60, s[28:31], s49 offen offset:1024 sc1
  buffer_load_dwordx4 v[192:195], v60, s[28:31], s49 offen offset:2048 sc1
  buffer_load_dwordx4 v[196:199], v60, s[28:31], s49 offen offset:3072 sc1
  s_add_u32 s49, s57, 16384
  buffer_load_dwordx4 v[200:203], v60, s[28:31], s49 offen sc1
  buffer_load_dwordx4 v[204:207], v60, s[28:31], s49 offen offset:1024 sc1
L_wqnx_61:
  s_cmp_ge_u32 s26, 6
  s_cbranch_scc1 L_p2nb_62
  s_cmp_eq_u32 s45, 0
  s_cbranch_scc1 L_p2nb_62
  s_barrier
L_p2nb_62:
  s_cmp_ge_u32 s26, 2
  s_cbranch_scc1 L_g_noex_63
  ds_read_b64 v[16:17], v56 offset:0
  ds_read_b64 v[18:19], v56 offset:256
  ds_read_b64 v[20:21], v57 offset:0
  ds_read_b64 v[22:23], v57 offset:256
  ds_read_b64 v[24:25], v56 offset:2048
  ds_read_b64 v[26:27], v56 offset:2304
  ds_read_b64 v[28:29], v57 offset:2048
  ds_read_b64 v[30:31], v57 offset:2304
  s_waitcnt vmcnt(17) lgkmcnt(6)
  v_mfma_f32_16x16x32_bf16 v[40:43], v[64:67], v[16:19], 0
  ds_read_b64 v[32:33], v56 offset:4096
  ds_read_b64 v[34:35], v56 offset:4352
  v_mfma_f32_16x16x32_bf16 v[48:51], v[136:139], v[16:19], 0
  s_waitcnt lgkmcnt(6)
  v_mfma_f32_16x16x32_bf16 v[44:47], v[64:67], v[20:23], 0
  ds_read_b64 v[36:37], v57 offset:4096
  ds_read_b64 v[38:39], v57 offset:4352
  s_waitcnt vmcnt(16) lgkmcnt(6)
  v_mfma_f32_16x16x32_bf16 v[40:43], v[68:71], v[24:27], v[40:43]
  ds_read_b64 v[16:17], v56 offset:6144
  ds_read_b64 v[18:19], v56 offset:6400
  v_mfma_f32_16x16x32_bf16 v[48:51], v[140:143], v[24:27], v[48:51]
  s_waitcnt lgkmcnt(6)
  v_mfma_f32_16x16x32_bf16 v[44:47], v[68:71], v[28:31], v[44:47]
  ds_read_b64 v[20:21], v57 offset:6144
  ds_read_b64 v[22:23], v57 offset:6400
  s_waitcnt vmcnt(15) lgkmcnt(6)
  v_mfma_f32_16x16x32_bf16 v[40:43], v[72:75], v[32:35], v[40:43]
  ds_read_b64 v[24:25], v56 offset:8192
  ds_read_b64 v[26:27], v56 offset:8448
  v_mfma_f32_16x16x32_bf16 v[48:51], v[144:147], v[32:35], v[48:51]
  s_waitcnt lgkmcnt(6)
  v_mfma_f32_16x16x32_bf16 v[44:47], v[72:75], v[36:39], v[44:47]
  ds_read_b64 v[28:29], v57 offset:8192
  ds_read_b64 v[30:31], v57 offset:8448
  s_waitcnt vmcnt(14) lgkmcnt(6)
  v_mfma_f32_16x16x32_bf16 v[40:43], v[76:79], v[16:19], v[40:43]
  ds_read_b64 v[32:33], v56 offset:10240
  ds_read_b64 v[34:35], v56 offset:10496
  v_mfma_f32_16x16x32_bf16 v[48:51], v[148:151], v[16:19], v[48:51]
  s_waitcnt lgkmcnt(6)
  v_mfma_f32_16x16x32_bf16 v[44:47], v[76:79], v[20:23], v[44:47]
  ds_read_b64 v[36:37], v57 offset:10240
  ds_read_b64 v[38:39], v57 offset:10496
  s_waitcnt vmcnt(13) lgkmcnt(6)
  v_mfma_f32_16x16x32_bf16 v[40:43], v[80:83], v[24:27], v[40:43]
  ds_read_b64 v[16:17], v56 offset:12288
  ds_read_b64 v[18:19], v56 offset:12544
  v_mfma_f32_16x16x32_bf16 v[48:51], v[152:155], v[24:27], v[48:51]
  s_waitcnt lgkmcnt(6)
  v_mfma_f32_16x16x32_bf16 v[44:47], v[80:83], v[28:31], v[44:47]
  ds_read_b64 v[20:21], v57 offset:12288
  ds_read_b64 v[22:23], v57 offset:12544
  s_waitcnt vmcnt(12) lgkmcnt(6)
  v_mfma_f32_16x16x32_bf16 v[40:43], v[84:87], v[32:35], v[40:43]
  ds_read_b64 v[24:25], v56 offset:14336
  ds_read_b64 v[26:27], v56 offset:14592
  v_mfma_f32_16x16x32_bf16 v[48:51], v[156:159], v[32:35], v[48:51]
  s_waitcnt lgkmcnt(6)
  v_mfma_f32_16x16x32_bf16 v[44:47], v[84:87], v[36:39], v[44:47]
  ds_read_b64 v[28:29], v57 offset:14336
  ds_read_b64 v[30:31], v57 offset:14592
  s_waitcnt vmcnt(11) lgkmcnt(6)
  v_mfma_f32_16x16x32_bf16 v[40:43], v[88:91], v[16:19], v[40:43]
  ds_read_b64 v[32:33], v56 offset:16384
  ds_read_b64 v[34:35], v56 offset:16640
  v_mfma_f32_16x16x32_bf16 v[48:51], v[160:163], v[16:19], v[48:51]
  s_waitcnt lgkmcnt(6)
  v_mfma_f32_16x16x32_bf16 v[44:47], v[88:91], v[20:23], v[44:47]
  ds_read_b64 v[36:37], v57 offset:16384
  ds_read_b64 v[38:39], v57 offset:16640
  s_waitcnt vmcnt(10) lgkmcnt(6)
  v_mfma_f32_16x16x32_bf16 v[40:43], v[92:95], v[24:27], v[40:43]
  ds_read_b64 v[16:17], v56 offset:18432
  ds_read_b64 v[18:19], v56 offset:18688
  v_mfma_f32_16x16x32_bf16 v[48:51], v[164:167], v[24:27], v[48:51]
  s_waitcnt lgkmcnt(6)
  v_mfma_f32_16x16x32_bf16 v[44:47], v[92:95], v[28:31], v[44:47]
  ds_read_b64 v[20:21], v57 offset:18432
  ds_read_b64 v[22:23], v57 offset:18688
  s_waitcnt vmcnt(9) lgkmcnt(6)
  v_mfma_f32_16x16x32_bf16 v[40:43], v[96:99], v[32:35], v[40:43]
  ds_read_b64 v[24:25], v56 offset:20480
  ds_read_b64 v[26:27], v56 offset:20736
  v_mfma_f32_16x16x32_bf16 v[48:51], v[168:171], v[32:35], v[48:51]
  s_waitcnt lgkmcnt(6)
  v_mfma_f32_16x16x32_bf16 v[44:47], v[96:99], v[36:39], v[44:47]
  ds_read_b64 v[28:29], v57 offset:20480
  ds_read_b64 v[30:31], v57 offset:20736
  s_waitcnt vmcnt(8) lgkmcnt(6)
  v_mfma_f32_16x16x32_bf16 v[40:43], v[100:103], v[16:19], v[40:43]
  ds_read_b64 v[32:33], v56 offset:22528
  ds_read_b64 v[34:35], v56 offset:22784
  v_mfma_f32_16x16x32_bf16 v[48:51], v[172:175], v[16:19], v[48:51]
  s_waitcnt lgkmcnt(6)
  v_mfma_f32_16x16x32_bf16 v[44:47], v[100:103], v[20:23], v[44:47]
  ds_read_b64 v[36:37], v57 offset:22528
  ds_read_b64 v[38:39], v57 offset:22784
  s_waitcnt vmcnt(7) lgkmcnt(6)
  v_mfma_f32_16x16x32_bf16 v[40:43], v[104:107], v[24:27], v[40:43]
  ds_read_b64 v[16:17], v56 offset:24576
  ds_read_b64 v[18:19], v56 offset:24832
  v_mfma_f32_16x16x32_bf16 v[48:51], v[176:179], v[24:27], v[48:51]
  s_waitcnt lgkmcnt(6)
  v_mfma_f32_16x16x32_bf16 v[44:47], v[104:107], v[28:31], v[44:47]
  ds_read_b64 v[20:21], v57 offset:24576
  ds_read_b64 v[22:23], v57 offset:24832
  s_waitcnt vmcnt(6) lgkmcnt(6)
  v_mfma_f32_16x16x32_bf16 v[40:43], v[108:111], v[32:35], v[40:43]
  ds_read_b64 v[24:25], v56 offset:26624
  ds_read_b64 v[26:27], v56 offset:26880
  v_mfma_f32_16x16x32_bf16 v[48:51], v[180:183], v[32:35], v[48:51]
  s_waitcnt lgkmcnt(6)
  v_mfma_f32_16x16x32_bf16 v[44:47], v[108:111], v[36:39], v[44:47]
  ds_read_b64 v[28:29], v57 offset:26624
  ds_read_b64 v[30:31], v57 offset:26880
  s_waitcnt vmcnt(5) lgkmcnt(6)
  v_mfma_f32_16x16x32_bf16 v[40:43], v[112:115], v[16:19], v[40:43]
  ds_read_b64 v[32:33], v56 offset:28672
  ds_read_b64 v[34:35], v56 offset:28928
  v_mfma_f32_16x16x32_bf16 v[48:51], v[184:187], v[16:19], v[48:51]
  s_waitcnt lgkmcnt(6)
  v_mfma_f32_16x16x32_bf16 v[44:47], v[112:115], v[20:23], v[44:47]
  ds_read_b64 v[36:37], v57 offset:28672
  ds_read_b64 v[38:39], v57 offset:28928
  s_waitcnt vmcnt(4) lgkmcnt(6)
  v_mfma_f32_16x16x32_bf16 v[40:43], v[116:119], v[24:27], v[40:43]
  ds_read_b64 v[16:17], v56 offset:30720
  ds_read_b64 v[18:19], v56 offset:30976
  v_mfma_f32_16x16x32_bf16 v[48:51], v[188:191], v[24:27], v[48:51]
  s_waitcnt lgkmcnt(6)
  v_mfma_f32_16x16x32_bf16 v[44:47], v[116:119], v[28:31], v[44:47]
  ds_read_b64 v[20:21], v57 offset:30720
  ds_read_b64 v[22:23], v57 offset:30976
  s_waitcnt vmcnt(3) lgkmcnt(6)
  v_mfma_f32_16x16x32_bf16 v[40:43], v[120:123], v[32:35], v[40:43]
  ds_read_b64 v[24:25], v56 offset:32768
  ds_read_b64 v[26:27], v56 offset:33024
  v_mfma_f32_16x16x32_bf16 v[48:51], v[192:195], v[32:35], v[48:51]
  s_waitcnt lgkmcnt(6)
  v_mfma_f32_16x16x32_bf16 v[44:47], v[120:123], v[36:39], v[44:47]
  ds_read_b64 v[28:29], v57 offset:32768
  ds_read_b64 v[30:31], v57 offset:33024
  s_waitcnt vmcnt(2) lgkmcnt(6)
  v_mfma_f32_16x16x32_bf16 v[40:43], v[124:127], v[16:19], v[40:43]
  ds_read_b64 v[32:33], v56 offset:34816
  ds_read_b64 v[34:35], v56 offset:35072
  v_mfma_f32_16x16x32_bf16 v[48:51], v[196:199], v[16:19], v[48:51]
  s_waitcnt lgkmcnt(6)
  v_mfma_f32_16x16x32_bf16 v[44:47], v[124:127], v[20:23], v[44:47]
  ds_read_b64 v[36:37], v57 offset:34816
  ds_read_b64 v[38:39], v57 offset:35072
  s_waitcnt vmcnt(1) lgkmcnt(6)
  v_mfma_f32_16x16x32_bf16 v[40:43], v[128:131], v[24:27], v[40:43]
  v_mfma_f32_16x16x32_bf16 v[48:51], v[200:203], v[24:27], v[48:51]
  s_waitcnt lgkmcnt(4)
  v_mfma_f32_16x16x32_bf16 v[44:47], v[128:131], v[28:31], v[44:47]
  s_waitcnt vmcnt(0) lgkmcnt(2)
  v_mfma_f32_16x16x32_bf16 v[40:43], v[132:135], v[32:35], v[40:43]
  v_mfma_f32_16x16x32_bf16 v[48:51], v[204:207], v[32:35], v[48:51]
  s_waitcnt lgkmcnt(0)
  v_mfma_f32_16x16x32_bf16 v[44:47], v[132:135], v[36:39], v[44:47]
  s_branch L_g_done_64
L_g_noex_63:
  ds_read_b64 v[16:17], v56 offset:0
  ds_read_b64 v[18:19], v56 offset:256
  ds_read_b64 v[20:21], v57 offset:0
  ds_read_b64 v[22:23], v57 offset:256
  ds_read_b64 v[24:25], v56 offset:2048
  ds_read_b64 v[26:27], v56 offset:2304
  ds_read_b64 v[28:29], v57 offset:2048
  ds_read_b64 v[30:31], v57 offset:2304
  s_waitcnt vmcnt(17) lgkmcnt(6)
  v_mfma_f32_16x16x32_bf16 v[40:43], v[64:67], v[16:19], 0
  ds_read_b64 v[32:33], v56 offset:4096
  ds_read_b64 v[34:35], v56 offset:4352
  s_waitcnt lgkmcnt(6)
  v_mfma_f32_16x16x32_bf16 v[44:47], v[64:67], v[20:23], 0
  ds_read_b64 v[36:37], v57 offset:4096
  ds_read_b64 v[38:39], v57 offset:4352
  s_waitcnt vmcnt(16) lgkmcnt(6)
  v_mfma_f32_16x16x32_bf16 v[40:43], v[68:71], v[24:27], v[40:43]
  ds_read_b64 v[16:17], v56 offset:6144
  ds_read_b64 v[18:19], v56 offset:6400
  s_waitcnt lgkmcnt(6)
  v_mfma_f32_16x16x32_bf16 v[44:47], v[68:71], v[28:31], v[44:47]
  ds_read_b64 v[20:21], v57 offset:6144
  ds_read_b64 v[22:23], v57 offset:6400
  s_waitcnt vmcnt(15) lgkmcnt(6)
  v_mfma_f32_16x16x32_bf16 v[40:43], v[72:75], v[32:35], v[40:43]
  ds_read_b64 v[24:25], v56 offset:8192
  ds_read_b64 v[26:27], v56 offset:8448
  s_waitcnt lgkmcnt(6)
  v_mfma_f32_16x16x32_bf16 v[44:47], v[72:75], v[36:39], v[44:47]
  ds_read_b64 v[28:29], v57 offset:8192
  ds_read_b64 v[30:31], v57 offset:8448
  s_waitcnt vmcnt(14) lgkmcnt(6)
  v_mfma_f32_16x16x32_bf16 v[40:43], v[76:79], v[16:19], v[40:43]
  ds_read_b64 v[32:33], v56 offset:10240
  ds_read_b64 v[34:35], v56 offset:10496
  s_waitcnt lgkmcnt(6)
  v_mfma_f32_16x16x32_bf16 v[44:47], v[76:79], v[20:23], v[44:47]
  ds_read_b64 v[36:37], v57 offset:10240
  ds_read_b64 v[38:39], v57 offset:10496
  s_waitcnt vmcnt(13) lgkmcnt(6)
  v_mfma_f32_16x16x32_bf16 v[40:43], v[80:83], v[24:27], v[40:43]
  ds_read_b64 v[16:17], v56 offset:12288
  ds_read_b64 v[18:19], v56 offset:12544
  s_waitcnt lgkmcnt(6)
  v_mfma_f32_16x16x32_bf16 v[44:47], v[80:83], v[28:31], v[44:47]
  ds_read_b64 v[20:21], v57 offset:12288
  ds_read_b64 v[22:23], v57 offset:12544
  s_waitcnt vmcnt(12) lgkmcnt(6)
  v_mfma_f32_16x16x32_bf16 v[40:43], v[84:87], v[32:35], v[40:43]
  ds_read_b64 v[24:25], v56 offset:14336
  ds_read_b64 v[26:27], v56 offset:14592
  s_waitcnt lgkmcnt(6)
  v_mfma_f32_16x16x32_bf16 v[44:47], v[84:87], v[36:39], v[44:47]
  ds_read_b64 v[28:29], v57 offset:14336
  ds_read_b64 v[30:31], v57 offset:14592
  s_waitcnt vmcnt(11) lgkmcnt(6)
  v_mfma_f32_16x16x32_bf16 v[40:43], v[88:91], v[16:19], v[40:43]
  ds_read_b64 v[32:33], v56 offset:16384
  ds_read_b64 v[34:35], v56 offset:16640
  s_waitcnt lgkmcnt(6)
  v_mfma_f32_16x16x32_bf16 v[44:47], v[88:91], v[20:23], v[44:47]
  ds_read_b64 v[36:37], v57 offset:16384
  ds_read_b64 v[38:39], v57 offset:16640
  s_waitcnt vmcnt(10) lgkmcnt(6)
  v_mfma_f32_16x16x32_bf16 v[40:43], v[92:95], v[24:27], v[40:43]
  ds_read_b64 v[16:17], v56 offset:18432
  ds_read_b64 v[18:19], v56 offset:18688
  s_waitcnt lgkmcnt(6)
  v_mfma_f32_16x16x32_bf16 v[44:47], v[92:95], v[28:31], v[44:47]
  ds_read_b64 v[20:21], v57 offset:18432
  ds_read_b64 v[22:23], v57 offset:18688
  s_waitcnt vmcnt(9) lgkmcnt(6)
  v_mfma_f32_16x16x32_bf16 v[40:43], v[96:99], v[32:35], v[40:43]
  ds_read_b64 v[24:25], v56 offset:20480
  ds_read_b64 v[26:27], v56 offset:20736
  s_waitcnt lgkmcnt(6)
  v_mfma_f32_16x16x32_bf16 v[44:47], v[96:99], v[36:39], v[44:47]
  ds_read_b64 v[28:29], v57 offset:20480
  ds_read_b64 v[30:31], v57 offset:20736
  s_waitcnt vmcnt(8) lgkmcnt(6)
  v_mfma_f32_16x16x32_bf16 v[40:43], v[100:103], v[16:19], v[40:43]
  ds_read_b64 v[32:33], v56 offset:22528
  ds_read_b64 v[34:35], v56 offset:22784
  s_waitcnt lgkmcnt(6)
  v_mfma_f32_16x16x32_bf16 v[44:47], v[100:103], v[20:23], v[44:47]
  ds_read_b64 v[36:37], v57 offset:22528
  ds_read_b64 v[38:39], v57 offset:22784
  s_waitcnt vmcnt(7) lgkmcnt(6)
  v_mfma_f32_16x16x32_bf16 v[40:43], v[104:107], v[24:27], v[40:43]
  ds_read_b64 v[16:17], v56 offset:24576
  ds_read_b64 v[18:19], v56 offset:24832
  s_waitcnt lgkmcnt(6)
  v_mfma_f32_16x16x32_bf16 v[44:47], v[104:107], v[28:31], v[44:47]
  ds_read_b64 v[20:21], v57 offset:24576
  ds_read_b64 v[22:23], v57 offset:24832
  s_waitcnt vmcnt(6) lgkmcnt(6)
  v_mfma_f32_16x16x32_bf16 v[40:43], v[108:111], v[32:35], v[40:43]
  ds_read_b64 v[24:25], v56 offset:26624
  ds_read_b64 v[26:27], v56 offset:26880
  s_waitcnt lgkmcnt(6)
  v_mfma_f32_16x16x32_bf16 v[44:47], v[108:111], v[36:39], v[44:47]
  ds_read_b64 v[28:29], v57 offset:26624
  ds_read_b64 v[30:31], v57 offset:26880
  s_waitcnt vmcnt(5) lgkmcnt(6)
  v_mfma_f32_16x16x32_bf16 v[40:43], v[112:115], v[16:19], v[40:43]
  ds_read_b64 v[32:33], v56 offset:28672
  ds_read_b64 v[34:35], v56 offset:28928
  s_waitcnt lgkmcnt(6)
  v_mfma_f32_16x16x32_bf16 v[44:47], v[112:115], v[20:23], v[44:47]
  ds_read_b64 v[36:37], v57 offset:28672
  ds_read_b64 v[38:39], v57 offset:28928
  s_waitcnt vmcnt(4) lgkmcnt(6)
  v_mfma_f32_16x16x32_bf16 v[40:43], v[116:119], v[24:27], v[40:43]
  ds_read_b64 v[16:17], v56 offset:30720
  ds_read_b64 v[18:19], v56 offset:30976
  s_waitcnt lgkmcnt(6)
  v_mfma_f32_16x16x32_bf16 v[44:47], v[116:119], v[28:31], v[44:47]
  ds_read_b64 v[20:21], v57 offset:30720
  ds_read_b64 v[22:23], v57 offset:30976
  s_waitcnt vmcnt(3) lgkmcnt(6)
  v_mfma_f32_16x16x32_bf16 v[40:43], v[120:123], v[32:35], v[40:43]
  ds_read_b64 v[24:25], v56 offset:32768
  ds_read_b64 v[26:27], v56 offset:33024
  s_waitcnt lgkmcnt(6)
  v_mfma_f32_16x16x32_bf16 v[44:47], v[120:123], v[36:39], v[44:47]
  ds_read_b64 v[28:29], v57 offset:32768
  ds_read_b64 v[30:31], v57 offset:33024
  s_waitcnt vmcnt(2) lgkmcnt(6)
  v_mfma_f32_16x16x32_bf16 v[40:43], v[124:127], v[16:19], v[40:43]
  ds_read_b64 v[32:33], v56 offset:34816
  ds_read_b64 v[34:35], v56 offset:35072
  s_waitcnt lgkmcnt(6)
  v_mfma_f32_16x16x32_bf16 v[44:47], v[124:127], v[20:23], v[44:47]
  ds_read_b64 v[36:37], v57 offset:34816
  ds_read_b64 v[38:39], v57 offset:35072
  s_waitcnt vmcnt(1) lgkmcnt(6)
  v_mfma_f32_16x16x32_bf16 v[40:43], v[128:131], v[24:27], v[40:43]
  s_waitcnt lgkmcnt(4)
  v_mfma_f32_16x16x32_bf16 v[44:47], v[128:131], v[28:31], v[44:47]
  s_waitcnt vmcnt(0) lgkmcnt(2)
  v_mfma_f32_16x16x32_bf16 v[40:43], v[132:135], v[32:35], v[40:43]
  s_waitcnt lgkmcnt(0)
  v_mfma_f32_16x16x32_bf16 v[44:47], v[132:135], v[36:39], v[44:47]
L_g_done_64:
  s_mov_b32 s79, 0
  s_waitcnt lgkmcnt(0)
  s_barrier
  s_and_b32 s50, s26, 1
  s_lshl_b32 s50, s50, 6
  s_add_u32 s50, s50, 161792
  v_lshlrev_b32 v4, 2, v2
  v_add_u32 v4, s50, v4
  v_xor_b32 v5, 64, v4
  ds_read_b32 v58, v4
  ds_read_b32 v59, v5
  s_waitcnt lgkmcnt(0)
  v_mul_f32 v58, 0x3eae1a93, v58
  v_mul_f32 v59, 0x3eae1a93, v59
  s_and_b32 s50, s26, 1
  s_lshl_b32 s51, s50, 4
  v_add_u32 v4, s51, v2
  v_xor_b32 v5, 16, v4
  v_mul_u32_u24 v4, 296, v4
  v_mul_u32_u24 v5, 296, v5
  v_lshlrev_b32 v6, 3, v3
  v_add_u32 v6, 151552, v6
  v_add_u32 v4, v4, v6
  v_add_u32 v5, v5, v6
  s_lshl_b32 s52, s26, 5
  v_add_u32 v7, s52, v4
  v_add_u32 v8, s52, v5
  v_mul_f32 v40, v40, v58
  v_mul_f32 v44, v44, v59
  v_mul_f32 v41, v41, v58
  v_mul_f32 v45, v45, v59
  v_mul_f32 v42, v42, v58
  v_mul_f32 v46, v46, v59
  v_mul_f32 v43, v43, v58
  v_mul_f32 v47, v47, v59
  v_cvt_pk_bf16_f32 v10, v40, v41
  v_cvt_pk_bf16_f32 v11, v42, v43
  v_cvt_pk_bf16_f32 v12, v44, v45
  v_cvt_pk_bf16_f32 v13, v46, v47
  ds_write_b64 v7, v[10:11]
  ds_write_b64 v8, v[12:13]
  s_cmp_ge_u32 s26, 2
  s_cbranch_scc1 L_qs_nx_65
  v_mul_f32 v48, v48, v58
  v_mul_f32 v49, v49, v58
  v_mul_f32 v50, v50, v58
  v_mul_f32 v51, v51, v58
  v_cvt_pk_bf16_f32 v14, v48, v49
  v_cvt_pk_bf16_f32 v15, v50, v51
  ds_write_b64 v4, v[14:15] offset:256
L_qs_nx_65:
  s_cmp_lg_u32 s26, 7
  s_cbranch_scc1 L_epoll_66
  s_mul_i32 s48, s45, 24576
  s_add_u32 s48, s48, 16384
  v_and_b32 v4, 31, v1
  v_lshlrev_b32 v4, 8, v4
  v_add_u32 v4, s48, v4
  buffer_load_dword v250, v4, s[28:31], 0 offen sc1
L_epoll_66:
  s_cmp_lg_u32 s45, 0
  s_cbranch_scc1 L_resdone_67
  s_mul_i32 s50, s44, 36
  s_lshl_b32 s51, s26, 2
  s_add_u32 s51, s51, s50
  s_lshl_b32 s51, s51, 8
  s_add_u32 s51, s51, 113664
  s_add_u32 s52, s50, 32
  s_lshl_b32 s52, s52, 8
  s_add_u32 s52, s52, 113664
  s_and_b32 s53, s26, 1
  v_lshrrev_b32 v4, 1, v3
  v_xor_b32 v5, s53, v4
  v_lshlrev_b32 v6, 8, v3
  v_lshl_add_u32 v6, v2, 3, v6
  v_lshl_add_u32 v7, v5, 7, v6
  v_xor_b32 v8, 128, v7
  v_add_u32 v9, s51, v7
  v_add_u32 v10, s51, v8
  v_add_u32 v11, s52, v7
  ds_read_b64 v[244:245], v9
  ds_read_b64 v[246:247], v10
  ds_read_b64 v[248:249], v11
L_resdone_67:
  s_waitcnt lgkmcnt(0)
  s_barrier
  s_and_b32 s50, s26, 3
  s_mul_i32 s50, s50, 72
  s_add_u32 s50, s50, 151552
  v_and_b32 v4, 31, v1
  v_mul_u32_u24 v4, 296, v4
  v_add_u32 v4, s50, v4
  v_lshrrev_b32 v5, 5, v1
  v_lshl_add_u32 v5, v5, 4, v4
  ds_read2_b32 v[184:185], v5 offset0:0 offset1:1
  ds_read2_b32 v[186:187], v5 offset0:2 offset1:3
  ds_read2_b32 v[192:193], v5 offset0:9 offset1:10
  ds_read2_b32 v[194:195], v5 offset0:11 offset1:12
  ds_read_b32 v188, v4 offset:32
  ds_read_b32 v196, v4 offset:68
  v_cmp_gt_u32 vcc, 32, v1
  v_mov_b32 v6, 0
  s_waitcnt lgkmcnt(0)
  v_cndmask_b32 v188, v6, v188, vcc
  v_cndmask_b32 v196, v6, v196, vcc
  s_mov_b32 s76, 0
L_redo:
  v_lshlrev_b32 v201, 4, v1
  s_lshl_b32 s84, s26, 10
  s_add_u32 s85, s84, s73
  s_cmp_lg_u32 s26, 7
  s_cbranch_scc1 L_wdone_68
  s_mul_i32 s48, s45, 24576
  s_add_u32 s48, s48, 16384
  v_and_b32 v4, 31, v1
  v_lshlrev_b32 v4, 8, v4
  v_add_u32 v4, s48, v4
  s_waitcnt vmcnt(0)
  v_cmp_gt_u32 vcc, 16, v250
  s_nop 4
  s_cbranch_vccz L_wdone_68
  s_mov_b32 s48, 0
  s_setprio 3
  s_sleep 4
L_poll_69:
  buffer_load_dword v5, v4, s[28:31], 0 offen sc1
  s_waitcnt vmcnt(0)
  v_cmp_gt_u32 vcc, 16, v5
  s_add_u32 s48, s48, 1
  s_cmp_gt_u32 s48, 60000
  s_cbranch_scc1 L_wdone_68
  s_nop 1
  s_cbranch_vccz L_wdone_68
  s_sleep 4
  s_branch L_poll_69
L_wdone_68:
  s_setprio 0
  s_barrier
  s_add_u32 m0, s84, 0
  s_add_u32 s50, s85, 0
  buffer_load_dwordx4 v201, s[28:31], s50 offen sc1 lds
  s_add_u32 m0, s84, 8192
  s_add_u32 s50, s85, 8192
  buffer_load_dwordx4 v201, s[28:31], s50 offen sc1 lds
  s_add_u32 m0, s84, 16384
  s_add_u32 s50, s85, 16384
  buffer_load_dwordx4 v201, s[28:31], s50 offen sc1 lds
  s_mov_b32 s82, 0x7ffff
  s_mov_b32 s83, 0x7ffff
  s_lshr_b32 s51, s26, 2
  s_lshl_b32 s52, s51, 12
  v_add_u32 v198, s52, v201
  s_lshl_b32 s52, s51, 9
  s_add_u32 s52, s52, 8192
  v_and_b32 v5, 31, v1
  v_lshlrev_b32 v199, 2, v5
  v_add_u32 v199, s52, v199
  s_mul_i32 s52, s51, 4864
  s_add_u32 s52, s52, 9216
  v_subrev_u32 v6, 16, v5
  v_cmp_gt_u32 vcc, 19, v5
  s_nop 1
  v_cndmask_b32 v6, v6, v5, vcc
  v_lshrrev_b32 v7, 5, v1
  v_mul_u32_u24 v7, 304, v7
  v_lshl_add_u32 v7, v6, 4, v7
  v_add_u32 v200, s52, v7
  v_mov_b32 v173, 0x3f803f80
  v_mov_b32 v189, 0
  v_mov_b32 v197, 0
  v_mov_b32 v48, 0
  v_mov_b32 v136, 0
  v_mov_b32 v49, 0
  v_mov_b32 v137, 0
  v_mov_b32 v50, 0
  v_mov_b32 v138, 0
  v_mov_b32 v51, 0
  v_mov_b32 v139, 0
  v_mov_b32 v52, 0
  v_mov_b32 v140, 0
  v_mov_b32 v53, 0
  v_mov_b32 v141, 0
  v_mov_b32 v54, 0
  v_mov_b32 v142, 0
  v_mov_b32 v55, 0
  v_mov_b32 v143, 0
  v_mov_b32 v56, 0
  v_mov_b32 v144, 0
  v_mov_b32 v57, 0
  v_mov_b32 v145, 0
  v_mov_b32 v58, 0
  v_mov_b32 v146, 0
  v_mov_b32 v59, 0
  v_mov_b32 v147, 0
  v_mov_b32 v60, 0
  v_mov_b32 v148, 0
  v_mov_b32 v61, 0
  v_mov_b32 v149, 0
  v_mov_b32 v62, 0
  v_mov_b32 v150, 0
  v_mov_b32 v63, 0
  v_mov_b32 v151, 0
  v_mov_b32 v160, 0
  v_mov_b32 v176, 0
  v_mov_b32 v161, 0
  v_mov_b32 v177, 0
  v_mov_b32 v162, 0
  v_mov_b32 v178, 0
  v_mov_b32 v163, 0
  v_mov_b32 v179, 0
  v_mov_b32 v164, 0
  v_mov_b32 v180, 0
  v_mov_b32 v165, 0
  v_mov_b32 v181, 0
  v_mov_b32 v166, 0
  v_mov_b32 v182, 0
  v_mov_b32 v167, 0
  v_mov_b32 v183, 0
  s_cmp_lt_u32 s26, 4
  s_cbranch_scc1 L_xr_lo_71
  s_and_b32 s52, s26, 1
  s_bfe_u32 s53, s26, 0x10001
  s_mul_i32 s54, s53, 768
  s_add_u32 s54, s54, 4096
  s_mul_i32 s52, s52, s54
  s_mul_i32 s53, s53, 9216
  s_add_u32 s52, s52, s53
  s_branch L_xr_dn_72
L_xr_lo_71:
  s_mul_i32 s52, s26, 2560
  s_add_u32 s52, s52, 151552
L_xr_dn_72:
  v_add_u32 v252, s52, v201
  s_xor_b32 s50, s26, 4
  s_cmp_lt_u32 s50, 4
  s_cbranch_scc1 L_xr_lo_73
  s_and_b32 s52, s50, 1
  s_bfe_u32 s53, s50, 0x10001
  s_mul_i32 s54, s53, 768
  s_add_u32 s54, s54, 4096
  s_mul_i32 s52, s52, s54
  s_mul_i32 s53, s53, 9216
  s_add_u32 s52, s52, s53
  s_branch L_xr_dn_74
L_xr_lo_73:
  s_mul_i32 s52, s50, 2560
  s_add_u32 s52, s52, 151552
L_xr_dn_74:
  v_add_u32 v253, s52, v201
  s_and_b32 s52, s26, 3
  s_mul_i32 s53, s27, 36864
  s_add_u32 s53, s53, s74
  v_bfe_u32 v4, v1, 4, 1
  v_mul_u32_u24 v4, 18432, v4
  v_lshl_add_u32 v202, v2, 4, v4
  v_lshrrev_b32 v5, 5, v1
  v_lshl_add_u32 v203, v5, 8, v202
  s_lshl_b32 s54, s44, 2
  s_add_u32 s54, s54, s52
  s_lshl_b32 s54, s54, 10
  s_lshl_b32 s55, s51, 9
  s_add_u32 s54, s54, s55
  s_add_u32 s87, s54, s53
  s_lshl_b32 s54, s44, 3
  s_lshl_b32 s55, s52, 1
  s_add_u32 s54, s54, s55
  s_add_u32 s54, s54, s51
  s_lshr_b32 s55, s54, 4
  s_add_u32 s55, s55, 16
  s_lshl_b32 s55, s55, 10
  s_bfe_u32 s56, s54, 0x20002
  s_lshl_b32 s56, s56, 8
  s_add_u32 s55, s55, s56
  s_and_b32 s56, s54, 3
  s_lshl_b32 s56, s56, 2
  s_add_u32 s55, s55, s56
  s_add_u32 s88, s55, s53
  s_mul_i32 s86, s44, 9
  s_add_u32 s86, s86, s26
  s_mul_i32 s86, s86, 18432
  s_cmp_eq_u32 s45, 0
  s_mov_b32 s89, 13393920
  s_cselect_b32 s89, 12730368, s89
  s_add_u32 s89, s89, s86
  s_cmp_lt_u32 s26, 2
  s_cselect_b32 s63, s45, 0
  v_and_b32 v5, 31, v1
  s_waitcnt vmcnt(0)
  s_barrier
  s_cmp_lg_u32 s76, 0
  s_cbranch_scc1 L_fbmax_75
  v_lshlrev_b32 v8, 4, v1
  v_lshlrev_b32 v9, 2, v5
  ds_read_b128 v[168:171], v8
  ds_read_b32 v172, v9 offset:8192
  s_waitcnt lgkmcnt(0)
  v_mfma_f32_32x32x16_bf16 v[16:31], v[168:171], v[184:187], 0
  v_mfma_f32_32x32x16_bf16 v[32:47], v[168:171], v[192:195], 0
  v_mfma_f32_32x32x8_bf16 v[16:31], v[172:173], v[188:189], v[16:31]
  v_mfma_f32_32x32x8_bf16 v[32:47], v[172:173], v[196:197], v[32:47]
  s_nop 8
  s_nop 1
  v_max3_f32 v10, v16, v17, v18
  v_max3_f32 v12, v19, v20, v21
  v_max3_f32 v11, v32, v33, v34
  v_max3_f32 v13, v35, v36, v37
  v_max3_f32 v10, v10, v22, v23
  v_max3_f32 v12, v12, v24, v25
  v_max3_f32 v11, v11, v38, v39
  v_max3_f32 v13, v13, v40, v41
  v_max3_f32 v10, v10, v26, v27
  v_max3_f32 v12, v12, v28, v29
  v_max3_f32 v11, v11, v42, v43
  v_max3_f32 v13, v13, v44, v45
  v_max3_f32 v10, v10, v30, v31
  v_max3_f32 v11, v11, v46, v47
  v_max_f32 v10, v10, v12
  v_max_f32 v11, v11, v13
  v_mov_b32 v12, v10
  v_mov_b32 v13, v11
  s_nop 0
  v_permlane32_swap_b32 v12, v10
  v_permlane32_swap_b32 v13, v11
  v_max_f32 v10, v10, v12
  v_max_f32 v11, v11, v13
  s_branch L_haveM_76
L_fbmax_75:
  s_add_u32 m0, s84, 24576
  s_add_u32 s50, s85, 24576
  buffer_load_dwordx4 v201, s[28:31], s50 offen sc1 lds
  s_add_u32 m0, s84, 32768
  s_add_u32 s50, s85, 32768
  buffer_load_dwordx4 v201, s[28:31], s50 offen sc1 lds
  s_add_u32 m0, s84, 40960
  s_add_u32 s50, s85, 40960
  buffer_load_dwordx4 v201, s[28:31], s50 offen sc1 lds
  s_add_u32 m0, s84, 49152
  s_add_u32 s50, s85, 49152
  buffer_load_dwordx4 v201, s[28:31], s50 offen sc1 lds
  s_add_u32 m0, s84, 57344
  s_add_u32 s50, s85, 57344
  buffer_load_dwordx4 v201, s[28:31], s50 offen sc1 lds
  s_add_u32 m0, s84, 65536
  s_add_u32 s50, s85, 65536
  buffer_load_dwordx4 v201, s[28:31], s50 offen sc1 lds
  s_add_u32 m0, s84, 73728
  s_add_u32 s50, s85, 73728
  buffer_load_dwordx4 v201, s[28:31], s50 offen sc1 lds
  s_add_u32 m0, s84, 81920
  s_add_u32 s50, s85, 81920
  buffer_load_dwordx4 v201, s[28:31], s50 offen sc1 lds
  s_add_u32 m0, s84, 90112
  s_add_u32 s50, s85, 90112
  buffer_load_dwordx4 v201, s[28:31], s50 offen sc1 lds
  s_add_u32 m0, s84, 98304
  s_add_u32 s50, s85, 98304
  buffer_load_dwordx4 v201, s[28:31], s50 offen sc1 lds
  s_add_u32 m0, s84, 106496
  s_add_u32 s50, s85, 106496
  buffer_load_dwordx4 v201, s[28:31], s50 offen sc1 lds
  s_add_u32 m0, s84, 114688
  s_add_u32 s50, s85, 114688
  buffer_load_dwordx4 v201, s[28:31], s50 offen sc1 lds
  s_add_u32 m0, s84, 122880
  s_add_u32 s50, s85, 122880
  buffer_load_dwordx4 v201, s[28:31], s50 offen sc1 lds
  s_add_u32 m0, s84, 131072
  s_add_u32 s50, s85, 131072
  buffer_load_dwordx4 v201, s[28:31], s50 offen sc1 lds
  s_add_u32 m0, s84, 139264
  s_add_u32 s50, s85, 139264
  buffer_load_dwordx4 v201, s[28:31], s50 offen sc1 lds
  s_cmp_ge_u32 s26, 4
  s_cbranch_scc1 L_kvd_77
  s_add_u32 m0, s84, 147456
  s_add_u32 s50, s85, 147456
  buffer_load_dwordx4 v201, s[28:31], s50 offen sc1 lds
L_kvd_77:
  s_waitcnt vmcnt(0)
  s_barrier
  v_mov_b32 v10, 0xff800000
  v_mov_b32 v11, 0xff800000
  v_mov_b32 v8, v198
  v_mov_b32 v9, v199
  s_mov_b32 s52, 0
L_fbloop_78:
  ds_read_b128 v[168:171], v8 offset:0
  ds_read_b32 v172, v9 offset:0
  s_waitcnt lgkmcnt(0)
  v_mfma_f32_32x32x16_bf16 v[16:31], v[168:171], v[184:187], 0
  v_mfma_f32_32x32x8_bf16 v[16:31], v[172:173], v[188:189], v[16:31]
  v_mfma_f32_32x32x16_bf16 v[32:47], v[168:171], v[192:195], 0
  v_mfma_f32_32x32x8_bf16 v[32:47], v[172:173], v[196:197], v[32:47]
  s_nop 9
  v_max3_f32 v12, v16, v17, v18
  v_max3_f32 v12, v12, v19, v20
  v_max3_f32 v12, v12, v21, v22
  v_max3_f32 v12, v12, v23, v24
  v_max3_f32 v12, v12, v25, v26
  v_max3_f32 v12, v12, v27, v28
  v_max3_f32 v12, v12, v29, v30
  v_max_f32 v12, v12, v31
  v_max3_f32 v13, v32, v33, v34
  v_max3_f32 v13, v13, v35, v36
  v_max3_f32 v13, v13, v37, v38
  v_max3_f32 v13, v13, v39, v40
  v_max3_f32 v13, v13, v41, v42
  v_max3_f32 v13, v13, v43, v44
  v_max3_f32 v13, v13, v45, v46
  v_max_f32 v13, v13, v47
  v_max_f32 v10, v10, v12
  v_max_f32 v11, v11, v13
  ds_read_b128 v[168:171], v8 offset:1024
  ds_read_b32 v172, v9 offset:128
  s_waitcnt lgkmcnt(0)
  v_mfma_f32_32x32x16_bf16 v[16:31], v[168:171], v[184:187], 0
  v_mfma_f32_32x32x8_bf16 v[16:31], v[172:173], v[188:189], v[16:31]
  v_mfma_f32_32x32x16_bf16 v[32:47], v[168:171], v[192:195], 0
  v_mfma_f32_32x32x8_bf16 v[32:47], v[172:173], v[196:197], v[32:47]
  s_nop 9
  v_max3_f32 v12, v16, v17, v18
  v_max3_f32 v12, v12, v19, v20
  v_max3_f32 v12, v12, v21, v22
  v_max3_f32 v12, v12, v23, v24
  v_max3_f32 v12, v12, v25, v26
  v_max3_f32 v12, v12, v27, v28
  v_max3_f32 v12, v12, v29, v30
  v_max_f32 v12, v12, v31
  v_max3_f32 v13, v32, v33, v34
  v_max3_f32 v13, v13, v35, v36
  v_max3_f32 v13, v13, v37, v38
  v_max3_f32 v13, v13, v39, v40
  v_max3_f32 v13, v13, v41, v42
  v_max3_f32 v13, v13, v43, v44
  v_max3_f32 v13, v13, v45, v46
  v_max_f32 v13, v13, v47
  v_max_f32 v10, v10, v12
  v_max_f32 v11, v11, v13
  ds_read_b128 v[168:171], v8 offset:2048
  ds_read_b32 v172, v9 offset:256
  s_waitcnt lgkmcnt(0)
  v_mfma_f32_32x32x16_bf16 v[16:31], v[168:171], v[184:187], 0
  v_mfma_f32_32x32x8_bf16 v[16:31], v[172:173], v[188:189], v[16:31]
  v_mfma_f32_32x32x16_bf16 v[32:47], v[168:171], v[192:195], 0
  v_mfma_f32_32x32x8_bf16 v[32:47], v[172:173], v[196:197], v[32:47]
  s_nop 9
  v_max3_f32 v12, v16, v17, v18
  v_max3_f32 v12, v12, v19, v20
  v_max3_f32 v12, v12, v21, v22
  v_max3_f32 v12, v12, v23, v24
  v_max3_f32 v12, v12, v25, v26
  v_max3_f32 v12, v12, v27, v28
  v_max3_f32 v12, v12, v29, v30
  v_max_f32 v12, v12, v31
  v_max3_f32 v13, v32, v33, v34
  v_max3_f32 v13, v13, v35, v36
  v_max3_f32 v13, v13, v37, v38
  v_max3_f32 v13, v13, v39, v40
  v_max3_f32 v13, v13, v41, v42
  v_max3_f32 v13, v13, v43, v44
  v_max3_f32 v13, v13, v45, v46
  v_max_f32 v13, v13, v47
  v_max_f32 v10, v10, v12
  v_max_f32 v11, v11, v13
  ds_read_b128 v[168:171], v8 offset:3072
  ds_read_b32 v172, v9 offset:384
  s_waitcnt lgkmcnt(0)
  v_mfma_f32_32x32x16_bf16 v[16:31], v[168:171], v[184:187], 0
  v_mfma_f32_32x32x8_bf16 v[16:31], v[172:173], v[188:189], v[16:31]
  v_mfma_f32_32x32x16_bf16 v[32:47], v[168:171], v[192:195], 0
  v_mfma_f32_32x32x8_bf16 v[32:47], v[172:173], v[196:197], v[32:47]
  s_nop 9
  v_max3_f32 v12, v16, v17, v18
  v_max3_f32 v12, v12, v19, v20
  v_max3_f32 v12, v12, v21, v22
  v_max3_f32 v12, v12, v23, v24
  v_max3_f32 v12, v12, v25, v26
  v_max3_f32 v12, v12, v27, v28
  v_max3_f32 v12, v12, v29, v30
  v_max_f32 v12, v12, v31
  v_max3_f32 v13, v32, v33, v34
  v_max3_f32 v13, v13, v35, v36
  v_max3_f32 v13, v13, v37, v38
  v_max3_f32 v13, v13, v39, v40
  v_max3_f32 v13, v13, v41, v42
  v_max3_f32 v13, v13, v43, v44
  v_max3_f32 v13, v13, v45, v46
  v_max_f32 v13, v13, v47
  v_max_f32 v10, v10, v12
  v_max_f32 v11, v11, v13
  v_add_u32 v8, 18944, v8
  v_add_u32 v9, 18944, v9
  s_add_u32 s52, s52, 1
  s_cmp_lt_u32 s52, 8
  s_cbranch_scc1 L_fbloop_78
  v_mov_b32 v4, v10
  s_nop 1
  v_permlane32_swap_b32 v4, v10
  v_max_f32 v10, v10, v4
  v_mov_b32 v4, v11
  s_nop 1
  v_permlane32_swap_b32 v4, v11
  v_max_f32 v11, v11, v4
  s_lshl_b32 s52, s26, 9
  s_add_u32 s52, s52, 151552
  v_lshlrev_b32 v8, 3, v1
  v_add_u32 v9, s52, v8
  ds_write_b64 v9, v[10:11]
  s_waitcnt lgkmcnt(0)
  s_barrier
  s_xor_b32 s52, s26, 4
  s_lshl_b32 s52, s52, 9
  s_add_u32 s52, s52, 151552
  v_add_u32 v9, s52, v8
  ds_read_b64 v[12:13], v9
  s_waitcnt lgkmcnt(0)
  v_max_f32 v10, v10, v12
  v_max_f32 v11, v11, v13
L_haveM_76:
  ds_read_b128 v[168:171], v198
  ds_read_b32 v172, v199
  v_sub_f32 v10, 0, v10
  v_sub_f32 v11, 0, v11
  v_cvt_pk_bf16_f32 v4, v10, v10
  v_cvt_pk_bf16_f32 v6, v11, v11
  v_lshlrev_b32 v4, 16, v4
  v_lshlrev_b32 v6, 16, v6
  v_sub_f32 v5, v10, v4
  v_sub_f32 v7, v11, v6
  v_cmp_gt_u32 vcc, 32, v1
  v_cvt_pk_bf16_f32 v4, v4, v5
  v_cvt_pk_bf16_f32 v6, v6, v7
  v_mov_b32 v5, 0
  v_cndmask_b32 v189, v5, v4, vcc
  v_cndmask_b32 v197, v5, v6, vcc
  s_waitcnt lgkmcnt(0)
  v_mfma_f32_32x32x16_bf16 v[16:31], v[168:171], v[184:187], 0
  v_mfma_f32_32x32x8_bf16 v[16:31], v[172:173], v[188:189], v[16:31]
  s_nop 12
  v_mfma_f32_32x32x16_bf16 v[32:47], v[168:171], v[192:195], 0
  v_exp_f32 v16, v16
  v_exp_f32 v17, v17
  v_exp_f32 v18, v18
  v_exp_f32 v19, v19
  v_cvt_pk_bf16_f32 v152, v16, v17
  v_cvt_pk_bf16_f32 v153, v18, v19
  s_add_u32 m0, s84, 24576
  s_add_u32 s50, s85, 24576
  buffer_load_dwordx4 v201, s[28:31], s50 offen sc1 lds
  v_mfma_f32_32x32x8_bf16 v[32:47], v[172:173], v[196:197], v[32:47]
  ds_read_b128 v[168:171], v198 offset:1024
  ds_read_b32 v172, v199 offset:128
  v_exp_f32 v20, v20
  v_exp_f32 v21, v21
  v_exp_f32 v22, v22
  v_exp_f32 v23, v23
  v_cvt_pk_bf16_f32 v154, v20, v21
  v_cvt_pk_bf16_f32 v155, v22, v23
  s_add_u32 m0, s84, 32768
  s_add_u32 s50, s85, 32768
  buffer_load_dwordx4 v201, s[28:31], s50 offen sc1 lds
  v_mfma_f32_32x32x16_bf16 v[136:151], v[176:179], v[160:163], v[136:151]
  v_exp_f32 v24, v24
  v_exp_f32 v25, v25
  v_exp_f32 v26, v26
  v_exp_f32 v27, v27
  v_cvt_pk_bf16_f32 v156, v24, v25
  v_cvt_pk_bf16_f32 v157, v26, v27
  s_add_u32 m0, s84, 40960
  s_add_u32 s50, s85, 40960
  buffer_load_dwordx4 v201, s[28:31], s50 offen sc1 lds
  v_mfma_f32_32x32x16_bf16 v[136:151], v[180:183], v[164:167], v[136:151]
  s_mov_b64 exec, s[82:83]
  ds_read_b128 v[176:179], v200 offset:0
  ds_read_b128 v[180:183], v200 offset:608
  s_mov_b64 exec, -1
  v_exp_f32 v28, v28
  v_exp_f32 v29, v29
  v_exp_f32 v30, v30
  v_exp_f32 v31, v31
  v_cvt_pk_bf16_f32 v158, v28, v29
  v_cvt_pk_bf16_f32 v159, v30, v31
  s_add_u32 m0, s84, 49152
  s_add_u32 s50, s85, 49152
  buffer_load_dwordx4 v201, s[28:31], s50 offen sc1 lds
  s_waitcnt lgkmcnt(2)
  v_mfma_f32_32x32x16_bf16 v[16:31], v[168:171], v[184:187], 0
  v_exp_f32 v32, v32
  v_exp_f32 v33, v33
  v_exp_f32 v34, v34
  v_exp_f32 v35, v35
  v_cvt_pk_bf16_f32 v160, v32, v33
  v_cvt_pk_bf16_f32 v161, v34, v35
  s_add_u32 m0, s84, 57344
  s_add_u32 s50, s85, 57344
  buffer_load_dwordx4 v201, s[28:31], s50 offen sc1 lds
  v_mfma_f32_32x32x8_bf16 v[16:31], v[172:173], v[188:189], v[16:31]
  v_exp_f32 v36, v36
  v_exp_f32 v37, v37
  v_exp_f32 v38, v38
  v_exp_f32 v39, v39
  v_cvt_pk_bf16_f32 v162, v36, v37
  v_cvt_pk_bf16_f32 v163, v38, v39
  s_add_u32 m0, s84, 65536
  s_add_u32 s50, s85, 65536
  buffer_load_dwordx4 v201, s[28:31], s50 offen sc1 lds
  s_waitcnt lgkmcnt(0)
  v_mfma_f32_32x32x16_bf16 v[48:63], v[176:179], v[152:155], v[48:63]
  v_exp_f32 v40, v40
  v_exp_f32 v41, v41
  v_exp_f32 v42, v42
  v_exp_f32 v43, v43
  v_cvt_pk_bf16_f32 v164, v40, v41
  v_cvt_pk_bf16_f32 v165, v42, v43
  s_add_u32 m0, s84, 73728
  s_add_u32 s50, s85, 73728
  buffer_load_dwordx4 v201, s[28:31], s50 offen sc1 lds
  v_mfma_f32_32x32x16_bf16 v[48:63], v[180:183], v[156:159], v[48:63]
  v_exp_f32 v44, v44
  v_exp_f32 v45, v45
  v_exp_f32 v46, v46
  v_exp_f32 v47, v47
  v_cvt_pk_bf16_f32 v166, v44, v45
  v_cvt_pk_bf16_f32 v167, v46, v47
  s_add_u32 m0, s84, 81920
  s_add_u32 s50, s85, 81920
  buffer_load_dwordx4 v201, s[28:31], s50 offen sc1 lds
  v_mfma_f32_32x32x16_bf16 v[32:47], v[168:171], v[192:195], 0
  v_exp_f32 v16, v16
  v_exp_f32 v17, v17
  v_exp_f32 v18, v18
  v_exp_f32 v19, v19
  v_cvt_pk_bf16_f32 v152, v16, v17
  v_cvt_pk_bf16_f32 v153, v18, v19
  s_add_u32 m0, s84, 90112
  s_add_u32 s50, s85, 90112
  buffer_load_dwordx4 v201, s[28:31], s50 offen sc1 lds
  v_mfma_f32_32x32x8_bf16 v[32:47], v[172:173], v[196:197], v[32:47]
  ds_read_b128 v[168:171], v198 offset:2048
  ds_read_b32 v172, v199 offset:256
  v_exp_f32 v20, v20
  v_exp_f32 v21, v21
  v_exp_f32 v22, v22
  v_exp_f32 v23, v23
  v_cvt_pk_bf16_f32 v154, v20, v21
  v_cvt_pk_bf16_f32 v155, v22, v23
  s_add_u32 m0, s84, 98304
  s_add_u32 s50, s85, 98304
  buffer_load_dwordx4 v201, s[28:31], s50 offen sc1 lds
  v_mfma_f32_32x32x16_bf16 v[136:151], v[176:179], v[160:163], v[136:151]
  v_exp_f32 v24, v24
  v_exp_f32 v25, v25
  v_exp_f32 v26, v26
  v_exp_f32 v27, v27
  v_cvt_pk_bf16_f32 v156, v24, v25
  v_cvt_pk_bf16_f32 v157, v26, v27
  s_add_u32 m0, s84, 106496
  s_add_u32 s50, s85, 106496
  buffer_load_dwordx4 v201, s[28:31], s50 offen sc1 lds
  v_mfma_f32_32x32x16_bf16 v[136:151], v[180:183], v[164:167], v[136:151]
  s_mov_b64 exec, s[82:83]
  ds_read_b128 v[176:179], v200 offset:1216
  ds_read_b128 v[180:183], v200 offset:1824
  s_mov_b64 exec, -1
  v_exp_f32 v28, v28
  v_exp_f32 v29, v29
  v_exp_f32 v30, v30
  v_exp_f32 v31, v31
  v_cvt_pk_bf16_f32 v158, v28, v29
  v_cvt_pk_bf16_f32 v159, v30, v31
  s_add_u32 m0, s84, 114688
  s_add_u32 s50, s85, 114688
  buffer_load_dwordx4 v201, s[28:31], s50 offen sc1 lds
  s_waitcnt lgkmcnt(2)
  v_mfma_f32_32x32x16_bf16 v[16:31], v[168:171], v[184:187], 0
  v_exp_f32 v32, v32
  v_exp_f32 v33, v33
  v_exp_f32 v34, v34
  v_exp_f32 v35, v35
  v_cvt_pk_bf16_f32 v160, v32, v33
  v_cvt_pk_bf16_f32 v161, v34, v35
  s_add_u32 m0, s84, 122880
  s_add_u32 s50, s85, 122880
  buffer_load_dwordx4 v201, s[28:31], s50 offen sc1 lds
  v_mfma_f32_32x32x8_bf16 v[16:31], v[172:173], v[188:189], v[16:31]
  v_exp_f32 v36, v36
  v_exp_f32 v37, v37
  v_exp_f32 v38, v38
  v_exp_f32 v39, v39
  v_cvt_pk_bf16_f32 v162, v36, v37
  v_cvt_pk_bf16_f32 v163, v38, v39
  s_add_u32 m0, s84, 131072
  s_add_u32 s50, s85, 131072
  buffer_load_dwordx4 v201, s[28:31], s50 offen sc1 lds
  s_waitcnt lgkmcnt(0)
  v_mfma_f32_32x32x16_bf16 v[48:63], v[176:179], v[152:155], v[48:63]
  v_exp_f32 v40, v40
  v_exp_f32 v41, v41
  v_exp_f32 v42, v42
  v_exp_f32 v43, v43
  v_cvt_pk_bf16_f32 v164, v40, v41
  v_cvt_pk_bf16_f32 v165, v42, v43
  s_add_u32 m0, s84, 139264
  s_add_u32 s50, s85, 139264
  buffer_load_dwordx4 v201, s[28:31], s50 offen sc1 lds
  v_mfma_f32_32x32x16_bf16 v[48:63], v[180:183], v[156:159], v[48:63]
  v_exp_f32 v44, v44
  v_exp_f32 v45, v45
  v_exp_f32 v46, v46
  v_exp_f32 v47, v47
  v_cvt_pk_bf16_f32 v166, v44, v45
  v_cvt_pk_bf16_f32 v167, v46, v47
  s_cmp_ge_u32 s26, 4
  s_cbranch_scc1 L_kvd_79
  s_add_u32 m0, s84, 147456
  s_add_u32 s50, s85, 147456
  buffer_load_dwordx4 v201, s[28:31], s50 offen sc1 lds
L_kvd_79:
  v_mfma_f32_32x32x16_bf16 v[32:47], v[168:171], v[192:195], 0
  v_exp_f32 v16, v16
  v_exp_f32 v17, v17
  v_exp_f32 v18, v18
  v_exp_f32 v19, v19
  v_cvt_pk_bf16_f32 v152, v16, v17
  v_cvt_pk_bf16_f32 v153, v18, v19
  s_cmp_eq_u32 s63, 0
  s_cbranch_scc1 L_wo2h_80
  s_add_u32 s50, s86, 13393920
  buffer_load_dwordx4 v[208:211], v201, s[28:31], s50 offen sc1
L_wo2h_80:
  s_cmp_eq_u32 s63, 0
  s_cbranch_scc1 L_wo2h_81
  s_add_u32 s50, s86, 13402112
  buffer_load_dwordx4 v[240:243], v201, s[28:31], s50 offen sc1
L_wo2h_81:
  v_mfma_f32_32x32x8_bf16 v[32:47], v[172:173], v[196:197], v[32:47]
  ds_read_b128 v[168:171], v198 offset:3072
  ds_read_b32 v172, v199 offset:384
  v_exp_f32 v20, v20
  v_exp_f32 v21, v21
  v_exp_f32 v22, v22
  v_exp_f32 v23, v23
  v_cvt_pk_bf16_f32 v154, v20, v21
  v_cvt_pk_bf16_f32 v155, v22, v23
  s_cmp_eq_u32 s63, 0
  s_cbranch_scc1 L_wo2h_82
  s_add_u32 s50, s86, 13394944
  buffer_load_dwordx4 v[212:215], v201, s[28:31], s50 offen sc1
L_wo2h_82:
  s_cmp_eq_u32 s63, 0
  s_cbranch_scc1 L_wo2h_83
  s_add_u32 s50, s86, 13403136
  buffer_load_dwordx4 v[244:247], v201, s[28:31], s50 offen sc1
L_wo2h_83:
  v_mfma_f32_32x32x16_bf16 v[136:151], v[176:179], v[160:163], v[136:151]
  v_exp_f32 v24, v24
  v_exp_f32 v25, v25
  v_exp_f32 v26, v26
  v_exp_f32 v27, v27
  v_cvt_pk_bf16_f32 v156, v24, v25
  v_cvt_pk_bf16_f32 v157, v26, v27
  s_cmp_eq_u32 s63, 0
  s_cbranch_scc1 L_wo2h_84
  s_add_u32 s50, s86, 13395968
  buffer_load_dwordx4 v[216:219], v201, s[28:31], s50 offen sc1
L_wo2h_84:
  s_cmp_eq_u32 s63, 0
  s_cbranch_scc1 L_wo2h_85
  s_add_u32 s50, s86, 13404160
  buffer_load_dwordx4 v[248:251], v201, s[28:31], s50 offen sc1
L_wo2h_85:
  v_mfma_f32_32x32x16_bf16 v[136:151], v[180:183], v[164:167], v[136:151]
  s_mov_b64 exec, s[82:83]
  ds_read_b128 v[176:179], v200 offset:2432
  ds_read_b128 v[180:183], v200 offset:3040
  s_mov_b64 exec, -1
  v_exp_f32 v28, v28
  v_exp_f32 v29, v29
  v_exp_f32 v30, v30
  v_exp_f32 v31, v31
  v_cvt_pk_bf16_f32 v158, v28, v29
  v_cvt_pk_bf16_f32 v159, v30, v31
  s_cmp_eq_u32 s63, 0
  s_cbranch_scc1 L_wo2h_86
  s_add_u32 s50, s86, 13396992
  buffer_load_dwordx4 v[220:223], v201, s[28:31], s50 offen sc1
L_wo2h_86:
  s_waitcnt lgkmcnt(2)
  v_mfma_f32_32x32x16_bf16 v[16:31], v[168:171], v[184:187], 0
  v_exp_f32 v32, v32
  v_exp_f32 v33, v33
  v_exp_f32 v34, v34
  v_exp_f32 v35, v35
  v_cvt_pk_bf16_f32 v160, v32, v33
  v_cvt_pk_bf16_f32 v161, v34, v35
  s_cmp_eq_u32 s63, 0
  s_cbranch_scc1 L_wo2h_87
  s_add_u32 s50, s86, 13398016
  buffer_load_dwordx4 v[224:227], v201, s[28:31], s50 offen sc1
L_wo2h_87:
  v_mfma_f32_32x32x8_bf16 v[16:31], v[172:173], v[188:189], v[16:31]
  v_exp_f32 v36, v36
  v_exp_f32 v37, v37
  v_exp_f32 v38, v38
  v_exp_f32 v39, v39
  v_cvt_pk_bf16_f32 v162, v36, v37
  v_cvt_pk_bf16_f32 v163, v38, v39
  s_cmp_eq_u32 s63, 0
  s_cbranch_scc1 L_wo2h_88
  s_add_u32 s50, s86, 13399040
  buffer_load_dwordx4 v[228:231], v201, s[28:31], s50 offen sc1
L_wo2h_88:
  s_waitcnt lgkmcnt(0)
  v_mfma_f32_32x32x16_bf16 v[48:63], v[176:179], v[152:155], v[48:63]
  v_exp_f32 v40, v40
  v_exp_f32 v41, v41
  v_exp_f32 v42, v42
  v_exp_f32 v43, v43
  v_cvt_pk_bf16_f32 v164, v40, v41
  v_cvt_pk_bf16_f32 v165, v42, v43
  s_cmp_eq_u32 s63, 0
  s_cbranch_scc1 L_wo2h_89
  s_add_u32 s50, s86, 13400064
  buffer_load_dwordx4 v[232:235], v201, s[28:31], s50 offen sc1
L_wo2h_89:
  v_mfma_f32_32x32x16_bf16 v[48:63], v[180:183], v[156:159], v[48:63]
  v_exp_f32 v44, v44
  v_exp_f32 v45, v45
  v_exp_f32 v46, v46
  v_exp_f32 v47, v47
  v_cvt_pk_bf16_f32 v166, v44, v45
  v_cvt_pk_bf16_f32 v167, v46, v47
  s_cmp_eq_u32 s63, 0
  s_cbranch_scc1 L_wo2h_90
  s_add_u32 s50, s86, 13401088
  buffer_load_dwordx4 v[236:239], v201, s[28:31], s50 offen sc1
L_wo2h_90:
  s_cmp_lg_u32 s63, 0
  s_cbranch_scc1 L_kvw1_91
  s_waitcnt vmcnt(0)
  s_branch L_kvwd_92
L_kvw1_91:
  s_waitcnt vmcnt(11)
L_kvwd_92:
  s_barrier
  v_mfma_f32_32x32x16_bf16 v[32:47], v[168:171], v[192:195], 0
  v_exp_f32 v16, v16
  v_exp_f32 v17, v17
  v_exp_f32 v18, v18
  v_exp_f32 v19, v19
  v_cvt_pk_bf16_f32 v152, v16, v17
  v_cvt_pk_bf16_f32 v153, v18, v19
  s_cmp_lg_u32 s63, 0
  s_cbranch_scc1 L_twlh_93
  s_add_u32 s50, s89, 0
  buffer_load_dwordx4 v[64:67], v201, s[28:31], s50 offen sc1
L_twlh_93:
  s_cmp_lg_u32 s63, 0
  s_cbranch_scc1 L_twlh_94
  s_add_u32 s50, s89, 8192
  buffer_load_dwordx4 v[96:99], v201, s[28:31], s50 offen sc1
L_twlh_94:
  s_cmp_lg_u32 s63, 0
  s_cbranch_scc1 L_twlh_95
  s_add_u32 s50, s89, 16384
  buffer_load_dwordx4 v[128:131], v201, s[28:31], s50 offen sc1
L_twlh_95:
  v_mfma_f32_32x32x8_bf16 v[32:47], v[172:173], v[196:197], v[32:47]
  ds_read_b128 v[168:171], v198 offset:18944
  ds_read_b32 v172, v199 offset:18944
  v_exp_f32 v20, v20
  v_exp_f32 v21, v21
  v_exp_f32 v22, v22
  v_exp_f32 v23, v23
  v_cvt_pk_bf16_f32 v154, v20, v21
  v_cvt_pk_bf16_f32 v155, v22, v23
  s_cmp_lg_u32 s63, 0
  s_cbranch_scc1 L_twlh_96
  s_add_u32 s50, s89, 1024
  buffer_load_dwordx4 v[68:71], v201, s[28:31], s50 offen sc1
L_twlh_96:
  s_cmp_lg_u32 s63, 0
  s_cbranch_scc1 L_twlh_97
  s_add_u32 s50, s89, 9216
  buffer_load_dwordx4 v[100:103], v201, s[28:31], s50 offen sc1
L_twlh_97:
  s_cmp_lg_u32 s63, 0
  s_cbranch_scc1 L_twlh_98
  s_add_u32 s50, s89, 17408
  buffer_load_dwordx4 v[132:135], v201, s[28:31], s50 offen sc1
L_twlh_98:
  v_mfma_f32_32x32x16_bf16 v[136:151], v[176:179], v[160:163], v[136:151]
  v_exp_f32 v24, v24
  v_exp_f32 v25, v25
  v_exp_f32 v26, v26
  v_exp_f32 v27, v27
  v_cvt_pk_bf16_f32 v156, v24, v25
  v_cvt_pk_bf16_f32 v157, v26, v27
  s_cmp_lg_u32 s63, 0
  s_cbranch_scc1 L_twlh_99
  s_add_u32 s50, s89, 2048
  buffer_load_dwordx4 v[72:75], v201, s[28:31], s50 offen sc1
L_twlh_99:
  s_cmp_lg_u32 s63, 0
  s_cbranch_scc1 L_twlh_100
  s_add_u32 s50, s89, 10240
  buffer_load_dwordx4 v[104:107], v201, s[28:31], s50 offen sc1
L_twlh_100:
  v_mfma_f32_32x32x16_bf16 v[136:151], v[180:183], v[164:167], v[136:151]
  s_mov_b64 exec, s[82:83]
  ds_read_b128 v[176:179], v200 offset:3648
  ds_read_b128 v[180:183], v200 offset:4256
  s_mov_b64 exec, -1
  v_exp_f32 v28, v28
  v_exp_f32 v29, v29
  v_exp_f32 v30, v30
  v_exp_f32 v31, v31
  v_cvt_pk_bf16_f32 v158, v28, v29
  v_cvt_pk_bf16_f32 v159, v30, v31
  s_cmp_lg_u32 s63, 0
  s_cbranch_scc1 L_twlh_101
  s_add_u32 s50, s89, 3072
  buffer_load_dwordx4 v[76:79], v201, s[28:31], s50 offen sc1
L_twlh_101:
  s_cmp_lg_u32 s63, 0
  s_cbranch_scc1 L_twlh_102
  s_add_u32 s50, s89, 11264
  buffer_load_dwordx4 v[108:111], v201, s[28:31], s50 offen sc1
L_twlh_102:
  s_waitcnt lgkmcnt(2)
  v_mfma_f32_32x32x16_bf16 v[16:31], v[168:171], v[184:187], 0
  v_exp_f32 v32, v32
  v_exp_f32 v33, v33
  v_exp_f32 v34, v34
  v_exp_f32 v35, v35
  v_cvt_pk_bf16_f32 v160, v32, v33
  v_cvt_pk_bf16_f32 v161, v34, v35
  s_cmp_lg_u32 s63, 0
  s_cbranch_scc1 L_twlh_103
  s_add_u32 s50, s89, 4096
  buffer_load_dwordx4 v[80:83], v201, s[28:31], s50 offen sc1
L_twlh_103:
  s_cmp_lg_u32 s63, 0
  s_cbranch_scc1 L_twlh_104
  s_add_u32 s50, s89, 12288
  buffer_load_dwordx4 v[112:115], v201, s[28:31], s50 offen sc1
L_twlh_104:
  v_mfma_f32_32x32x8_bf16 v[16:31], v[172:173], v[188:189], v[16:31]
  v_exp_f32 v36, v36
  v_exp_f32 v37, v37
  v_exp_f32 v38, v38
  v_exp_f32 v39, v39
  v_cvt_pk_bf16_f32 v162, v36, v37
  v_cvt_pk_bf16_f32 v163, v38, v39
  s_cmp_lg_u32 s63, 0
  s_cbranch_scc1 L_twlh_105
  s_add_u32 s50, s89, 5120
  buffer_load_dwordx4 v[84:87], v201, s[28:31], s50 offen sc1
L_twlh_105:
  s_cmp_lg_u32 s63, 0
  s_cbranch_scc1 L_twlh_106
  s_add_u32 s50, s89, 13312
  buffer_load_dwordx4 v[116:119], v201, s[28:31], s50 offen sc1
L_twlh_106:
  s_waitcnt lgkmcnt(0)
  v_mfma_f32_32x32x16_bf16 v[48:63], v[176:179], v[152:155], v[48:63]
  v_exp_f32 v40, v40
  v_exp_f32 v41, v41
  v_exp_f32 v42, v42
  v_exp_f32 v43, v43
  v_cvt_pk_bf16_f32 v164, v40, v41
  v_cvt_pk_bf16_f32 v165, v42, v43
  s_cmp_lg_u32 s63, 0
  s_cbranch_scc1 L_twlh_107
  s_add_u32 s50, s89, 6144
  buffer_load_dwordx4 v[88:91], v201, s[28:31], s50 offen sc1
L_twlh_107:
  s_cmp_lg_u32 s63, 0
  s_cbranch_scc1 L_twlh_108
  s_add_u32 s50, s89, 14336
  buffer_load_dwordx4 v[120:123], v201, s[28:31], s50 offen sc1
L_twlh_108:
  v_mfma_f32_32x32x16_bf16 v[48:63], v[180:183], v[156:159], v[48:63]
  v_exp_f32 v44, v44
  v_exp_f32 v45, v45
  v_exp_f32 v46, v46
  v_exp_f32 v47, v47
  v_cvt_pk_bf16_f32 v166, v44, v45
  v_cvt_pk_bf16_f32 v167, v46, v47
  s_cmp_lg_u32 s63, 0
  s_cbranch_scc1 L_twlh_109
  s_add_u32 s50, s89, 7168
  buffer_load_dwordx4 v[92:95], v201, s[28:31], s50 offen sc1
L_twlh_109:
  s_cmp_lg_u32 s63, 0
  s_cbranch_scc1 L_twlh_110
  s_add_u32 s50, s89, 15360
  buffer_load_dwordx4 v[124:127], v201, s[28:31], s50 offen sc1
L_twlh_110:
  v_add_u32 v198, 18944, v198
  v_add_u32 v199, 18944, v199
  v_add_u32 v200, 18944, v200
  s_mov_b32 s52, 1
.p2align 6
L_attn_main_70:
  v_mfma_f32_32x32x16_bf16 v[32:47], v[168:171], v[192:195], 0
  v_exp_f32 v16, v16
  v_exp_f32 v17, v17
  v_exp_f32 v18, v18
  v_exp_f32 v19, v19
  v_cvt_pk_bf16_f32 v152, v16, v17
  v_cvt_pk_bf16_f32 v153, v18, v19
  v_mfma_f32_32x32x8_bf16 v[32:47], v[172:173], v[196:197], v[32:47]
  ds_read_b128 v[168:171], v198 offset:1024
  ds_read_b32 v172, v199 offset:128
  v_exp_f32 v20, v20
  v_exp_f32 v21, v21
  v_exp_f32 v22, v22
  v_exp_f32 v23, v23
  v_cvt_pk_bf16_f32 v154, v20, v21
  v_cvt_pk_bf16_f32 v155, v22, v23
  v_mfma_f32_32x32x16_bf16 v[136:151], v[176:179], v[160:163], v[136:151]
  v_exp_f32 v24, v24
  v_exp_f32 v25, v25
  v_exp_f32 v26, v26
  v_exp_f32 v27, v27
  v_cvt_pk_bf16_f32 v156, v24, v25
  v_cvt_pk_bf16_f32 v157, v26, v27
  v_mfma_f32_32x32x16_bf16 v[136:151], v[180:183], v[164:167], v[136:151]
  s_mov_b64 exec, s[82:83]
  ds_read_b128 v[176:179], v200 offset:0
  ds_read_b128 v[180:183], v200 offset:608
  s_mov_b64 exec, -1
  v_exp_f32 v28, v28
  v_exp_f32 v29, v29
  v_exp_f32 v30, v30
  v_exp_f32 v31, v31
  v_cvt_pk_bf16_f32 v158, v28, v29
  v_cvt_pk_bf16_f32 v159, v30, v31
  s_waitcnt lgkmcnt(2)
  v_mfma_f32_32x32x16_bf16 v[16:31], v[168:171], v[184:187], 0
  v_exp_f32 v32, v32
  v_exp_f32 v33, v33
  v_exp_f32 v34, v34
  v_exp_f32 v35, v35
  v_cvt_pk_bf16_f32 v160, v32, v33
  v_cvt_pk_bf16_f32 v161, v34, v35
  v_mfma_f32_32x32x8_bf16 v[16:31], v[172:173], v[188:189], v[16:31]
  v_exp_f32 v36, v36
  v_exp_f32 v37, v37
  v_exp_f32 v38, v38
  v_exp_f32 v39, v39
  v_cvt_pk_bf16_f32 v162, v36, v37
  v_cvt_pk_bf16_f32 v163, v38, v39
  s_waitcnt lgkmcnt(0)
  v_mfma_f32_32x32x16_bf16 v[48:63], v[176:179], v[152:155], v[48:63]
  v_exp_f32 v40, v40
  v_exp_f32 v41, v41
  v_exp_f32 v42, v42
  v_exp_f32 v43, v43
  v_cvt_pk_bf16_f32 v164, v40, v41
  v_cvt_pk_bf16_f32 v165, v42, v43
  v_mfma_f32_32x32x16_bf16 v[48:63], v[180:183], v[156:159], v[48:63]
  v_exp_f32 v44, v44
  v_exp_f32 v45, v45
  v_exp_f32 v46, v46
  v_exp_f32 v47, v47
  v_cvt_pk_bf16_f32 v166, v44, v45
  v_cvt_pk_bf16_f32 v167, v46, v47
  v_mfma_f32_32x32x16_bf16 v[32:47], v[168:171], v[192:195], 0
  v_exp_f32 v16, v16
  v_exp_f32 v17, v17
  v_exp_f32 v18, v18
  v_exp_f32 v19, v19
  v_cvt_pk_bf16_f32 v152, v16, v17
  v_cvt_pk_bf16_f32 v153, v18, v19
  v_mfma_f32_32x32x8_bf16 v[32:47], v[172:173], v[196:197], v[32:47]
  ds_read_b128 v[168:171], v198 offset:2048
  ds_read_b32 v172, v199 offset:256
  v_exp_f32 v20, v20
  v_exp_f32 v21, v21
  v_exp_f32 v22, v22
  v_exp_f32 v23, v23
  v_cvt_pk_bf16_f32 v154, v20, v21
  v_cvt_pk_bf16_f32 v155, v22, v23
  v_mfma_f32_32x32x16_bf16 v[136:151], v[176:179], v[160:163], v[136:151]
  v_exp_f32 v24, v24
  v_exp_f32 v25, v25
  v_exp_f32 v26, v26
  v_exp_f32 v27, v27
  v_cvt_pk_bf16_f32 v156, v24, v25
  v_cvt_pk_bf16_f32 v157, v26, v27
  v_mfma_f32_32x32x16_bf16 v[136:151], v[180:183], v[164:167], v[136:151]
  s_mov_b64 exec, s[82:83]
  ds_read_b128 v[176:179], v200 offset:1216
  ds_read_b128 v[180:183], v200 offset:1824
  s_mov_b64 exec, -1
  v_exp_f32 v28, v28
  v_exp_f32 v29, v29
  v_exp_f32 v30, v30
  v_exp_f32 v31, v31
  v_cvt_pk_bf16_f32 v158, v28, v29
  v_cvt_pk_bf16_f32 v159, v30, v31
  s_waitcnt lgkmcnt(2)
  v_mfma_f32_32x32x16_bf16 v[16:31], v[168:171], v[184:187], 0
  v_exp_f32 v32, v32
  v_exp_f32 v33, v33
  v_exp_f32 v34, v34
  v_exp_f32 v35, v35
  v_cvt_pk_bf16_f32 v160, v32, v33
  v_cvt_pk_bf16_f32 v161, v34, v35
  v_mfma_f32_32x32x8_bf16 v[16:31], v[172:173], v[188:189], v[16:31]
  v_exp_f32 v36, v36
  v_exp_f32 v37, v37
  v_exp_f32 v38, v38
  v_exp_f32 v39, v39
  v_cvt_pk_bf16_f32 v162, v36, v37
  v_cvt_pk_bf16_f32 v163, v38, v39
  s_waitcnt lgkmcnt(0)
  v_mfma_f32_32x32x16_bf16 v[48:63], v[176:179], v[152:155], v[48:63]
  v_exp_f32 v40, v40
  v_exp_f32 v41, v41
  v_exp_f32 v42, v42
  v_exp_f32 v43, v43
  v_cvt_pk_bf16_f32 v164, v40, v41
  v_cvt_pk_bf16_f32 v165, v42, v43
  v_mfma_f32_32x32x16_bf16 v[48:63], v[180:183], v[156:159], v[48:63]
  v_exp_f32 v44, v44
  v_exp_f32 v45, v45
  v_exp_f32 v46, v46
  v_exp_f32 v47, v47
  v_cvt_pk_bf16_f32 v166, v44, v45
  v_cvt_pk_bf16_f32 v167, v46, v47
  v_mfma_f32_32x32x16_bf16 v[32:47], v[168:171], v[192:195], 0
  v_exp_f32 v16, v16
  v_exp_f32 v17, v17
  v_exp_f32 v18, v18
  v_exp_f32 v19, v19
  v_cvt_pk_bf16_f32 v152, v16, v17
  v_cvt_pk_bf16_f32 v153, v18, v19
  v_mfma_f32_32x32x8_bf16 v[32:47], v[172:173], v[196:197], v[32:47]
  ds_read_b128 v[168:171], v198 offset:3072
  ds_read_b32 v172, v199 offset:384
  v_exp_f32 v20, v20
  v_exp_f32 v21, v21
  v_exp_f32 v22, v22
  v_exp_f32 v23, v23
  v_cvt_pk_bf16_f32 v154, v20, v21
  v_cvt_pk_bf16_f32 v155, v22, v23
  v_mfma_f32_32x32x16_bf16 v[136:151], v[176:179], v[160:163], v[136:151]
  v_exp_f32 v24, v24
  v_exp_f32 v25, v25
  v_exp_f32 v26, v26
  v_exp_f32 v27, v27
  v_cvt_pk_bf16_f32 v156, v24, v25
  v_cvt_pk_bf16_f32 v157, v26, v27
  v_mfma_f32_32x32x16_bf16 v[136:151], v[180:183], v[164:167], v[136:151]
  s_mov_b64 exec, s[82:83]
  ds_read_b128 v[176:179], v200 offset:2432
  ds_read_b128 v[180:183], v200 offset:3040
  s_mov_b64 exec, -1
  v_exp_f32 v28, v28
  v_exp_f32 v29, v29
  v_exp_f32 v30, v30
  v_exp_f32 v31, v31
  v_cvt_pk_bf16_f32 v158, v28, v29
  v_cvt_pk_bf16_f32 v159, v30, v31
  s_waitcnt lgkmcnt(2)
  v_mfma_f32_32x32x16_bf16 v[16:31], v[168:171], v[184:187], 0
  v_exp_f32 v32, v32
  v_exp_f32 v33, v33
  v_exp_f32 v34, v34
  v_exp_f32 v35, v35
  v_cvt_pk_bf16_f32 v160, v32, v33
  v_cvt_pk_bf16_f32 v161, v34, v35
  v_mfma_f32_32x32x8_bf16 v[16:31], v[172:173], v[188:189], v[16:31]
  v_exp_f32 v36, v36
  v_exp_f32 v37, v37
  v_exp_f32 v38, v38
  v_exp_f32 v39, v39
  v_cvt_pk_bf16_f32 v162, v36, v37
  v_cvt_pk_bf16_f32 v163, v38, v39
  s_waitcnt lgkmcnt(0)
  v_mfma_f32_32x32x16_bf16 v[48:63], v[176:179], v[152:155], v[48:63]
  v_exp_f32 v40, v40
  v_exp_f32 v41, v41
  v_exp_f32 v42, v42
  v_exp_f32 v43, v43
  v_cvt_pk_bf16_f32 v164, v40, v41
  v_cvt_pk_bf16_f32 v165, v42, v43
  v_mfma_f32_32x32x16_bf16 v[48:63], v[180:183], v[156:159], v[48:63]
  v_exp_f32 v44, v44
  v_exp_f32 v45, v45
  v_exp_f32 v46, v46
  v_exp_f32 v47, v47
  v_cvt_pk_bf16_f32 v166, v44, v45
  v_cvt_pk_bf16_f32 v167, v46, v47
  v_mfma_f32_32x32x16_bf16 v[32:47], v[168:171], v[192:195], 0
  v_exp_f32 v16, v16
  v_exp_f32 v17, v17
  v_exp_f32 v18, v18
  v_exp_f32 v19, v19
  v_cvt_pk_bf16_f32 v152, v16, v17
  v_cvt_pk_bf16_f32 v153, v18, v19
  v_mfma_f32_32x32x8_bf16 v[32:47], v[172:173], v[196:197], v[32:47]
  ds_read_b128 v[168:171], v198 offset:18944
  ds_read_b32 v172, v199 offset:18944
  v_exp_f32 v20, v20
  v_exp_f32 v21, v21
  v_exp_f32 v22, v22
  v_exp_f32 v23, v23
  v_cvt_pk_bf16_f32 v154, v20, v21
  v_cvt_pk_bf16_f32 v155, v22, v23
  v_mfma_f32_32x32x16_bf16 v[136:151], v[176:179], v[160:163], v[136:151]
  v_exp_f32 v24, v24
  v_exp_f32 v25, v25
  v_exp_f32 v26, v26
  v_exp_f32 v27, v27
  v_cvt_pk_bf16_f32 v156, v24, v25
  v_cvt_pk_bf16_f32 v157, v26, v27
  v_mfma_f32_32x32x16_bf16 v[136:151], v[180:183], v[164:167], v[136:151]
  s_mov_b64 exec, s[82:83]
  ds_read_b128 v[176:179], v200 offset:3648
  ds_read_b128 v[180:183], v200 offset:4256
  s_mov_b64 exec, -1
  v_exp_f32 v28, v28
  v_exp_f32 v29, v29
  v_exp_f32 v30, v30
  v_exp_f32 v31, v31
  v_cvt_pk_bf16_f32 v158, v28, v29
  v_cvt_pk_bf16_f32 v159, v30, v31
  s_waitcnt lgkmcnt(2)
  v_mfma_f32_32x32x16_bf16 v[16:31], v[168:171], v[184:187], 0
  v_exp_f32 v32, v32
  v_exp_f32 v33, v33
  v_exp_f32 v34, v34
  v_exp_f32 v35, v35
  v_cvt_pk_bf16_f32 v160, v32, v33
  v_cvt_pk_bf16_f32 v161, v34, v35
  v_mfma_f32_32x32x8_bf16 v[16:31], v[172:173], v[188:189], v[16:31]
  v_exp_f32 v36, v36
  v_exp_f32 v37, v37
  v_exp_f32 v38, v38
  v_exp_f32 v39, v39
  v_cvt_pk_bf16_f32 v162, v36, v37
  v_cvt_pk_bf16_f32 v163, v38, v39
  s_waitcnt lgkmcnt(0)
  v_mfma_f32_32x32x16_bf16 v[48:63], v[176:179], v[152:155], v[48:63]
  v_exp_f32 v40, v40
  v_exp_f32 v41, v41
  v_exp_f32 v42, v42
  v_exp_f32 v43, v43
  v_cvt_pk_bf16_f32 v164, v40, v41
  v_cvt_pk_bf16_f32 v165, v42, v43
  v_mfma_f32_32x32x16_bf16 v[48:63], v[180:183], v[156:159], v[48:63]
  v_exp_f32 v44, v44
  v_exp_f32 v45, v45
  v_exp_f32 v46, v46
  v_exp_f32 v47, v47
  v_cvt_pk_bf16_f32 v166, v44, v45
  v_cvt_pk_bf16_f32 v167, v46, v47
  v_add_u32 v198, 18944, v198
  v_add_u32 v199, 18944, v199
  v_add_u32 v200, 18944, v200
  s_add_u32 s52, s52, 1
  s_cmp_lt_u32 s52, 8
  s_cbranch_scc1 L_attn_main_70
  v_mfma_f32_32x32x16_bf16 v[136:151], v[176:179], v[160:163], v[136:151]
  v_mfma_f32_32x32x16_bf16 v[136:151], v[180:183], v[164:167], v[136:151]
  s_mov_b32 s53, 0x5d000000
  v_cmp_nlt_f32 vcc, v58, s53
  s_nop 9
  v_cmp_nlt_f32 s[54:55], v146, s53
  s_nop 3
  s_or_b64 vcc, vcc, s[54:55]
  s_cmp_eq_u32 vcc_lo, 0
  s_cbranch_scc1 L_nofl_111
  v_mov_b32 v4, 161920
  v_mov_b32 v5, 1
  ds_write_b32 v4, v5
L_nofl_111:
  s_cmp_ge_u32 s26, 4
  s_cbranch_scc1 L_give1_112
  ds_write_b128 v252, v[136:139] offset:0
  ds_write_b128 v252, v[140:143] offset:1024
  s_mov_b32 exec_hi, 0
  ds_write_b128 v252, v[144:147] offset:2048
  s_mov_b64 exec, -1
  s_branch L_gived_113
L_give1_112:
  ds_write_b128 v252, v[48:51] offset:0
  ds_write_b128 v252, v[52:55] offset:1024
  s_mov_b32 exec_hi, 0
  ds_write_b128 v252, v[56:59] offset:2048
  s_mov_b64 exec, -1
  v_mov_b32 v48, v136
  v_mov_b32 v49, v137
  v_mov_b32 v50, v138
  v_mov_b32 v51, v139
  v_mov_b32 v52, v140
  v_mov_b32 v53, v141
  v_mov_b32 v54, v142
  v_mov_b32 v55, v143
  v_mov_b32 v56, v144
  v_mov_b32 v57, v145
  v_mov_b32 v58, v146
  v_mov_b32 v59, v147
L_gived_113:
  v_mov_b32 v7, 161920
  s_waitcnt lgkmcnt(0)
  s_barrier
  ds_read_b32 v8, v7
  ds_read_b128 v[16:19], v253 offset:0
  ds_read_b128 v[20:23], v253 offset:1024
  ds_read_b128 v[24:27], v253 offset:2048
  s_waitcnt lgkmcnt(0)
  v_readfirstlane_b32 s50, v8
  s_cmp_lg_u32 s76, 0
  s_cbranch_scc1 L_fbgo_114
  s_nop 1
  s_cmp_eq_u32 s50, 0
  s_cbranch_scc1 L_fbgo_114
  s_mov_b32 s76, 1
  s_branch L_redo
L_fbgo_114:
  v_add_f32 v48, v48, v16
  v_add_f32 v49, v49, v17
  v_add_f32 v50, v50, v18
  v_add_f32 v51, v51, v19
  v_add_f32 v52, v52, v20
  v_add_f32 v53, v53, v21
  v_add_f32 v54, v54, v22
  v_add_f32 v55, v55, v23
  v_add_f32 v56, v56, v24
  v_add_f32 v57, v57, v25
  v_add_f32 v58, v58, v26
  v_mov_b32 v8, v58
  s_nop 1
  v_permlane32_swap_b32 v8, v58
  v_rcp_f32 v8, v8
  s_nop 0
  v_mul_f32 v48, v48, v8
  v_mul_f32 v49, v49, v8
  v_mul_f32 v50, v50, v8
  v_mul_f32 v51, v51, v8
  v_mul_f32 v52, v52, v8
  v_mul_f32 v53, v53, v8
  v_mul_f32 v54, v54, v8
  v_mul_f32 v55, v55, v8
  v_mul_f32 v56, v56, v8
  v_mul_f32 v57, v57, v8
  v_cvt_pk_bf16_f32 v16, v48, v49
  v_cvt_pk_bf16_f32 v17, v50, v51
  v_cvt_pk_bf16_f32 v18, v52, v53
  v_cvt_pk_bf16_f32 v19, v54, v55
  v_cvt_pk_bf16_f32 v20, v56, v57
  buffer_store_dwordx4 v[16:19], v203, s[28:31], s87 offen sc1
  s_mov_b32 exec_hi, 0
  buffer_store_dword v20, v202, s[28:31], s88 offen sc1
  s_mov_b64 exec, -1
  s_cmp_eq_u32 s45, 0
  s_cbranch_scc1 L_fi_back0
  s_cmp_lt_u32 s26, 2
  s_cbranch_scc1 L_p8e_lo_115
  s_cmp_lt_u32 s26, 6
  s_cbranch_scc1 L_fi_back0
  s_mov_b32 s62, 0
L_fi136:
  s_mul_i32 s57, s44, 9
  s_add_u32 s57, s57, s26
  s_lshl_b32 s50, s57, 4
  v_add_u32 v5, s50, v2
  s_mov_b32 s51, 7456541
  v_lshlrev_b32 v10, 2, v3
  v_mul_u32_u24 v10, v5, v10
  v_mul_hi_u32 v9, v10, s51
  v_mul_u32_u24 v9, 576, v9
  v_sub_u32 v10, v10, v9
  v_lshlrev_b32 v11, 4, v5
  v_mul_hi_u32 v9, v11, s51
  v_mul_u32_u24 v9, 576, v9
  v_sub_u32 v11, v11, v9
  v_sub_u32 v13, 576, v11
  v_mov_b32 v24, v10
  v_add_u32 v9, v10, v5
  v_subrev_u32 v8, 576, v9
  v_min_u32 v26, v9, v8
  v_add_u32 v9, v10, v13
  v_subrev_u32 v8, 576, v9
  v_min_u32 v28, v9, v8
  v_add_u32 v9, v28, v5
  v_subrev_u32 v8, 576, v9
  v_min_u32 v30, v9, v8
  v_add_u32 v9, 144, v24
  v_subrev_u32 v8, 576, v9
  v_min_u32 v25, v9, v8
  v_add_u32 v9, 144, v26
  v_subrev_u32 v8, 576, v9
  v_min_u32 v27, v9, v8
  v_add_u32 v9, 144, v28
  v_subrev_u32 v8, 576, v9
  v_min_u32 v29, v9, v8
  v_add_u32 v9, 144, v30
  v_subrev_u32 v8, 576, v9
  v_min_u32 v31, v9, v8
  v_mov_b32 v32, v5
  v_mov_b32 v33, v11
  v_cvt_f32_u32 v24, v24
  v_cvt_f32_u32 v25, v25
  v_cvt_f32_u32 v26, v26
  v_cvt_f32_u32 v27, v27
  v_cvt_f32_u32 v28, v28
  v_cvt_f32_u32 v29, v29
  v_cvt_f32_u32 v30, v30
  v_cvt_f32_u32 v31, v31
  v_cvt_f32_u32 v32, v32
  v_cvt_f32_u32 v33, v33
  v_mul_f32 v24, 0x3ae38e39, v24
  v_mul_f32 v25, 0x3ae38e39, v25
  v_mul_f32 v26, 0x3ae38e39, v26
  v_mul_f32 v27, 0x3ae38e39, v27
  v_mul_f32 v28, 0x3ae38e39, v28
  v_mul_f32 v29, 0x3ae38e39, v29
  v_mul_f32 v30, 0x3ae38e39, v30
  v_mul_f32 v31, 0x3ae38e39, v31
  v_mul_f32 v32, 0x3ae38e39, v32
  v_mul_f32 v33, 0x3ae38e39, v33
  v_cos_f32 v24, v24
  v_cos_f32 v25, v25
  v_cos_f32 v26, v26
  v_cos_f32 v27, v27
  v_cos_f32 v28, v28
  v_cos_f32 v29, v29
  v_cos_f32 v30, v30
  v_cos_f32 v31, v31
  v_cos_f32 v32, v32
  v_cos_f32 v33, v33
  v_mul_f32 v24, 0x3d715bef, v24
  v_mul_f32 v25, 0x3d715bef, v25
  v_mul_f32 v26, 0x3d715bef, v26
  v_mul_f32 v27, 0x3d715bef, v27
  v_mul_f32 v28, 0x3d715bef, v28
  v_mul_f32 v29, 0x3d715bef, v29
  v_mul_f32 v30, 0x3d715bef, v30
  v_mul_f32 v31, 0x3d715bef, v31
  v_add_f32 v32, v32, v32
  v_add_f32 v33, v33, v33
  v_pk_fma_f32 v[38:39], v[32:33], v[26:27], v[24:25] op_sel:[0,0,0] op_sel_hi:[0,1,1] neg_lo:[0,0,1] neg_hi:[0,0,1]
  v_pk_fma_f32 v[34:35], v[32:33], v[24:25], v[28:29] op_sel:[1,0,0] op_sel_hi:[1,1,1] neg_lo:[0,0,1] neg_hi:[0,0,1]
  v_cvt_pk_bf16_f32 v136, v24, v25
  v_pk_fma_f32 v[40:41], v[32:33], v[38:39], v[26:27] op_sel:[0,0,0] op_sel_hi:[0,1,1] neg_lo:[0,0,1] neg_hi:[0,0,1]
  v_pk_fma_f32 v[36:37], v[32:33], v[26:27], v[30:31] op_sel:[1,0,0] op_sel_hi:[1,1,1] neg_lo:[0,0,1] neg_hi:[0,0,1]
  v_cvt_pk_bf16_f32 v137, v26, v27
  v_cvt_pk_bf16_f32 v138, v38, v39
  v_cvt_pk_bf16_f32 v139, v40, v41
  v_pk_fma_f32 v[38:39], v[32:33], v[36:37], v[34:35] op_sel:[0,0,0] op_sel_hi:[0,1,1] neg_lo:[0,0,1] neg_hi:[0,0,1]
  v_pk_fma_f32 v[28:29], v[32:33], v[34:35], v[24:25] op_sel:[1,0,0] op_sel_hi:[1,1,1] neg_lo:[0,0,1] neg_hi:[0,0,1]
  v_cvt_pk_bf16_f32 v140, v34, v35
  v_pk_fma_f32 v[40:41], v[32:33], v[38:39], v[36:37] op_sel:[0,0,0] op_sel_hi:[0,1,1] neg_lo:[0,0,1] neg_hi:[0,0,1]
  v_pk_fma_f32 v[30:31], v[32:33], v[36:37], v[26:27] op_sel:[1,0,0] op_sel_hi:[1,1,1] neg_lo:[0,0,1] neg_hi:[0,0,1]
  v_cvt_pk_bf16_f32 v141, v36, v37
  v_cvt_pk_bf16_f32 v142, v38, v39
  v_cvt_pk_bf16_f32 v143, v40, v41
  v_pk_fma_f32 v[38:39], v[32:33], v[30:31], v[28:29] op_sel:[0,0,0] op_sel_hi:[0,1,1] neg_lo:[0,0,1] neg_hi:[0,0,1]
  v_pk_fma_f32 v[24:25], v[32:33], v[28:29], v[34:35] op_sel:[1,0,0] op_sel_hi:[1,1,1] neg_lo:[0,0,1] neg_hi:[0,0,1]
  v_cvt_pk_bf16_f32 v144, v28, v29
  v_pk_fma_f32 v[40:41], v[32:33], v[38:39], v[30:31] op_sel:[0,0,0] op_sel_hi:[0,1,1] neg_lo:[0,0,1] neg_hi:[0,0,1]
  v_pk_fma_f32 v[26:27], v[32:33], v[30:31], v[36:37] op_sel:[1,0,0] op_sel_hi:[1,1,1] neg_lo:[0,0,1] neg_hi:[0,0,1]
  v_cvt_pk_bf16_f32 v145, v30, v31
  v_cvt_pk_bf16_f32 v146, v38, v39
  v_cvt_pk_bf16_f32 v147, v40, v41
  v_pk_fma_f32 v[38:39], v[32:33], v[26:27], v[24:25] op_sel:[0,0,0] op_sel_hi:[0,1,1] neg_lo:[0,0,1] neg_hi:[0,0,1]
  v_pk_fma_f32 v[34:35], v[32:33], v[24:25], v[28:29] op_sel:[1,0,0] op_sel_hi:[1,1,1] neg_lo:[0,0,1] neg_hi:[0,0,1]
  v_cvt_pk_bf16_f32 v148, v24, v25
  v_pk_fma_f32 v[40:41], v[32:33], v[38:39], v[26:27] op_sel:[0,0,0] op_sel_hi:[0,1,1] neg_lo:[0,0,1] neg_hi:[0,0,1]
  v_pk_fma_f32 v[36:37], v[32:33], v[26:27], v[30:31] op_sel:[1,0,0] op_sel_hi:[1,1,1] neg_lo:[0,0,1] neg_hi:[0,0,1]
  v_cvt_pk_bf16_f32 v149, v26, v27
  v_cvt_pk_bf16_f32 v150, v38, v39
  v_cvt_pk_bf16_f32 v151, v40, v41
  v_pk_fma_f32 v[38:39], v[32:33], v[36:37], v[34:35] op_sel:[0,0,0] op_sel_hi:[0,1,1] neg_lo:[0,0,1] neg_hi:[0,0,1]
  v_pk_fma_f32 v[28:29], v[32:33], v[34:35], v[24:25] op_sel:[1,0,0] op_sel_hi:[1,1,1] neg_lo:[0,0,1] neg_hi:[0,0,1]
  v_cvt_pk_bf16_f32 v152, v34, v35
  v_pk_fma_f32 v[40:41], v[32:33], v[38:39], v[36:37] op_sel:[0,0,0] op_sel_hi:[0,1,1] neg_lo:[0,0,1] neg_hi:[0,0,1]
  v_pk_fma_f32 v[30:31], v[32:33], v[36:37], v[26:27] op_sel:[1,0,0] op_sel_hi:[1,1,1] neg_lo:[0,0,1] neg_hi:[0,0,1]
  v_cvt_pk_bf16_f32 v153, v36, v37
  v_cvt_pk_bf16_f32 v154, v38, v39
  v_cvt_pk_bf16_f32 v155, v40, v41
  v_pk_fma_f32 v[38:39], v[32:33], v[30:31], v[28:29] op_sel:[0,0,0] op_sel_hi:[0,1,1] neg_lo:[0,0,1] neg_hi:[0,0,1]
  v_pk_fma_f32 v[24:25], v[32:33], v[28:29], v[34:35] op_sel:[1,0,0] op_sel_hi:[1,1,1] neg_lo:[0,0,1] neg_hi:[0,0,1]
  v_cvt_pk_bf16_f32 v156, v28, v29
  v_pk_fma_f32 v[40:41], v[32:33], v[38:39], v[30:31] op_sel:[0,0,0] op_sel_hi:[0,1,1] neg_lo:[0,0,1] neg_hi:[0,0,1]
  v_pk_fma_f32 v[26:27], v[32:33], v[30:31], v[36:37] op_sel:[1,0,0] op_sel_hi:[1,1,1] neg_lo:[0,0,1] neg_hi:[0,0,1]
  v_cvt_pk_bf16_f32 v157, v30, v31
  v_cvt_pk_bf16_f32 v158, v38, v39
  v_cvt_pk_bf16_f32 v159, v40, v41
  v_pk_fma_f32 v[38:39], v[32:33], v[26:27], v[24:25] op_sel:[0,0,0] op_sel_hi:[0,1,1] neg_lo:[0,0,1] neg_hi:[0,0,1]
  v_pk_fma_f32 v[34:35], v[32:33], v[24:25], v[28:29] op_sel:[1,0,0] op_sel_hi:[1,1,1] neg_lo:[0,0,1] neg_hi:[0,0,1]
  v_cvt_pk_bf16_f32 v160, v24, v25
  v_pk_fma_f32 v[40:41], v[32:33], v[38:39], v[26:27] op_sel:[0,0,0] op_sel_hi:[0,1,1] neg_lo:[0,0,1] neg_hi:[0,0,1]
  v_pk_fma_f32 v[36:37], v[32:33], v[26:27], v[30:31] op_sel:[1,0,0] op_sel_hi:[1,1,1] neg_lo:[0,0,1] neg_hi:[0,0,1]
  v_cvt_pk_bf16_f32 v161, v26, v27
  v_cvt_pk_bf16_f32 v162, v38, v39
  v_cvt_pk_bf16_f32 v163, v40, v41
  v_pk_fma_f32 v[38:39], v[32:33], v[36:37], v[34:35] op_sel:[0,0,0] op_sel_hi:[0,1,1] neg_lo:[0,0,1] neg_hi:[0,0,1]
  v_pk_fma_f32 v[28:29], v[32:33], v[34:35], v[24:25] op_sel:[1,0,0] op_sel_hi:[1,1,1] neg_lo:[0,0,1] neg_hi:[0,0,1]
  v_cvt_pk_bf16_f32 v164, v34, v35
  v_pk_fma_f32 v[40:41], v[32:33], v[38:39], v[36:37] op_sel:[0,0,0] op_sel_hi:[0,1,1] neg_lo:[0,0,1] neg_hi:[0,0,1]
  v_pk_fma_f32 v[30:31], v[32:33], v[36:37], v[26:27] op_sel:[1,0,0] op_sel_hi:[1,1,1] neg_lo:[0,0,1] neg_hi:[0,0,1]
  v_cvt_pk_bf16_f32 v165, v36, v37
  v_cvt_pk_bf16_f32 v166, v38, v39
  v_cvt_pk_bf16_f32 v167, v40, v41
  v_pk_fma_f32 v[38:39], v[32:33], v[30:31], v[28:29] op_sel:[0,0,0] op_sel_hi:[0,1,1] neg_lo:[0,0,1] neg_hi:[0,0,1]
  v_pk_fma_f32 v[24:25], v[32:33], v[28:29], v[34:35] op_sel:[1,0,0] op_sel_hi:[1,1,1] neg_lo:[0,0,1] neg_hi:[0,0,1]
  v_cvt_pk_bf16_f32 v168, v28, v29
  v_pk_fma_f32 v[40:41], v[32:33], v[38:39], v[30:31] op_sel:[0,0,0] op_sel_hi:[0,1,1] neg_lo:[0,0,1] neg_hi:[0,0,1]
  v_pk_fma_f32 v[26:27], v[32:33], v[30:31], v[36:37] op_sel:[1,0,0] op_sel_hi:[1,1,1] neg_lo:[0,0,1] neg_hi:[0,0,1]
  v_cvt_pk_bf16_f32 v169, v30, v31
  v_cvt_pk_bf16_f32 v170, v38, v39
  v_cvt_pk_bf16_f32 v171, v40, v41
  v_pk_fma_f32 v[38:39], v[32:33], v[26:27], v[24:25] op_sel:[0,0,0] op_sel_hi:[0,1,1] neg_lo:[0,0,1] neg_hi:[0,0,1]
  v_pk_fma_f32 v[34:35], v[32:33], v[24:25], v[28:29] op_sel:[1,0,0] op_sel_hi:[1,1,1] neg_lo:[0,0,1] neg_hi:[0,0,1]
  v_cvt_pk_bf16_f32 v172, v24, v25
  v_pk_fma_f32 v[40:41], v[32:33], v[38:39], v[26:27] op_sel:[0,0,0] op_sel_hi:[0,1,1] neg_lo:[0,0,1] neg_hi:[0,0,1]
  v_pk_fma_f32 v[36:37], v[32:33], v[26:27], v[30:31] op_sel:[1,0,0] op_sel_hi:[1,1,1] neg_lo:[0,0,1] neg_hi:[0,0,1]
  v_cvt_pk_bf16_f32 v173, v26, v27
  v_cvt_pk_bf16_f32 v174, v38, v39
  v_cvt_pk_bf16_f32 v175, v40, v41
  v_pk_fma_f32 v[38:39], v[32:33], v[36:37], v[34:35] op_sel:[0,0,0] op_sel_hi:[0,1,1] neg_lo:[0,0,1] neg_hi:[0,0,1]
  v_pk_fma_f32 v[28:29], v[32:33], v[34:35], v[24:25] op_sel:[1,0,0] op_sel_hi:[1,1,1] neg_lo:[0,0,1] neg_hi:[0,0,1]
  v_cvt_pk_bf16_f32 v176, v34, v35
  v_pk_fma_f32 v[40:41], v[32:33], v[38:39], v[36:37] op_sel:[0,0,0] op_sel_hi:[0,1,1] neg_lo:[0,0,1] neg_hi:[0,0,1]
  v_pk_fma_f32 v[30:31], v[32:33], v[36:37], v[26:27] op_sel:[1,0,0] op_sel_hi:[1,1,1] neg_lo:[0,0,1] neg_hi:[0,0,1]
  v_cvt_pk_bf16_f32 v177, v36, v37
  v_cvt_pk_bf16_f32 v178, v38, v39
  v_cvt_pk_bf16_f32 v179, v40, v41
  v_pk_fma_f32 v[38:39], v[32:33], v[30:31], v[28:29] op_sel:[0,0,0] op_sel_hi:[0,1,1] neg_lo:[0,0,1] neg_hi:[0,0,1]
  v_pk_fma_f32 v[24:25], v[32:33], v[28:29], v[34:35] op_sel:[1,0,0] op_sel_hi:[1,1,1] neg_lo:[0,0,1] neg_hi:[0,0,1]
  v_cvt_pk_bf16_f32 v180, v28, v29
  v_pk_fma_f32 v[40:41], v[32:33], v[38:39], v[30:31] op_sel:[0,0,0] op_sel_hi:[0,1,1] neg_lo:[0,0,1] neg_hi:[0,0,1]
  v_pk_fma_f32 v[26:27], v[32:33], v[30:31], v[36:37] op_sel:[1,0,0] op_sel_hi:[1,1,1] neg_lo:[0,0,1] neg_hi:[0,0,1]
  v_cvt_pk_bf16_f32 v181, v30, v31
  v_cvt_pk_bf16_f32 v182, v38, v39
  v_cvt_pk_bf16_f32 v183, v40, v41
  v_pk_fma_f32 v[38:39], v[32:33], v[26:27], v[24:25] op_sel:[0,0,0] op_sel_hi:[0,1,1] neg_lo:[0,0,1] neg_hi:[0,0,1]
  v_pk_fma_f32 v[34:35], v[32:33], v[24:25], v[28:29] op_sel:[1,0,0] op_sel_hi:[1,1,1] neg_lo:[0,0,1] neg_hi:[0,0,1]
  v_cvt_pk_bf16_f32 v184, v24, v25
  v_pk_fma_f32 v[40:41], v[32:33], v[38:39], v[26:27] op_sel:[0,0,0] op_sel_hi:[0,1,1] neg_lo:[0,0,1] neg_hi:[0,0,1]
  v_pk_fma_f32 v[36:37], v[32:33], v[26:27], v[30:31] op_sel:[1,0,0] op_sel_hi:[1,1,1] neg_lo:[0,0,1] neg_hi:[0,0,1]
  v_cvt_pk_bf16_f32 v185, v26, v27
  v_cvt_pk_bf16_f32 v186, v38, v39
  v_cvt_pk_bf16_f32 v187, v40, v41
  v_pk_fma_f32 v[38:39], v[32:33], v[36:37], v[34:35] op_sel:[0,0,0] op_sel_hi:[0,1,1] neg_lo:[0,0,1] neg_hi:[0,0,1]
  v_pk_fma_f32 v[28:29], v[32:33], v[34:35], v[24:25] op_sel:[1,0,0] op_sel_hi:[1,1,1] neg_lo:[0,0,1] neg_hi:[0,0,1]
  v_cvt_pk_bf16_f32 v188, v34, v35
  v_pk_fma_f32 v[40:41], v[32:33], v[38:39], v[36:37] op_sel:[0,0,0] op_sel_hi:[0,1,1] neg_lo:[0,0,1] neg_hi:[0,0,1]
  v_pk_fma_f32 v[30:31], v[32:33], v[36:37], v[26:27] op_sel:[1,0,0] op_sel_hi:[1,1,1] neg_lo:[0,0,1] neg_hi:[0,0,1]
  v_cvt_pk_bf16_f32 v189, v36, v37
  v_cvt_pk_bf16_f32 v190, v38, v39
  v_cvt_pk_bf16_f32 v191, v40, v41
  v_pk_fma_f32 v[38:39], v[32:33], v[30:31], v[28:29] op_sel:[0,0,0] op_sel_hi:[0,1,1] neg_lo:[0,0,1] neg_hi:[0,0,1]
  v_pk_fma_f32 v[24:25], v[32:33], v[28:29], v[34:35] op_sel:[1,0,0] op_sel_hi:[1,1,1] neg_lo:[0,0,1] neg_hi:[0,0,1]
  v_cvt_pk_bf16_f32 v192, v28, v29
  v_pk_fma_f32 v[40:41], v[32:33], v[38:39], v[30:31] op_sel:[0,0,0] op_sel_hi:[0,1,1] neg_lo:[0,0,1] neg_hi:[0,0,1]
  v_pk_fma_f32 v[26:27], v[32:33], v[30:31], v[36:37] op_sel:[1,0,0] op_sel_hi:[1,1,1] neg_lo:[0,0,1] neg_hi:[0,0,1]
  v_cvt_pk_bf16_f32 v193, v30, v31
  v_cvt_pk_bf16_f32 v194, v38, v39
  v_cvt_pk_bf16_f32 v195, v40, v41
  v_pk_fma_f32 v[38:39], v[32:33], v[26:27], v[24:25] op_sel:[0,0,0] op_sel_hi:[0,1,1] neg_lo:[0,0,1] neg_hi:[0,0,1]
  v_pk_fma_f32 v[34:35], v[32:33], v[24:25], v[28:29] op_sel:[1,0,0] op_sel_hi:[1,1,1] neg_lo:[0,0,1] neg_hi:[0,0,1]
  v_cvt_pk_bf16_f32 v196, v24, v25
  v_pk_fma_f32 v[40:41], v[32:33], v[38:39], v[26:27] op_sel:[0,0,0] op_sel_hi:[0,1,1] neg_lo:[0,0,1] neg_hi:[0,0,1]
  v_pk_fma_f32 v[36:37], v[32:33], v[26:27], v[30:31] op_sel:[1,0,0] op_sel_hi:[1,1,1] neg_lo:[0,0,1] neg_hi:[0,0,1]
  v_cvt_pk_bf16_f32 v197, v26, v27
  v_cvt_pk_bf16_f32 v198, v38, v39
  v_cvt_pk_bf16_f32 v199, v40, v41
  v_pk_fma_f32 v[38:39], v[32:33], v[36:37], v[34:35] op_sel:[0,0,0] op_sel_hi:[0,1,1] neg_lo:[0,0,1] neg_hi:[0,0,1]
  v_pk_fma_f32 v[28:29], v[32:33], v[34:35], v[24:25] op_sel:[1,0,0] op_sel_hi:[1,1,1] neg_lo:[0,0,1] neg_hi:[0,0,1]
  v_cvt_pk_bf16_f32 v200, v34, v35
  v_pk_fma_f32 v[40:41], v[32:33], v[38:39], v[36:37] op_sel:[0,0,0] op_sel_hi:[0,1,1] neg_lo:[0,0,1] neg_hi:[0,0,1]
  v_pk_fma_f32 v[30:31], v[32:33], v[36:37], v[26:27] op_sel:[1,0,0] op_sel_hi:[1,1,1] neg_lo:[0,0,1] neg_hi:[0,0,1]
  v_cvt_pk_bf16_f32 v201, v36, v37
  v_cvt_pk_bf16_f32 v202, v38, v39
  v_cvt_pk_bf16_f32 v203, v40, v41
  v_pk_fma_f32 v[38:39], v[32:33], v[30:31], v[28:29] op_sel:[0,0,0] op_sel_hi:[0,1,1] neg_lo:[0,0,1] neg_hi:[0,0,1]
  v_cvt_pk_bf16_f32 v204, v28, v29
  v_pk_fma_f32 v[40:41], v[32:33], v[38:39], v[30:31] op_sel:[0,0,0] op_sel_hi:[0,1,1] neg_lo:[0,0,1] neg_hi:[0,0,1]
  v_cvt_pk_bf16_f32 v205, v30, v31
  v_cvt_pk_bf16_f32 v206, v38, v39
  v_cvt_pk_bf16_f32 v207, v40, v41
  v_and_b32 v8, 1, v5
  v_lshlrev_b32 v8, 15, v8
  v_xor_b32 v8, 0x3d2b3d2b, v8
  v_cmp_eq_u32 vcc, 0, v3
  s_nop 1
  v_cndmask_b32 v136, v136, v8, vcc
  s_cmp_lg_u32 s62, 0
  s_cbranch_scc1 L_fi_back1
  s_branch L_fi_back0
L_p8e_lo_115:
  s_mul_i32 s57, s44, 9
  s_add_u32 s57, s57, s26
  s_lshl_b32 s50, s57, 4
  v_add_u32 v5, s50, v2
  s_mov_b32 s51, 7456541
  v_lshlrev_b32 v10, 2, v3
  v_mul_u32_u24 v10, v5, v10
  v_mul_hi_u32 v9, v10, s51
  v_mul_u32_u24 v9, 576, v9
  v_sub_u32 v10, v10, v9
  v_lshlrev_b32 v11, 4, v5
  v_mul_hi_u32 v9, v11, s51
  v_mul_u32_u24 v9, 576, v9
  v_sub_u32 v11, v11, v9
  v_sub_u32 v13, 576, v11
  v_mov_b32 v24, v10
  v_add_u32 v9, v10, v5
  v_subrev_u32 v8, 576, v9
  v_min_u32 v26, v9, v8
  v_add_u32 v9, v10, v13
  v_subrev_u32 v8, 576, v9
  v_min_u32 v28, v9, v8
  v_add_u32 v9, v28, v5
  v_subrev_u32 v8, 576, v9
  v_min_u32 v30, v9, v8
  v_add_u32 v9, 144, v24
  v_subrev_u32 v8, 576, v9
  v_min_u32 v25, v9, v8
  v_add_u32 v9, 144, v26
  v_subrev_u32 v8, 576, v9
  v_min_u32 v27, v9, v8
  v_add_u32 v9, 144, v28
  v_subrev_u32 v8, 576, v9
  v_min_u32 v29, v9, v8
  v_add_u32 v9, 144, v30
  v_subrev_u32 v8, 576, v9
  v_min_u32 v31, v9, v8
  v_mov_b32 v32, v5
  v_mov_b32 v33, v11
  v_cvt_f32_u32 v24, v24
  v_cvt_f32_u32 v25, v25
  v_cvt_f32_u32 v26, v26
  v_cvt_f32_u32 v27, v27
  v_cvt_f32_u32 v28, v28
  v_cvt_f32_u32 v29, v29
  v_cvt_f32_u32 v30, v30
  v_cvt_f32_u32 v31, v31
  v_cvt_f32_u32 v32, v32
  v_cvt_f32_u32 v33, v33
  v_mul_f32 v24, 0x3ae38e39, v24
  v_mul_f32 v25, 0x3ae38e39, v25
  v_mul_f32 v26, 0x3ae38e39, v26
  v_mul_f32 v27, 0x3ae38e39, v27
  v_mul_f32 v28, 0x3ae38e39, v28
  v_mul_f32 v29, 0x3ae38e39, v29
  v_mul_f32 v30, 0x3ae38e39, v30
  v_mul_f32 v31, 0x3ae38e39, v31
  v_mul_f32 v32, 0x3ae38e39, v32
  v_mul_f32 v33, 0x3ae38e39, v33
  v_cos_f32 v24, v24
  v_cos_f32 v25, v25
  v_cos_f32 v26, v26
  v_cos_f32 v27, v27
  v_cos_f32 v28, v28
  v_cos_f32 v29, v29
  v_cos_f32 v30, v30
  v_cos_f32 v31, v31
  v_cos_f32 v32, v32
  v_cos_f32 v33, v33
  v_mul_f32 v24, 0x3d715bef, v24
  v_mul_f32 v25, 0x3d715bef, v25
  v_mul_f32 v26, 0x3d715bef, v26
  v_mul_f32 v27, 0x3d715bef, v27
  v_mul_f32 v28, 0x3d715bef, v28
  v_mul_f32 v29, 0x3d715bef, v29
  v_mul_f32 v30, 0x3d715bef, v30
  v_mul_f32 v31, 0x3d715bef, v31
  v_add_f32 v32, v32, v32
  v_add_f32 v33, v33, v33
  v_pk_fma_f32 v[38:39], v[32:33], v[26:27], v[24:25] op_sel:[0,0,0] op_sel_hi:[0,1,1] neg_lo:[0,0,1] neg_hi:[0,0,1]
  v_pk_fma_f32 v[34:35], v[32:33], v[24:25], v[28:29] op_sel:[1,0,0] op_sel_hi:[1,1,1] neg_lo:[0,0,1] neg_hi:[0,0,1]
  v_cvt_pk_bf16_f32 v64, v24, v25
  v_pk_fma_f32 v[40:41], v[32:33], v[38:39], v[26:27] op_sel:[0,0,0] op_sel_hi:[0,1,1] neg_lo:[0,0,1] neg_hi:[0,0,1]
  v_pk_fma_f32 v[36:37], v[32:33], v[26:27], v[30:31] op_sel:[1,0,0] op_sel_hi:[1,1,1] neg_lo:[0,0,1] neg_hi:[0,0,1]
  v_cvt_pk_bf16_f32 v65, v26, v27
  v_cvt_pk_bf16_f32 v66, v38, v39
  v_cvt_pk_bf16_f32 v67, v40, v41
  v_pk_fma_f32 v[38:39], v[32:33], v[36:37], v[34:35] op_sel:[0,0,0] op_sel_hi:[0,1,1] neg_lo:[0,0,1] neg_hi:[0,0,1]
  v_pk_fma_f32 v[28:29], v[32:33], v[34:35], v[24:25] op_sel:[1,0,0] op_sel_hi:[1,1,1] neg_lo:[0,0,1] neg_hi:[0,0,1]
  v_cvt_pk_bf16_f32 v68, v34, v35
  v_pk_fma_f32 v[40:41], v[32:33], v[38:39], v[36:37] op_sel:[0,0,0] op_sel_hi:[0,1,1] neg_lo:[0,0,1] neg_hi:[0,0,1]
  v_pk_fma_f32 v[30:31], v[32:33], v[36:37], v[26:27] op_sel:[1,0,0] op_sel_hi:[1,1,1] neg_lo:[0,0,1] neg_hi:[0,0,1]
  v_cvt_pk_bf16_f32 v69, v36, v37
  v_cvt_pk_bf16_f32 v70, v38, v39
  v_cvt_pk_bf16_f32 v71, v40, v41
  v_pk_fma_f32 v[38:39], v[32:33], v[30:31], v[28:29] op_sel:[0,0,0] op_sel_hi:[0,1,1] neg_lo:[0,0,1] neg_hi:[0,0,1]
  v_pk_fma_f32 v[24:25], v[32:33], v[28:29], v[34:35] op_sel:[1,0,0] op_sel_hi:[1,1,1] neg_lo:[0,0,1] neg_hi:[0,0,1]
  v_cvt_pk_bf16_f32 v72, v28, v29
  v_pk_fma_f32 v[40:41], v[32:33], v[38:39], v[30:31] op_sel:[0,0,0] op_sel_hi:[0,1,1] neg_lo:[0,0,1] neg_hi:[0,0,1]
  v_pk_fma_f32 v[26:27], v[32:33], v[30:31], v[36:37] op_sel:[1,0,0] op_sel_hi:[1,1,1] neg_lo:[0,0,1] neg_hi:[0,0,1]
  v_cvt_pk_bf16_f32 v73, v30, v31
  v_cvt_pk_bf16_f32 v74, v38, v39
  v_cvt_pk_bf16_f32 v75, v40, v41
  v_pk_fma_f32 v[38:39], v[32:33], v[26:27], v[24:25] op_sel:[0,0,0] op_sel_hi:[0,1,1] neg_lo:[0,0,1] neg_hi:[0,0,1]
  v_pk_fma_f32 v[34:35], v[32:33], v[24:25], v[28:29] op_sel:[1,0,0] op_sel_hi:[1,1,1] neg_lo:[0,0,1] neg_hi:[0,0,1]
  v_cvt_pk_bf16_f32 v76, v24, v25
  v_pk_fma_f32 v[40:41], v[32:33], v[38:39], v[26:27] op_sel:[0,0,0] op_sel_hi:[0,1,1] neg_lo:[0,0,1] neg_hi:[0,0,1]
  v_pk_fma_f32 v[36:37], v[32:33], v[26:27], v[30:31] op_sel:[1,0,0] op_sel_hi:[1,1,1] neg_lo:[0,0,1] neg_hi:[0,0,1]
  v_cvt_pk_bf16_f32 v77, v26, v27
  v_cvt_pk_bf16_f32 v78, v38, v39
  v_cvt_pk_bf16_f32 v79, v40, v41
  v_pk_fma_f32 v[38:39], v[32:33], v[36:37], v[34:35] op_sel:[0,0,0] op_sel_hi:[0,1,1] neg_lo:[0,0,1] neg_hi:[0,0,1]
  v_pk_fma_f32 v[28:29], v[32:33], v[34:35], v[24:25] op_sel:[1,0,0] op_sel_hi:[1,1,1] neg_lo:[0,0,1] neg_hi:[0,0,1]
  v_cvt_pk_bf16_f32 v80, v34, v35
  v_pk_fma_f32 v[40:41], v[32:33], v[38:39], v[36:37] op_sel:[0,0,0] op_sel_hi:[0,1,1] neg_lo:[0,0,1] neg_hi:[0,0,1]
  v_pk_fma_f32 v[30:31], v[32:33], v[36:37], v[26:27] op_sel:[1,0,0] op_sel_hi:[1,1,1] neg_lo:[0,0,1] neg_hi:[0,0,1]
  v_cvt_pk_bf16_f32 v81, v36, v37
  v_cvt_pk_bf16_f32 v82, v38, v39
  v_cvt_pk_bf16_f32 v83, v40, v41
  v_pk_fma_f32 v[38:39], v[32:33], v[30:31], v[28:29] op_sel:[0,0,0] op_sel_hi:[0,1,1] neg_lo:[0,0,1] neg_hi:[0,0,1]
  v_pk_fma_f32 v[24:25], v[32:33], v[28:29], v[34:35] op_sel:[1,0,0] op_sel_hi:[1,1,1] neg_lo:[0,0,1] neg_hi:[0,0,1]
  v_cvt_pk_bf16_f32 v84, v28, v29
  v_pk_fma_f32 v[40:41], v[32:33], v[38:39], v[30:31] op_sel:[0,0,0] op_sel_hi:[0,1,1] neg_lo:[0,0,1] neg_hi:[0,0,1]
  v_pk_fma_f32 v[26:27], v[32:33], v[30:31], v[36:37] op_sel:[1,0,0] op_sel_hi:[1,1,1] neg_lo:[0,0,1] neg_hi:[0,0,1]
  v_cvt_pk_bf16_f32 v85, v30, v31
  v_cvt_pk_bf16_f32 v86, v38, v39
  v_cvt_pk_bf16_f32 v87, v40, v41
  v_pk_fma_f32 v[38:39], v[32:33], v[26:27], v[24:25] op_sel:[0,0,0] op_sel_hi:[0,1,1] neg_lo:[0,0,1] neg_hi:[0,0,1]
  v_pk_fma_f32 v[34:35], v[32:33], v[24:25], v[28:29] op_sel:[1,0,0] op_sel_hi:[1,1,1] neg_lo:[0,0,1] neg_hi:[0,0,1]
  v_cvt_pk_bf16_f32 v88, v24, v25
  v_pk_fma_f32 v[40:41], v[32:33], v[38:39], v[26:27] op_sel:[0,0,0] op_sel_hi:[0,1,1] neg_lo:[0,0,1] neg_hi:[0,0,1]
  v_pk_fma_f32 v[36:37], v[32:33], v[26:27], v[30:31] op_sel:[1,0,0] op_sel_hi:[1,1,1] neg_lo:[0,0,1] neg_hi:[0,0,1]
  v_cvt_pk_bf16_f32 v89, v26, v27
  v_cvt_pk_bf16_f32 v90, v38, v39
  v_cvt_pk_bf16_f32 v91, v40, v41
  v_pk_fma_f32 v[38:39], v[32:33], v[36:37], v[34:35] op_sel:[0,0,0] op_sel_hi:[0,1,1] neg_lo:[0,0,1] neg_hi:[0,0,1]
  v_pk_fma_f32 v[28:29], v[32:33], v[34:35], v[24:25] op_sel:[1,0,0] op_sel_hi:[1,1,1] neg_lo:[0,0,1] neg_hi:[0,0,1]
  v_cvt_pk_bf16_f32 v92, v34, v35
  v_pk_fma_f32 v[40:41], v[32:33], v[38:39], v[36:37] op_sel:[0,0,0] op_sel_hi:[0,1,1] neg_lo:[0,0,1] neg_hi:[0,0,1]
  v_pk_fma_f32 v[30:31], v[32:33], v[36:37], v[26:27] op_sel:[1,0,0] op_sel_hi:[1,1,1] neg_lo:[0,0,1] neg_hi:[0,0,1]
  v_cvt_pk_bf16_f32 v93, v36, v37
  v_cvt_pk_bf16_f32 v94, v38, v39
  v_cvt_pk_bf16_f32 v95, v40, v41
  v_pk_fma_f32 v[38:39], v[32:33], v[30:31], v[28:29] op_sel:[0,0,0] op_sel_hi:[0,1,1] neg_lo:[0,0,1] neg_hi:[0,0,1]
  v_pk_fma_f32 v[24:25], v[32:33], v[28:29], v[34:35] op_sel:[1,0,0] op_sel_hi:[1,1,1] neg_lo:[0,0,1] neg_hi:[0,0,1]
  v_cvt_pk_bf16_f32 v96, v28, v29
  v_pk_fma_f32 v[40:41], v[32:33], v[38:39], v[30:31] op_sel:[0,0,0] op_sel_hi:[0,1,1] neg_lo:[0,0,1] neg_hi:[0,0,1]
  v_pk_fma_f32 v[26:27], v[32:33], v[30:31], v[36:37] op_sel:[1,0,0] op_sel_hi:[1,1,1] neg_lo:[0,0,1] neg_hi:[0,0,1]
  v_cvt_pk_bf16_f32 v97, v30, v31
  v_cvt_pk_bf16_f32 v98, v38, v39
  v_cvt_pk_bf16_f32 v99, v40, v41
  v_pk_fma_f32 v[38:39], v[32:33], v[26:27], v[24:25] op_sel:[0,0,0] op_sel_hi:[0,1,1] neg_lo:[0,0,1] neg_hi:[0,0,1]
  v_pk_fma_f32 v[34:35], v[32:33], v[24:25], v[28:29] op_sel:[1,0,0] op_sel_hi:[1,1,1] neg_lo:[0,0,1] neg_hi:[0,0,1]
  v_cvt_pk_bf16_f32 v100, v24, v25
  v_pk_fma_f32 v[40:41], v[32:33], v[38:39], v[26:27] op_sel:[0,0,0] op_sel_hi:[0,1,1] neg_lo:[0,0,1] neg_hi:[0,0,1]
  v_pk_fma_f32 v[36:37], v[32:33], v[26:27], v[30:31] op_sel:[1,0,0] op_sel_hi:[1,1,1] neg_lo:[0,0,1] neg_hi:[0,0,1]
  v_cvt_pk_bf16_f32 v101, v26, v27
  v_cvt_pk_bf16_f32 v102, v38, v39
  v_cvt_pk_bf16_f32 v103, v40, v41
  v_pk_fma_f32 v[38:39], v[32:33], v[36:37], v[34:35] op_sel:[0,0,0] op_sel_hi:[0,1,1] neg_lo:[0,0,1] neg_hi:[0,0,1]
  v_pk_fma_f32 v[28:29], v[32:33], v[34:35], v[24:25] op_sel:[1,0,0] op_sel_hi:[1,1,1] neg_lo:[0,0,1] neg_hi:[0,0,1]
  v_cvt_pk_bf16_f32 v104, v34, v35
  v_pk_fma_f32 v[40:41], v[32:33], v[38:39], v[36:37] op_sel:[0,0,0] op_sel_hi:[0,1,1] neg_lo:[0,0,1] neg_hi:[0,0,1]
  v_pk_fma_f32 v[30:31], v[32:33], v[36:37], v[26:27] op_sel:[1,0,0] op_sel_hi:[1,1,1] neg_lo:[0,0,1] neg_hi:[0,0,1]
  v_cvt_pk_bf16_f32 v105, v36, v37
  v_cvt_pk_bf16_f32 v106, v38, v39
  v_cvt_pk_bf16_f32 v107, v40, v41
  v_pk_fma_f32 v[38:39], v[32:33], v[30:31], v[28:29] op_sel:[0,0,0] op_sel_hi:[0,1,1] neg_lo:[0,0,1] neg_hi:[0,0,1]
  v_pk_fma_f32 v[24:25], v[32:33], v[28:29], v[34:35] op_sel:[1,0,0] op_sel_hi:[1,1,1] neg_lo:[0,0,1] neg_hi:[0,0,1]
  v_cvt_pk_bf16_f32 v108, v28, v29
  v_pk_fma_f32 v[40:41], v[32:33], v[38:39], v[30:31] op_sel:[0,0,0] op_sel_hi:[0,1,1] neg_lo:[0,0,1] neg_hi:[0,0,1]
  v_pk_fma_f32 v[26:27], v[32:33], v[30:31], v[36:37] op_sel:[1,0,0] op_sel_hi:[1,1,1] neg_lo:[0,0,1] neg_hi:[0,0,1]
  v_cvt_pk_bf16_f32 v109, v30, v31
  v_cvt_pk_bf16_f32 v110, v38, v39
  v_cvt_pk_bf16_f32 v111, v40, v41
  v_pk_fma_f32 v[38:39], v[32:33], v[26:27], v[24:25] op_sel:[0,0,0] op_sel_hi:[0,1,1] neg_lo:[0,0,1] neg_hi:[0,0,1]
  v_pk_fma_f32 v[34:35], v[32:33], v[24:25], v[28:29] op_sel:[1,0,0] op_sel_hi:[1,1,1] neg_lo:[0,0,1] neg_hi:[0,0,1]
  v_cvt_pk_bf16_f32 v112, v24, v25
  v_pk_fma_f32 v[40:41], v[32:33], v[38:39], v[26:27] op_sel:[0,0,0] op_sel_hi:[0,1,1] neg_lo:[0,0,1] neg_hi:[0,0,1]
  v_pk_fma_f32 v[36:37], v[32:33], v[26:27], v[30:31] op_sel:[1,0,0] op_sel_hi:[1,1,1] neg_lo:[0,0,1] neg_hi:[0,0,1]
  v_cvt_pk_bf16_f32 v113, v26, v27
  v_cvt_pk_bf16_f32 v114, v38, v39
  v_cvt_pk_bf16_f32 v115, v40, v41
  v_pk_fma_f32 v[38:39], v[32:33], v[36:37], v[34:35] op_sel:[0,0,0] op_sel_hi:[0,1,1] neg_lo:[0,0,1] neg_hi:[0,0,1]
  v_pk_fma_f32 v[28:29], v[32:33], v[34:35], v[24:25] op_sel:[1,0,0] op_sel_hi:[1,1,1] neg_lo:[0,0,1] neg_hi:[0,0,1]
  v_cvt_pk_bf16_f32 v116, v34, v35
  v_pk_fma_f32 v[40:41], v[32:33], v[38:39], v[36:37] op_sel:[0,0,0] op_sel_hi:[0,1,1] neg_lo:[0,0,1] neg_hi:[0,0,1]
  v_pk_fma_f32 v[30:31], v[32:33], v[36:37], v[26:27] op_sel:[1,0,0] op_sel_hi:[1,1,1] neg_lo:[0,0,1] neg_hi:[0,0,1]
  v_cvt_pk_bf16_f32 v117, v36, v37
  v_cvt_pk_bf16_f32 v118, v38, v39
  v_cvt_pk_bf16_f32 v119, v40, v41
  v_pk_fma_f32 v[38:39], v[32:33], v[30:31], v[28:29] op_sel:[0,0,0] op_sel_hi:[0,1,1] neg_lo:[0,0,1] neg_hi:[0,0,1]
  v_pk_fma_f32 v[24:25], v[32:33], v[28:29], v[34:35] op_sel:[1,0,0] op_sel_hi:[1,1,1] neg_lo:[0,0,1] neg_hi:[0,0,1]
  v_cvt_pk_bf16_f32 v120, v28, v29
  v_pk_fma_f32 v[40:41], v[32:33], v[38:39], v[30:31] op_sel:[0,0,0] op_sel_hi:[0,1,1] neg_lo:[0,0,1] neg_hi:[0,0,1]
  v_pk_fma_f32 v[26:27], v[32:33], v[30:31], v[36:37] op_sel:[1,0,0] op_sel_hi:[1,1,1] neg_lo:[0,0,1] neg_hi:[0,0,1]
  v_cvt_pk_bf16_f32 v121, v30, v31
  v_cvt_pk_bf16_f32 v122, v38, v39
  v_cvt_pk_bf16_f32 v123, v40, v41
  v_pk_fma_f32 v[38:39], v[32:33], v[26:27], v[24:25] op_sel:[0,0,0] op_sel_hi:[0,1,1] neg_lo:[0,0,1] neg_hi:[0,0,1]
  v_pk_fma_f32 v[34:35], v[32:33], v[24:25], v[28:29] op_sel:[1,0,0] op_sel_hi:[1,1,1] neg_lo:[0,0,1] neg_hi:[0,0,1]
  v_cvt_pk_bf16_f32 v124, v24, v25
  v_pk_fma_f32 v[40:41], v[32:33], v[38:39], v[26:27] op_sel:[0,0,0] op_sel_hi:[0,1,1] neg_lo:[0,0,1] neg_hi:[0,0,1]
  v_pk_fma_f32 v[36:37], v[32:33], v[26:27], v[30:31] op_sel:[1,0,0] op_sel_hi:[1,1,1] neg_lo:[0,0,1] neg_hi:[0,0,1]
  v_cvt_pk_bf16_f32 v125, v26, v27
  v_cvt_pk_bf16_f32 v126, v38, v39
  v_cvt_pk_bf16_f32 v127, v40, v41
  v_pk_fma_f32 v[38:39], v[32:33], v[36:37], v[34:35] op_sel:[0,0,0] op_sel_hi:[0,1,1] neg_lo:[0,0,1] neg_hi:[0,0,1]
  v_pk_fma_f32 v[28:29], v[32:33], v[34:35], v[24:25] op_sel:[1,0,0] op_sel_hi:[1,1,1] neg_lo:[0,0,1] neg_hi:[0,0,1]
  v_cvt_pk_bf16_f32 v128, v34, v35
  v_pk_fma_f32 v[40:41], v[32:33], v[38:39], v[36:37] op_sel:[0,0,0] op_sel_hi:[0,1,1] neg_lo:[0,0,1] neg_hi:[0,0,1]
  v_pk_fma_f32 v[30:31], v[32:33], v[36:37], v[26:27] op_sel:[1,0,0] op_sel_hi:[1,1,1] neg_lo:[0,0,1] neg_hi:[0,0,1]
  v_cvt_pk_bf16_f32 v129, v36, v37
  v_cvt_pk_bf16_f32 v130, v38, v39
  v_cvt_pk_bf16_f32 v131, v40, v41
  v_pk_fma_f32 v[38:39], v[32:33], v[30:31], v[28:29] op_sel:[0,0,0] op_sel_hi:[0,1,1] neg_lo:[0,0,1] neg_hi:[0,0,1]
  v_cvt_pk_bf16_f32 v132, v28, v29
  v_pk_fma_f32 v[40:41], v[32:33], v[38:39], v[30:31] op_sel:[0,0,0] op_sel_hi:[0,1,1] neg_lo:[0,0,1] neg_hi:[0,0,1]
  v_cvt_pk_bf16_f32 v133, v30, v31
  v_cvt_pk_bf16_f32 v134, v38, v39
  v_cvt_pk_bf16_f32 v135, v40, v41
  v_and_b32 v8, 1, v5
  v_lshlrev_b32 v8, 15, v8
  v_xor_b32 v8, 0x3d2b3d2b, v8
  v_cmp_eq_u32 vcc, 0, v3
  s_nop 1
  v_cndmask_b32 v64, v64, v8, vcc
L_fi_back0:
  s_waitcnt vmcnt(0) lgkmcnt(0)
  s_barrier
  s_cmp_lg_u32 s26, 0
  s_cbranch_scc1 L_arr_116
  s_lshl_b32 s48, s45, 14
  s_lshl_b32 s49, s27, 8
  s_add_u32 s48, s48, s49
  s_add_u32 s48, s48, 49152
  v_mov_b32 v4, s48
  v_mov_b32 v5, 1
  s_mov_b64 exec, 1
  buffer_atomic_add v5, v4, s[28:31], 0 offen sc1
  s_mov_b64 exec, -1
L_arr_116:
  s_cmp_lg_u32 s45, 0
  s_cbranch_scc1 L_last_117
  s_cmp_ge_u32 s26, 2
  s_cbranch_scc1 L_tw_done_118
  v_lshlrev_b32 v60, 4, v1
  s_mul_i32 s57, s44, 9
  s_add_u32 s57, s57, 8
  s_mul_i32 s57, s57, 18432
  s_add_u32 s57, s57, 12730368
  s_add_u32 s49, s57, 0
  buffer_load_dwordx4 v[136:139], v60, s[28:31], s49 offen sc1
  buffer_load_dwordx4 v[140:143], v60, s[28:31], s49 offen offset:1024 sc1
  buffer_load_dwordx4 v[144:147], v60, s[28:31], s49 offen offset:2048 sc1
  buffer_load_dwordx4 v[148:151], v60, s[28:31], s49 offen offset:3072 sc1
  s_add_u32 s49, s57, 4096
  buffer_load_dwordx4 v[152:155], v60, s[28:31], s49 offen sc1
  buffer_load_dwordx4 v[156:159], v60, s[28:31], s49 offen offset:1024 sc1
  buffer_load_dwordx4 v[160:163], v60, s[28:31], s49 offen offset:2048 sc1
  buffer_load_dwordx4 v[164:167], v60, s[28:31], s49 offen offset:3072 sc1
  s_add_u32 s49, s57, 8192
  buffer_load_dwordx4 v[168:171], v60, s[28:31], s49 offen sc1
  buffer_load_dwordx4 v[172:175], v60, s[28:31], s49 offen offset:1024 sc1
  buffer_load_dwordx4 v[176:179], v60, s[28:31], s49 offen offset:2048 sc1
  buffer_load_dwordx4 v[180:183], v60, s[28:31], s49 offen offset:3072 sc1
  s_add_u32 s49, s57, 12288
  buffer_load_dwordx4 v[184:187], v60, s[28:31], s49 offen sc1
  buffer_load_dwordx4 v[188:191], v60, s[28:31], s49 offen offset:1024 sc1
  buffer_load_dwordx4 v[192:195], v60, s[28:31], s49 offen offset:2048 sc1
  buffer_load_dwordx4 v[196:199], v60, s[28:31], s49 offen offset:3072 sc1
  s_add_u32 s49, s57, 16384
  buffer_load_dwordx4 v[200:203], v60, s[28:31], s49 offen sc1
  buffer_load_dwordx4 v[204:207], v60, s[28:31], s49 offen offset:1024 sc1
L_tw_done_118:
  s_cmp_lg_u32 s26, 7
  s_cbranch_scc1 L_wdone_119
  s_lshl_b32 s48, s45, 14
  s_lshl_b32 s49, s27, 8
  s_add_u32 s48, s48, s49
  s_add_u32 s48, s48, 49152
  v_mov_b32 v4, s48
  s_mov_b32 s48, 0
  s_setprio 3
  s_sleep 4
L_poll_120:
  buffer_load_dword v5, v4, s[28:31], 0 offen sc1
  s_waitcnt vmcnt(0)
  v_cmp_gt_u32 vcc, 4, v5
  s_add_u32 s48, s48, 1
  s_cmp_gt_u32 s48, 60000
  s_cbranch_scc1 L_wdone_119
  s_nop 1
  s_cbranch_vccz L_wdone_119
  s_sleep 4
  s_branch L_poll_120
L_wdone_119:
  s_setprio 0
  s_barrier
  v_lshlrev_b32 v60, 4, v1
  s_mul_i32 s54, s27, 36864
  s_add_u32 s54, s54, s74
  s_add_u32 s50, s26, 0
  s_lshl_b32 s50, s50, 10
  s_mov_b32 m0, s50
  s_add_u32 s50, s50, s54
  buffer_load_dwordx4 v60, s[28:31], s50 offen sc1 lds
  s_add_u32 s50, s26, 8
  s_lshl_b32 s50, s50, 10
  s_mov_b32 m0, s50
  s_add_u32 s50, s50, s54
  buffer_load_dwordx4 v60, s[28:31], s50 offen sc1 lds
  s_add_u32 s50, s26, 16
  s_lshl_b32 s50, s50, 10
  s_mov_b32 m0, s50
  s_add_u32 s50, s50, s54
  buffer_load_dwordx4 v60, s[28:31], s50 offen sc1 lds
  s_add_u32 s50, s26, 24
  s_lshl_b32 s50, s50, 10
  s_mov_b32 m0, s50
  s_add_u32 s50, s50, s54
  buffer_load_dwordx4 v60, s[28:31], s50 offen sc1 lds
  s_cmp_ge_u32 s26, 4
  s_cbranch_scc1 L_tdma_121
  s_add_u32 s50, s26, 32
  s_lshl_b32 s50, s50, 10
  s_mov_b32 m0, s50
  s_add_u32 s50, s50, s54
  buffer_load_dwordx4 v60, s[28:31], s50 offen sc1 lds
L_tdma_121:
  v_lshlrev_b32 v40, 16, v244
  v_and_b32 v41, 0xffff0000, v244
  v_lshlrev_b32 v42, 16, v245
  v_and_b32 v43, 0xffff0000, v245
  v_lshlrev_b32 v44, 16, v246
  v_and_b32 v45, 0xffff0000, v246
  v_lshlrev_b32 v46, 16, v247
  v_and_b32 v47, 0xffff0000, v247
  v_lshlrev_b32 v48, 16, v248
  v_and_b32 v49, 0xffff0000, v248
  v_lshlrev_b32 v50, 16, v249
  v_and_b32 v51, 0xffff0000, v249
  s_and_b32 s50, s26, 1
  s_mul_i32 s50, s50, 18432
  v_lshlrev_b32 v56, 4, v1
  v_add_u32 v57, 18432, v56
  v_subrev_u32 v57, s50, v57
  v_add_u32 v56, s50, v56
  s_mul_i32 s50, s27, 144
  s_mul_i32 s51, s44, 36
  s_add_u32 s50, s50, s51
  s_lshl_b32 s51, s26, 2
  s_add_u32 s51, s51, s50
  s_lshl_b32 s51, s51, 8
  s_add_u32 s80, s51, 4849664
  s_add_u32 s52, s50, 32
  s_lshl_b32 s52, s52, 8
  s_add_u32 s81, s52, 4849664
  s_lshl_b32 s50, s44, 13
  s_lshl_b32 s51, s27, 7
  s_add_u32 s50, s50, s51
  s_add_u32 s82, s50, 9601024
  s_and_b32 s53, s26, 1
  v_lshrrev_b32 v4, 1, v3
  v_xor_b32 v5, s53, v4
  v_lshlrev_b32 v6, 8, v3
  v_lshl_add_u32 v6, v2, 3, v6
  v_lshl_add_u32 v61, v5, 7, v6
  v_xor_b32 v62, 128, v61
  s_lshl_b32 s54, s26, 7
  s_lshl_b32 s55, s53, 6
  s_add_u32 s54, s54, s55
  s_add_u32 s54, s54, 161280
  v_lshlrev_b32 v63, 2, v2
  v_add_u32 v63, s54, v63
  s_waitcnt vmcnt(0)
  s_barrier
  s_cmp_ge_u32 s26, 2
  s_cbranch_scc1 L_g_noex_122
  ds_read_b128 v[16:19], v56 offset:0
  ds_read_b128 v[20:23], v57 offset:0
  ds_read_b128 v[24:27], v56 offset:1024
  ds_read_b128 v[28:31], v57 offset:1024
  ds_read_b128 v[32:35], v56 offset:2048
  ds_read_b128 v[36:39], v57 offset:2048
  s_waitcnt lgkmcnt(4)
  v_mfma_f32_16x16x32_bf16 v[40:43], v[64:67], v[16:19], v[40:43]
  v_mfma_f32_16x16x32_bf16 v[44:47], v[64:67], v[20:23], v[44:47]
  v_mfma_f32_16x16x32_bf16 v[48:51], v[136:139], v[16:19], v[48:51]
  ds_read_b128 v[16:19], v56 offset:3072
  ds_read_b128 v[20:23], v57 offset:3072
  s_waitcnt lgkmcnt(4)
  v_mfma_f32_16x16x32_bf16 v[40:43], v[68:71], v[24:27], v[40:43]
  v_mfma_f32_16x16x32_bf16 v[44:47], v[68:71], v[28:31], v[44:47]
  v_mfma_f32_16x16x32_bf16 v[48:51], v[140:143], v[24:27], v[48:51]
  ds_read_b128 v[24:27], v56 offset:4096
  ds_read_b128 v[28:31], v57 offset:4096
  s_waitcnt lgkmcnt(4)
  v_mfma_f32_16x16x32_bf16 v[40:43], v[72:75], v[32:35], v[40:43]
  v_mfma_f32_16x16x32_bf16 v[44:47], v[72:75], v[36:39], v[44:47]
  v_mfma_f32_16x16x32_bf16 v[48:51], v[144:147], v[32:35], v[48:51]
  ds_read_b128 v[32:35], v56 offset:5120
  ds_read_b128 v[36:39], v57 offset:5120
  s_waitcnt lgkmcnt(4)
  v_mfma_f32_16x16x32_bf16 v[40:43], v[76:79], v[16:19], v[40:43]
  v_mfma_f32_16x16x32_bf16 v[44:47], v[76:79], v[20:23], v[44:47]
  v_mfma_f32_16x16x32_bf16 v[48:51], v[148:151], v[16:19], v[48:51]
  ds_read_b128 v[16:19], v56 offset:6144
  ds_read_b128 v[20:23], v57 offset:6144
  s_waitcnt lgkmcnt(4)
  v_mfma_f32_16x16x32_bf16 v[40:43], v[80:83], v[24:27], v[40:43]
  v_mfma_f32_16x16x32_bf16 v[44:47], v[80:83], v[28:31], v[44:47]
  v_mfma_f32_16x16x32_bf16 v[48:51], v[152:155], v[24:27], v[48:51]
  ds_read_b128 v[24:27], v56 offset:7168
  ds_read_b128 v[28:31], v57 offset:7168
  s_waitcnt lgkmcnt(4)
  v_mfma_f32_16x16x32_bf16 v[40:43], v[84:87], v[32:35], v[40:43]
  v_mfma_f32_16x16x32_bf16 v[44:47], v[84:87], v[36:39], v[44:47]
  v_mfma_f32_16x16x32_bf16 v[48:51], v[156:159], v[32:35], v[48:51]
  ds_read_b128 v[32:35], v56 offset:8192
  ds_read_b128 v[36:39], v57 offset:8192
  s_waitcnt lgkmcnt(4)
  v_mfma_f32_16x16x32_bf16 v[40:43], v[88:91], v[16:19], v[40:43]
  v_mfma_f32_16x16x32_bf16 v[44:47], v[88:91], v[20:23], v[44:47]
  v_mfma_f32_16x16x32_bf16 v[48:51], v[160:163], v[16:19], v[48:51]
  ds_read_b128 v[16:19], v56 offset:9216
  ds_read_b128 v[20:23], v57 offset:9216
  s_waitcnt lgkmcnt(4)
  v_mfma_f32_16x16x32_bf16 v[40:43], v[92:95], v[24:27], v[40:43]
  v_mfma_f32_16x16x32_bf16 v[44:47], v[92:95], v[28:31], v[44:47]
  v_mfma_f32_16x16x32_bf16 v[48:51], v[164:167], v[24:27], v[48:51]
  ds_read_b128 v[24:27], v56 offset:10240
  ds_read_b128 v[28:31], v57 offset:10240
  s_waitcnt lgkmcnt(4)
  v_mfma_f32_16x16x32_bf16 v[40:43], v[96:99], v[32:35], v[40:43]
  v_mfma_f32_16x16x32_bf16 v[44:47], v[96:99], v[36:39], v[44:47]
  v_mfma_f32_16x16x32_bf16 v[48:51], v[168:171], v[32:35], v[48:51]
  ds_read_b128 v[32:35], v56 offset:11264
  ds_read_b128 v[36:39], v57 offset:11264
  s_waitcnt lgkmcnt(4)
  v_mfma_f32_16x16x32_bf16 v[40:43], v[100:103], v[16:19], v[40:43]
  v_mfma_f32_16x16x32_bf16 v[44:47], v[100:103], v[20:23], v[44:47]
  v_mfma_f32_16x16x32_bf16 v[48:51], v[172:175], v[16:19], v[48:51]
  ds_read_b128 v[16:19], v56 offset:12288
  ds_read_b128 v[20:23], v57 offset:12288
  s_waitcnt lgkmcnt(4)
  v_mfma_f32_16x16x32_bf16 v[40:43], v[104:107], v[24:27], v[40:43]
  v_mfma_f32_16x16x32_bf16 v[44:47], v[104:107], v[28:31], v[44:47]
  v_mfma_f32_16x16x32_bf16 v[48:51], v[176:179], v[24:27], v[48:51]
  ds_read_b128 v[24:27], v56 offset:13312
  ds_read_b128 v[28:31], v57 offset:13312
  s_waitcnt lgkmcnt(4)
  v_mfma_f32_16x16x32_bf16 v[40:43], v[108:111], v[32:35], v[40:43]
  v_mfma_f32_16x16x32_bf16 v[44:47], v[108:111], v[36:39], v[44:47]
  v_mfma_f32_16x16x32_bf16 v[48:51], v[180:183], v[32:35], v[48:51]
  ds_read_b128 v[32:35], v56 offset:14336
  ds_read_b128 v[36:39], v57 offset:14336
  s_waitcnt lgkmcnt(4)
  v_mfma_f32_16x16x32_bf16 v[40:43], v[112:115], v[16:19], v[40:43]
  v_mfma_f32_16x16x32_bf16 v[44:47], v[112:115], v[20:23], v[44:47]
  v_mfma_f32_16x16x32_bf16 v[48:51], v[184:187], v[16:19], v[48:51]
  ds_read_b128 v[16:19], v56 offset:15360
  ds_read_b128 v[20:23], v57 offset:15360
  s_waitcnt lgkmcnt(4)
  v_mfma_f32_16x16x32_bf16 v[40:43], v[116:119], v[24:27], v[40:43]
  v_mfma_f32_16x16x32_bf16 v[44:47], v[116:119], v[28:31], v[44:47]
  v_mfma_f32_16x16x32_bf16 v[48:51], v[188:191], v[24:27], v[48:51]
  ds_read_b128 v[24:27], v56 offset:16384
  ds_read_b128 v[28:31], v57 offset:16384
  s_waitcnt lgkmcnt(4)
  v_mfma_f32_16x16x32_bf16 v[40:43], v[120:123], v[32:35], v[40:43]
  v_mfma_f32_16x16x32_bf16 v[44:47], v[120:123], v[36:39], v[44:47]
  v_mfma_f32_16x16x32_bf16 v[48:51], v[192:195], v[32:35], v[48:51]
  ds_read_b128 v[32:35], v56 offset:17408
  ds_read_b128 v[36:39], v57 offset:17408
  s_waitcnt lgkmcnt(4)
  v_mfma_f32_16x16x32_bf16 v[40:43], v[124:127], v[16:19], v[40:43]
  v_mfma_f32_16x16x32_bf16 v[44:47], v[124:127], v[20:23], v[44:47]
  v_mfma_f32_16x16x32_bf16 v[48:51], v[196:199], v[16:19], v[48:51]
  s_waitcnt lgkmcnt(2)
  v_mfma_f32_16x16x32_bf16 v[40:43], v[128:131], v[24:27], v[40:43]
  v_mfma_f32_16x16x32_bf16 v[44:47], v[128:131], v[28:31], v[44:47]
  v_mfma_f32_16x16x32_bf16 v[48:51], v[200:203], v[24:27], v[48:51]
  s_waitcnt lgkmcnt(0)
  v_mfma_f32_16x16x32_bf16 v[40:43], v[132:135], v[32:35], v[40:43]
  v_mfma_f32_16x16x32_bf16 v[44:47], v[132:135], v[36:39], v[44:47]
  v_mfma_f32_16x16x32_bf16 v[48:51], v[204:207], v[32:35], v[48:51]
  s_branch L_g_done_123
L_g_noex_122:
  ds_read_b128 v[16:19], v56 offset:0
  ds_read_b128 v[20:23], v57 offset:0
  ds_read_b128 v[24:27], v56 offset:1024
  ds_read_b128 v[28:31], v57 offset:1024
  ds_read_b128 v[32:35], v56 offset:2048
  ds_read_b128 v[36:39], v57 offset:2048
  s_waitcnt lgkmcnt(4)
  v_mfma_f32_16x16x32_bf16 v[40:43], v[64:67], v[16:19], v[40:43]
  v_mfma_f32_16x16x32_bf16 v[44:47], v[64:67], v[20:23], v[44:47]
  ds_read_b128 v[16:19], v56 offset:3072
  ds_read_b128 v[20:23], v57 offset:3072
  s_waitcnt lgkmcnt(4)
  v_mfma_f32_16x16x32_bf16 v[40:43], v[68:71], v[24:27], v[40:43]
  v_mfma_f32_16x16x32_bf16 v[44:47], v[68:71], v[28:31], v[44:47]
  ds_read_b128 v[24:27], v56 offset:4096
  ds_read_b128 v[28:31], v57 offset:4096
  s_waitcnt lgkmcnt(4)
  v_mfma_f32_16x16x32_bf16 v[40:43], v[72:75], v[32:35], v[40:43]
  v_mfma_f32_16x16x32_bf16 v[44:47], v[72:75], v[36:39], v[44:47]
  ds_read_b128 v[32:35], v56 offset:5120
  ds_read_b128 v[36:39], v57 offset:5120
  s_waitcnt lgkmcnt(4)
  v_mfma_f32_16x16x32_bf16 v[40:43], v[76:79], v[16:19], v[40:43]
  v_mfma_f32_16x16x32_bf16 v[44:47], v[76:79], v[20:23], v[44:47]
  ds_read_b128 v[16:19], v56 offset:6144
  ds_read_b128 v[20:23], v57 offset:6144
  s_waitcnt lgkmcnt(4)
  v_mfma_f32_16x16x32_bf16 v[40:43], v[80:83], v[24:27], v[40:43]
  v_mfma_f32_16x16x32_bf16 v[44:47], v[80:83], v[28:31], v[44:47]
  ds_read_b128 v[24:27], v56 offset:7168
  ds_read_b128 v[28:31], v57 offset:7168
  s_waitcnt lgkmcnt(4)
  v_mfma_f32_16x16x32_bf16 v[40:43], v[84:87], v[32:35], v[40:43]
  v_mfma_f32_16x16x32_bf16 v[44:47], v[84:87], v[36:39], v[44:47]
  ds_read_b128 v[32:35], v56 offset:8192
  ds_read_b128 v[36:39], v57 offset:8192
  s_waitcnt lgkmcnt(4)
  v_mfma_f32_16x16x32_bf16 v[40:43], v[88:91], v[16:19], v[40:43]
  v_mfma_f32_16x16x32_bf16 v[44:47], v[88:91], v[20:23], v[44:47]
  ds_read_b128 v[16:19], v56 offset:9216
  ds_read_b128 v[20:23], v57 offset:9216
  s_waitcnt lgkmcnt(4)
  v_mfma_f32_16x16x32_bf16 v[40:43], v[92:95], v[24:27], v[40:43]
  v_mfma_f32_16x16x32_bf16 v[44:47], v[92:95], v[28:31], v[44:47]
  ds_read_b128 v[24:27], v56 offset:10240
  ds_read_b128 v[28:31], v57 offset:10240
  s_waitcnt lgkmcnt(4)
  v_mfma_f32_16x16x32_bf16 v[40:43], v[96:99], v[32:35], v[40:43]
  v_mfma_f32_16x16x32_bf16 v[44:47], v[96:99], v[36:39], v[44:47]
  ds_read_b128 v[32:35], v56 offset:11264
  ds_read_b128 v[36:39], v57 offset:11264
  s_waitcnt lgkmcnt(4)
  v_mfma_f32_16x16x32_bf16 v[40:43], v[100:103], v[16:19], v[40:43]
  v_mfma_f32_16x16x32_bf16 v[44:47], v[100:103], v[20:23], v[44:47]
  ds_read_b128 v[16:19], v56 offset:12288
  ds_read_b128 v[20:23], v57 offset:12288
  s_waitcnt lgkmcnt(4)
  v_mfma_f32_16x16x32_bf16 v[40:43], v[104:107], v[24:27], v[40:43]
  v_mfma_f32_16x16x32_bf16 v[44:47], v[104:107], v[28:31], v[44:47]
  ds_read_b128 v[24:27], v56 offset:13312
  ds_read_b128 v[28:31], v57 offset:13312
  s_waitcnt lgkmcnt(4)
  v_mfma_f32_16x16x32_bf16 v[40:43], v[108:111], v[32:35], v[40:43]
  v_mfma_f32_16x16x32_bf16 v[44:47], v[108:111], v[36:39], v[44:47]
  ds_read_b128 v[32:35], v56 offset:14336
  ds_read_b128 v[36:39], v57 offset:14336
  s_waitcnt lgkmcnt(4)
  v_mfma_f32_16x16x32_bf16 v[40:43], v[112:115], v[16:19], v[40:43]
  v_mfma_f32_16x16x32_bf16 v[44:47], v[112:115], v[20:23], v[44:47]
  ds_read_b128 v[16:19], v56 offset:15360
  ds_read_b128 v[20:23], v57 offset:15360
  s_waitcnt lgkmcnt(4)
  v_mfma_f32_16x16x32_bf16 v[40:43], v[116:119], v[24:27], v[40:43]
  v_mfma_f32_16x16x32_bf16 v[44:47], v[116:119], v[28:31], v[44:47]
  ds_read_b128 v[24:27], v56 offset:16384
  ds_read_b128 v[28:31], v57 offset:16384
  s_waitcnt lgkmcnt(4)
  v_mfma_f32_16x16x32_bf16 v[40:43], v[120:123], v[32:35], v[40:43]
  v_mfma_f32_16x16x32_bf16 v[44:47], v[120:123], v[36:39], v[44:47]
  ds_read_b128 v[32:35], v56 offset:17408
  ds_read_b128 v[36:39], v57 offset:17408
  s_waitcnt lgkmcnt(4)
  v_mfma_f32_16x16x32_bf16 v[40:43], v[124:127], v[16:19], v[40:43]
  v_mfma_f32_16x16x32_bf16 v[44:47], v[124:127], v[20:23], v[44:47]
  s_waitcnt lgkmcnt(2)
  v_mfma_f32_16x16x32_bf16 v[40:43], v[128:131], v[24:27], v[40:43]
  v_mfma_f32_16x16x32_bf16 v[44:47], v[128:131], v[28:31], v[44:47]
  s_waitcnt lgkmcnt(0)
  v_mfma_f32_16x16x32_bf16 v[40:43], v[132:135], v[32:35], v[40:43]
  v_mfma_f32_16x16x32_bf16 v[44:47], v[132:135], v[36:39], v[44:47]
L_g_done_123:
  s_nop 6
  v_mul_f32 v9, v40, v40
  v_mul_f32 v10, v44, v44
  v_mul_f32 v11, v41, v41
  v_mul_f32 v12, v45, v45
  s_or_b32 s53, s44, s26
  s_cmp_lg_u32 s53, 0
  s_cbranch_scc1 L_nodc_124
  v_cmp_eq_u32 vcc, 0, v3
  v_mov_b32 v13, 0
  s_nop 0
  v_cndmask_b32 v11, v11, v13, vcc
  v_cndmask_b32 v12, v12, v13, vcc
L_nodc_124:
  v_add_f32 v9, v9, v11
  v_add_f32 v10, v10, v12
  v_fmac_f32 v9, v42, v42
  v_fmac_f32 v10, v46, v46
  v_fmac_f32 v9, v43, v43
  v_fmac_f32 v10, v47, v47
  v_mov_b32 v11, v9
  v_mov_b32 v12, v10
  v_cvt_pk_bf16_f32 v14, v40, v41
  v_cvt_pk_bf16_f32 v15, v42, v43
  v_permlane16_swap_b32 v11, v9
  v_permlane16_swap_b32 v12, v10
  v_add_f32 v9, v9, v11
  v_add_f32 v10, v10, v12
  v_mov_b32 v11, v9
  v_mov_b32 v12, v10
  v_cvt_pk_bf16_f32 v52, v44, v45
  v_cvt_pk_bf16_f32 v53, v46, v47
  v_permlane32_swap_b32 v11, v9
  v_permlane32_swap_b32 v12, v10
  v_add_f32 v9, v9, v11
  v_add_f32 v10, v10, v12
  v_xor_b32 v12, 64, v63
  ds_write_b32 v63, v9
  ds_write_b32 v12, v10
  buffer_store_dwordx2 v[14:15], v61, s[28:31], s80 offen sc1
  buffer_store_dwordx2 v[52:53], v62, s[28:31], s80 offen sc1
  s_cmp_ge_u32 s26, 2
  s_cbranch_scc1 L_ep_noex_125
  v_mul_f32 v9, v48, v48
  v_fmac_f32 v9, v49, v49
  v_fmac_f32 v9, v50, v50
  v_fmac_f32 v9, v51, v51
  v_cvt_pk_bf16_f32 v54, v48, v49
  v_cvt_pk_bf16_f32 v55, v50, v51
  v_mov_b32 v13, v9
  s_nop 1
  v_permlane16_swap_b32 v13, v9
  v_add_f32 v9, v9, v13
  v_mov_b32 v13, v9
  s_nop 1
  v_permlane32_swap_b32 v13, v9
  v_add_f32 v9, v9, v13
  s_lshl_b32 s55, s26, 6
  s_add_u32 s55, s55, 162304
  v_lshlrev_b32 v11, 2, v2
  v_add_u32 v11, s55, v11
  ds_write_b32 v11, v9
  buffer_store_dwordx2 v[54:55], v61, s[28:31], s81 offen sc1
L_ep_noex_125:
  s_waitcnt lgkmcnt(0)
  s_barrier
  s_cmp_lg_u32 s26, 7
  s_cbranch_scc1 L_ep_fin_126
  v_and_b32 v4, 31, v1
  v_lshlrev_b32 v4, 2, v4
  v_add_u32 v14, 161280, v4
  ds_read_b32 v5, v14 offset:0
  ds_read_b32 v6, v14 offset:128
  ds_read_b32 v7, v14 offset:256
  ds_read_b32 v8, v14 offset:384
  ds_read_b32 v9, v14 offset:512
  ds_read_b32 v10, v14 offset:640
  ds_read_b32 v11, v14 offset:768
  ds_read_b32 v12, v14 offset:896
  ds_read_b32 v13, v14 offset:1024
  s_waitcnt lgkmcnt(0)
  v_add_f32 v5, v5, v6
  v_add_f32 v5, v5, v7
  v_add_f32 v5, v5, v8
  v_add_f32 v5, v5, v9
  v_add_f32 v5, v5, v10
  v_add_f32 v5, v5, v11
  v_add_f32 v5, v5, v12
  v_add_f32 v5, v5, v13
  s_mov_b32 exec_hi, 0
  buffer_store_dword v5, v4, s[28:31], s82 offen sc1
  s_mov_b64 exec, -1
L_ep_fin_126:
  s_waitcnt vmcnt(0) lgkmcnt(0)
  s_barrier
  s_cmp_lg_u32 s26, 0
  s_cbranch_scc1 L_arr_127
  s_mov_b32 s48, 24576
  s_and_b32 s49, s2, 31
  s_lshl_b32 s49, s49, 8
  s_add_u32 s48, s48, s49
  v_mov_b32 v4, s48
  v_mov_b32 v5, 1
  s_mov_b64 exec, 1
  buffer_atomic_add v5, v4, s[28:31], 0 offen sc1
  s_mov_b64 exec, -1
L_arr_127:
  s_mov_b32 s45, 1
  s_branch L_layer
L_last_117:
  v_lshlrev_b32 v60, 4, v1
  s_mul_i32 s54, s27, 36864
  s_add_u32 s54, s54, s72
  s_add_u32 s50, s26, 0
  s_lshl_b32 s50, s50, 10
  s_add_u32 m0, s50, 40960
  s_add_u32 s50, s50, s54
  buffer_load_dwordx4 v60, s[28:31], s50 offen sc1 lds
  s_add_u32 s50, s26, 8
  s_lshl_b32 s50, s50, 10
  s_add_u32 m0, s50, 40960
  s_add_u32 s50, s50, s54
  buffer_load_dwordx4 v60, s[28:31], s50 offen sc1 lds
  s_add_u32 s50, s26, 16
  s_lshl_b32 s50, s50, 10
  s_add_u32 m0, s50, 40960
  s_add_u32 s50, s50, s54
  buffer_load_dwordx4 v60, s[28:31], s50 offen sc1 lds
  s_add_u32 s50, s26, 24
  s_lshl_b32 s50, s50, 10
  s_add_u32 m0, s50, 40960
  s_add_u32 s50, s50, s54
  buffer_load_dwordx4 v60, s[28:31], s50 offen sc1 lds
  s_cmp_ge_u32 s26, 4
  s_cbranch_scc1 L_tdma_128
  s_add_u32 s50, s26, 32
  s_lshl_b32 s50, s50, 10
  s_add_u32 m0, s50, 40960
  s_add_u32 s50, s50, s54
  buffer_load_dwordx4 v60, s[28:31], s50 offen sc1 lds
L_tdma_128:
  s_cmp_ge_u32 s26, 6
  s_cbranch_scc1 L_fi_back1
  s_cmp_lt_u32 s26, 2
  s_cbranch_scc1 L_p8p_lo_129
  s_mov_b32 s62, 1
  s_branch L_fi136
L_p8p_lo_129:
  s_mul_i32 s57, s44, 9
  s_add_u32 s57, s57, 8
  s_lshl_b32 s50, s57, 4
  v_add_u32 v5, s50, v2
  s_mov_b32 s51, 7456541
  v_lshlrev_b32 v10, 2, v3
  v_mul_u32_u24 v10, v5, v10
  v_mul_hi_u32 v9, v10, s51
  v_mul_u32_u24 v9, 576, v9
  v_sub_u32 v10, v10, v9
  v_lshlrev_b32 v11, 4, v5
  v_mul_hi_u32 v9, v11, s51
  v_mul_u32_u24 v9, 576, v9
  v_sub_u32 v11, v11, v9
  v_sub_u32 v13, 576, v11
  v_mov_b32 v24, v10
  v_add_u32 v9, v10, v5
  v_subrev_u32 v8, 576, v9
  v_min_u32 v26, v9, v8
  v_add_u32 v9, v10, v13
  v_subrev_u32 v8, 576, v9
  v_min_u32 v28, v9, v8
  v_add_u32 v9, v28, v5
  v_subrev_u32 v8, 576, v9
  v_min_u32 v30, v9, v8
  v_add_u32 v9, 144, v24
  v_subrev_u32 v8, 576, v9
  v_min_u32 v25, v9, v8
  v_add_u32 v9, 144, v26
  v_subrev_u32 v8, 576, v9
  v_min_u32 v27, v9, v8
  v_add_u32 v9, 144, v28
  v_subrev_u32 v8, 576, v9
  v_min_u32 v29, v9, v8
  v_add_u32 v9, 144, v30
  v_subrev_u32 v8, 576, v9
  v_min_u32 v31, v9, v8
  v_mov_b32 v32, v5
  v_mov_b32 v33, v11
  v_cvt_f32_u32 v24, v24
  v_cvt_f32_u32 v25, v25
  v_cvt_f32_u32 v26, v26
  v_cvt_f32_u32 v27, v27
  v_cvt_f32_u32 v28, v28
  v_cvt_f32_u32 v29, v29
  v_cvt_f32_u32 v30, v30
  v_cvt_f32_u32 v31, v31
  v_cvt_f32_u32 v32, v32
  v_cvt_f32_u32 v33, v33
  v_mul_f32 v24, 0x3ae38e39, v24
  v_mul_f32 v25, 0x3ae38e39, v25
  v_mul_f32 v26, 0x3ae38e39, v26
  v_mul_f32 v27, 0x3ae38e39, v27
  v_mul_f32 v28, 0x3ae38e39, v28
  v_mul_f32 v29, 0x3ae38e39, v29
  v_mul_f32 v30, 0x3ae38e39, v30
  v_mul_f32 v31, 0x3ae38e39, v31
  v_mul_f32 v32, 0x3ae38e39, v32
  v_mul_f32 v33, 0x3ae38e39, v33
  v_cos_f32 v24, v24
  v_cos_f32 v25, v25
  v_cos_f32 v26, v26
  v_cos_f32 v27, v27
  v_cos_f32 v28, v28
  v_cos_f32 v29, v29
  v_cos_f32 v30, v30
  v_cos_f32 v31, v31
  v_cos_f32 v32, v32
  v_cos_f32 v33, v33
  v_mul_f32 v24, 0x3d715bef, v24
  v_mul_f32 v25, 0x3d715bef, v25
  v_mul_f32 v26, 0x3d715bef, v26
  v_mul_f32 v27, 0x3d715bef, v27
  v_mul_f32 v28, 0x3d715bef, v28
  v_mul_f32 v29, 0x3d715bef, v29
  v_mul_f32 v30, 0x3d715bef, v30
  v_mul_f32 v31, 0x3d715bef, v31
  v_add_f32 v32, v32, v32
  v_add_f32 v33, v33, v33
  v_pk_fma_f32 v[38:39], v[32:33], v[26:27], v[24:25] op_sel:[0,0,0] op_sel_hi:[0,1,1] neg_lo:[0,0,1] neg_hi:[0,0,1]
  v_pk_fma_f32 v[34:35], v[32:33], v[24:25], v[28:29] op_sel:[1,0,0] op_sel_hi:[1,1,1] neg_lo:[0,0,1] neg_hi:[0,0,1]
  v_cvt_pk_bf16_f32 v136, v24, v25
  v_pk_fma_f32 v[40:41], v[32:33], v[38:39], v[26:27] op_sel:[0,0,0] op_sel_hi:[0,1,1] neg_lo:[0,0,1] neg_hi:[0,0,1]
  v_pk_fma_f32 v[36:37], v[32:33], v[26:27], v[30:31] op_sel:[1,0,0] op_sel_hi:[1,1,1] neg_lo:[0,0,1] neg_hi:[0,0,1]
  v_cvt_pk_bf16_f32 v137, v26, v27
  v_cvt_pk_bf16_f32 v138, v38, v39
  v_cvt_pk_bf16_f32 v139, v40, v41
  v_pk_fma_f32 v[38:39], v[32:33], v[36:37], v[34:35] op_sel:[0,0,0] op_sel_hi:[0,1,1] neg_lo:[0,0,1] neg_hi:[0,0,1]
  v_pk_fma_f32 v[28:29], v[32:33], v[34:35], v[24:25] op_sel:[1,0,0] op_sel_hi:[1,1,1] neg_lo:[0,0,1] neg_hi:[0,0,1]
  v_cvt_pk_bf16_f32 v140, v34, v35
  v_pk_fma_f32 v[40:41], v[32:33], v[38:39], v[36:37] op_sel:[0,0,0] op_sel_hi:[0,1,1] neg_lo:[0,0,1] neg_hi:[0,0,1]
  v_pk_fma_f32 v[30:31], v[32:33], v[36:37], v[26:27] op_sel:[1,0,0] op_sel_hi:[1,1,1] neg_lo:[0,0,1] neg_hi:[0,0,1]
  v_cvt_pk_bf16_f32 v141, v36, v37
  v_cvt_pk_bf16_f32 v142, v38, v39
  v_cvt_pk_bf16_f32 v143, v40, v41
  v_pk_fma_f32 v[38:39], v[32:33], v[30:31], v[28:29] op_sel:[0,0,0] op_sel_hi:[0,1,1] neg_lo:[0,0,1] neg_hi:[0,0,1]
  v_pk_fma_f32 v[24:25], v[32:33], v[28:29], v[34:35] op_sel:[1,0,0] op_sel_hi:[1,1,1] neg_lo:[0,0,1] neg_hi:[0,0,1]
  v_cvt_pk_bf16_f32 v144, v28, v29
  v_pk_fma_f32 v[40:41], v[32:33], v[38:39], v[30:31] op_sel:[0,0,0] op_sel_hi:[0,1,1] neg_lo:[0,0,1] neg_hi:[0,0,1]
  v_pk_fma_f32 v[26:27], v[32:33], v[30:31], v[36:37] op_sel:[1,0,0] op_sel_hi:[1,1,1] neg_lo:[0,0,1] neg_hi:[0,0,1]
  v_cvt_pk_bf16_f32 v145, v30, v31
  v_cvt_pk_bf16_f32 v146, v38, v39
  v_cvt_pk_bf16_f32 v147, v40, v41
  v_pk_fma_f32 v[38:39], v[32:33], v[26:27], v[24:25] op_sel:[0,0,0] op_sel_hi:[0,1,1] neg_lo:[0,0,1] neg_hi:[0,0,1]
  v_pk_fma_f32 v[34:35], v[32:33], v[24:25], v[28:29] op_sel:[1,0,0] op_sel_hi:[1,1,1] neg_lo:[0,0,1] neg_hi:[0,0,1]
  v_cvt_pk_bf16_f32 v148, v24, v25
  v_pk_fma_f32 v[40:41], v[32:33], v[38:39], v[26:27] op_sel:[0,0,0] op_sel_hi:[0,1,1] neg_lo:[0,0,1] neg_hi:[0,0,1]
  v_pk_fma_f32 v[36:37], v[32:33], v[26:27], v[30:31] op_sel:[1,0,0] op_sel_hi:[1,1,1] neg_lo:[0,0,1] neg_hi:[0,0,1]
  v_cvt_pk_bf16_f32 v149, v26, v27
  v_cvt_pk_bf16_f32 v150, v38, v39
  v_cvt_pk_bf16_f32 v151, v40, v41
  v_pk_fma_f32 v[38:39], v[32:33], v[36:37], v[34:35] op_sel:[0,0,0] op_sel_hi:[0,1,1] neg_lo:[0,0,1] neg_hi:[0,0,1]
  v_pk_fma_f32 v[28:29], v[32:33], v[34:35], v[24:25] op_sel:[1,0,0] op_sel_hi:[1,1,1] neg_lo:[0,0,1] neg_hi:[0,0,1]
  v_cvt_pk_bf16_f32 v152, v34, v35
  v_pk_fma_f32 v[40:41], v[32:33], v[38:39], v[36:37] op_sel:[0,0,0] op_sel_hi:[0,1,1] neg_lo:[0,0,1] neg_hi:[0,0,1]
  v_pk_fma_f32 v[30:31], v[32:33], v[36:37], v[26:27] op_sel:[1,0,0] op_sel_hi:[1,1,1] neg_lo:[0,0,1] neg_hi:[0,0,1]
  v_cvt_pk_bf16_f32 v153, v36, v37
  v_cvt_pk_bf16_f32 v154, v38, v39
  v_cvt_pk_bf16_f32 v155, v40, v41
  v_pk_fma_f32 v[38:39], v[32:33], v[30:31], v[28:29] op_sel:[0,0,0] op_sel_hi:[0,1,1] neg_lo:[0,0,1] neg_hi:[0,0,1]
  v_pk_fma_f32 v[24:25], v[32:33], v[28:29], v[34:35] op_sel:[1,0,0] op_sel_hi:[1,1,1] neg_lo:[0,0,1] neg_hi:[0,0,1]
  v_cvt_pk_bf16_f32 v156, v28, v29
  v_pk_fma_f32 v[40:41], v[32:33], v[38:39], v[30:31] op_sel:[0,0,0] op_sel_hi:[0,1,1] neg_lo:[0,0,1] neg_hi:[0,0,1]
  v_pk_fma_f32 v[26:27], v[32:33], v[30:31], v[36:37] op_sel:[1,0,0] op_sel_hi:[1,1,1] neg_lo:[0,0,1] neg_hi:[0,0,1]
  v_cvt_pk_bf16_f32 v157, v30, v31
  v_cvt_pk_bf16_f32 v158, v38, v39
  v_cvt_pk_bf16_f32 v159, v40, v41
  v_pk_fma_f32 v[38:39], v[32:33], v[26:27], v[24:25] op_sel:[0,0,0] op_sel_hi:[0,1,1] neg_lo:[0,0,1] neg_hi:[0,0,1]
  v_pk_fma_f32 v[34:35], v[32:33], v[24:25], v[28:29] op_sel:[1,0,0] op_sel_hi:[1,1,1] neg_lo:[0,0,1] neg_hi:[0,0,1]
  v_cvt_pk_bf16_f32 v160, v24, v25
  v_pk_fma_f32 v[40:41], v[32:33], v[38:39], v[26:27] op_sel:[0,0,0] op_sel_hi:[0,1,1] neg_lo:[0,0,1] neg_hi:[0,0,1]
  v_pk_fma_f32 v[36:37], v[32:33], v[26:27], v[30:31] op_sel:[1,0,0] op_sel_hi:[1,1,1] neg_lo:[0,0,1] neg_hi:[0,0,1]
  v_cvt_pk_bf16_f32 v161, v26, v27
  v_cvt_pk_bf16_f32 v162, v38, v39
  v_cvt_pk_bf16_f32 v163, v40, v41
  v_pk_fma_f32 v[38:39], v[32:33], v[36:37], v[34:35] op_sel:[0,0,0] op_sel_hi:[0,1,1] neg_lo:[0,0,1] neg_hi:[0,0,1]
  v_pk_fma_f32 v[28:29], v[32:33], v[34:35], v[24:25] op_sel:[1,0,0] op_sel_hi:[1,1,1] neg_lo:[0,0,1] neg_hi:[0,0,1]
  v_cvt_pk_bf16_f32 v164, v34, v35
  v_pk_fma_f32 v[40:41], v[32:33], v[38:39], v[36:37] op_sel:[0,0,0] op_sel_hi:[0,1,1] neg_lo:[0,0,1] neg_hi:[0,0,1]
  v_pk_fma_f32 v[30:31], v[32:33], v[36:37], v[26:27] op_sel:[1,0,0] op_sel_hi:[1,1,1] neg_lo:[0,0,1] neg_hi:[0,0,1]
  v_cvt_pk_bf16_f32 v165, v36, v37
  v_cvt_pk_bf16_f32 v166, v38, v39
  v_cvt_pk_bf16_f32 v167, v40, v41
  v_pk_fma_f32 v[38:39], v[32:33], v[30:31], v[28:29] op_sel:[0,0,0] op_sel_hi:[0,1,1] neg_lo:[0,0,1] neg_hi:[0,0,1]
  v_pk_fma_f32 v[24:25], v[32:33], v[28:29], v[34:35] op_sel:[1,0,0] op_sel_hi:[1,1,1] neg_lo:[0,0,1] neg_hi:[0,0,1]
  v_cvt_pk_bf16_f32 v168, v28, v29
  v_pk_fma_f32 v[40:41], v[32:33], v[38:39], v[30:31] op_sel:[0,0,0] op_sel_hi:[0,1,1] neg_lo:[0,0,1] neg_hi:[0,0,1]
  v_pk_fma_f32 v[26:27], v[32:33], v[30:31], v[36:37] op_sel:[1,0,0] op_sel_hi:[1,1,1] neg_lo:[0,0,1] neg_hi:[0,0,1]
  v_cvt_pk_bf16_f32 v169, v30, v31
  v_cvt_pk_bf16_f32 v170, v38, v39
  v_cvt_pk_bf16_f32 v171, v40, v41
  v_pk_fma_f32 v[38:39], v[32:33], v[26:27], v[24:25] op_sel:[0,0,0] op_sel_hi:[0,1,1] neg_lo:[0,0,1] neg_hi:[0,0,1]
  v_pk_fma_f32 v[34:35], v[32:33], v[24:25], v[28:29] op_sel:[1,0,0] op_sel_hi:[1,1,1] neg_lo:[0,0,1] neg_hi:[0,0,1]
  v_cvt_pk_bf16_f32 v172, v24, v25
  v_pk_fma_f32 v[40:41], v[32:33], v[38:39], v[26:27] op_sel:[0,0,0] op_sel_hi:[0,1,1] neg_lo:[0,0,1] neg_hi:[0,0,1]
  v_pk_fma_f32 v[36:37], v[32:33], v[26:27], v[30:31] op_sel:[1,0,0] op_sel_hi:[1,1,1] neg_lo:[0,0,1] neg_hi:[0,0,1]
  v_cvt_pk_bf16_f32 v173, v26, v27
  v_cvt_pk_bf16_f32 v174, v38, v39
  v_cvt_pk_bf16_f32 v175, v40, v41
  v_pk_fma_f32 v[38:39], v[32:33], v[36:37], v[34:35] op_sel:[0,0,0] op_sel_hi:[0,1,1] neg_lo:[0,0,1] neg_hi:[0,0,1]
  v_pk_fma_f32 v[28:29], v[32:33], v[34:35], v[24:25] op_sel:[1,0,0] op_sel_hi:[1,1,1] neg_lo:[0,0,1] neg_hi:[0,0,1]
  v_cvt_pk_bf16_f32 v176, v34, v35
  v_pk_fma_f32 v[40:41], v[32:33], v[38:39], v[36:37] op_sel:[0,0,0] op_sel_hi:[0,1,1] neg_lo:[0,0,1] neg_hi:[0,0,1]
  v_pk_fma_f32 v[30:31], v[32:33], v[36:37], v[26:27] op_sel:[1,0,0] op_sel_hi:[1,1,1] neg_lo:[0,0,1] neg_hi:[0,0,1]
  v_cvt_pk_bf16_f32 v177, v36, v37
  v_cvt_pk_bf16_f32 v178, v38, v39
  v_cvt_pk_bf16_f32 v179, v40, v41
  v_pk_fma_f32 v[38:39], v[32:33], v[30:31], v[28:29] op_sel:[0,0,0] op_sel_hi:[0,1,1] neg_lo:[0,0,1] neg_hi:[0,0,1]
  v_pk_fma_f32 v[24:25], v[32:33], v[28:29], v[34:35] op_sel:[1,0,0] op_sel_hi:[1,1,1] neg_lo:[0,0,1] neg_hi:[0,0,1]
  v_cvt_pk_bf16_f32 v180, v28, v29
  v_pk_fma_f32 v[40:41], v[32:33], v[38:39], v[30:31] op_sel:[0,0,0] op_sel_hi:[0,1,1] neg_lo:[0,0,1] neg_hi:[0,0,1]
  v_pk_fma_f32 v[26:27], v[32:33], v[30:31], v[36:37] op_sel:[1,0,0] op_sel_hi:[1,1,1] neg_lo:[0,0,1] neg_hi:[0,0,1]
  v_cvt_pk_bf16_f32 v181, v30, v31
  v_cvt_pk_bf16_f32 v182, v38, v39
  v_cvt_pk_bf16_f32 v183, v40, v41
  v_pk_fma_f32 v[38:39], v[32:33], v[26:27], v[24:25] op_sel:[0,0,0] op_sel_hi:[0,1,1] neg_lo:[0,0,1] neg_hi:[0,0,1]
  v_pk_fma_f32 v[34:35], v[32:33], v[24:25], v[28:29] op_sel:[1,0,0] op_sel_hi:[1,1,1] neg_lo:[0,0,1] neg_hi:[0,0,1]
  v_cvt_pk_bf16_f32 v184, v24, v25
  v_pk_fma_f32 v[40:41], v[32:33], v[38:39], v[26:27] op_sel:[0,0,0] op_sel_hi:[0,1,1] neg_lo:[0,0,1] neg_hi:[0,0,1]
  v_pk_fma_f32 v[36:37], v[32:33], v[26:27], v[30:31] op_sel:[1,0,0] op_sel_hi:[1,1,1] neg_lo:[0,0,1] neg_hi:[0,0,1]
  v_cvt_pk_bf16_f32 v185, v26, v27
  v_cvt_pk_bf16_f32 v186, v38, v39
  v_cvt_pk_bf16_f32 v187, v40, v41
  v_pk_fma_f32 v[38:39], v[32:33], v[36:37], v[34:35] op_sel:[0,0,0] op_sel_hi:[0,1,1] neg_lo:[0,0,1] neg_hi:[0,0,1]
  v_pk_fma_f32 v[28:29], v[32:33], v[34:35], v[24:25] op_sel:[1,0,0] op_sel_hi:[1,1,1] neg_lo:[0,0,1] neg_hi:[0,0,1]
  v_cvt_pk_bf16_f32 v188, v34, v35
  v_pk_fma_f32 v[40:41], v[32:33], v[38:39], v[36:37] op_sel:[0,0,0] op_sel_hi:[0,1,1] neg_lo:[0,0,1] neg_hi:[0,0,1]
  v_pk_fma_f32 v[30:31], v[32:33], v[36:37], v[26:27] op_sel:[1,0,0] op_sel_hi:[1,1,1] neg_lo:[0,0,1] neg_hi:[0,0,1]
  v_cvt_pk_bf16_f32 v189, v36, v37
  v_cvt_pk_bf16_f32 v190, v38, v39
  v_cvt_pk_bf16_f32 v191, v40, v41
  v_pk_fma_f32 v[38:39], v[32:33], v[30:31], v[28:29] op_sel:[0,0,0] op_sel_hi:[0,1,1] neg_lo:[0,0,1] neg_hi:[0,0,1]
  v_pk_fma_f32 v[24:25], v[32:33], v[28:29], v[34:35] op_sel:[1,0,0] op_sel_hi:[1,1,1] neg_lo:[0,0,1] neg_hi:[0,0,1]
  v_cvt_pk_bf16_f32 v192, v28, v29
  v_pk_fma_f32 v[40:41], v[32:33], v[38:39], v[30:31] op_sel:[0,0,0] op_sel_hi:[0,1,1] neg_lo:[0,0,1] neg_hi:[0,0,1]
  v_pk_fma_f32 v[26:27], v[32:33], v[30:31], v[36:37] op_sel:[1,0,0] op_sel_hi:[1,1,1] neg_lo:[0,0,1] neg_hi:[0,0,1]
  v_cvt_pk_bf16_f32 v193, v30, v31
  v_cvt_pk_bf16_f32 v194, v38, v39
  v_cvt_pk_bf16_f32 v195, v40, v41
  v_pk_fma_f32 v[38:39], v[32:33], v[26:27], v[24:25] op_sel:[0,0,0] op_sel_hi:[0,1,1] neg_lo:[0,0,1] neg_hi:[0,0,1]
  v_pk_fma_f32 v[34:35], v[32:33], v[24:25], v[28:29] op_sel:[1,0,0] op_sel_hi:[1,1,1] neg_lo:[0,0,1] neg_hi:[0,0,1]
  v_cvt_pk_bf16_f32 v196, v24, v25
  v_pk_fma_f32 v[40:41], v[32:33], v[38:39], v[26:27] op_sel:[0,0,0] op_sel_hi:[0,1,1] neg_lo:[0,0,1] neg_hi:[0,0,1]
  v_pk_fma_f32 v[36:37], v[32:33], v[26:27], v[30:31] op_sel:[1,0,0] op_sel_hi:[1,1,1] neg_lo:[0,0,1] neg_hi:[0,0,1]
  v_cvt_pk_bf16_f32 v197, v26, v27
  v_cvt_pk_bf16_f32 v198, v38, v39
  v_cvt_pk_bf16_f32 v199, v40, v41
  v_pk_fma_f32 v[38:39], v[32:33], v[36:37], v[34:35] op_sel:[0,0,0] op_sel_hi:[0,1,1] neg_lo:[0,0,1] neg_hi:[0,0,1]
  v_pk_fma_f32 v[28:29], v[32:33], v[34:35], v[24:25] op_sel:[1,0,0] op_sel_hi:[1,1,1] neg_lo:[0,0,1] neg_hi:[0,0,1]
  v_cvt_pk_bf16_f32 v200, v34, v35
  v_pk_fma_f32 v[40:41], v[32:33], v[38:39], v[36:37] op_sel:[0,0,0] op_sel_hi:[0,1,1] neg_lo:[0,0,1] neg_hi:[0,0,1]
  v_pk_fma_f32 v[30:31], v[32:33], v[36:37], v[26:27] op_sel:[1,0,0] op_sel_hi:[1,1,1] neg_lo:[0,0,1] neg_hi:[0,0,1]
  v_cvt_pk_bf16_f32 v201, v36, v37
  v_cvt_pk_bf16_f32 v202, v38, v39
  v_cvt_pk_bf16_f32 v203, v40, v41
  v_pk_fma_f32 v[38:39], v[32:33], v[30:31], v[28:29] op_sel:[0,0,0] op_sel_hi:[0,1,1] neg_lo:[0,0,1] neg_hi:[0,0,1]
  v_cvt_pk_bf16_f32 v204, v28, v29
  v_pk_fma_f32 v[40:41], v[32:33], v[38:39], v[30:31] op_sel:[0,0,0] op_sel_hi:[0,1,1] neg_lo:[0,0,1] neg_hi:[0,0,1]
  v_cvt_pk_bf16_f32 v205, v30, v31
  v_cvt_pk_bf16_f32 v206, v38, v39
  v_cvt_pk_bf16_f32 v207, v40, v41
  v_and_b32 v8, 1, v5
  v_lshlrev_b32 v8, 15, v8
  v_xor_b32 v8, 0x3d2b3d2b, v8
  v_cmp_eq_u32 vcc, 0, v3
  s_nop 1
  v_cndmask_b32 v136, v136, v8, vcc
L_fi_back1:
  s_cmp_lg_u32 s26, 7
  s_cbranch_scc1 L_wdone_130
  s_lshl_b32 s48, s45, 14
  s_lshl_b32 s49, s27, 8
  s_add_u32 s48, s48, s49
  s_add_u32 s48, s48, 49152
  v_mov_b32 v4, s48
  s_mov_b32 s48, 0
  s_setprio 3
  s_sleep 4
L_poll_131:
  buffer_load_dword v5, v4, s[28:31], 0 offen sc1
  s_waitcnt vmcnt(0)
  v_cmp_gt_u32 vcc, 4, v5
  s_add_u32 s48, s48, 1
  s_cmp_gt_u32 s48, 60000
  s_cbranch_scc1 L_wdone_130
  s_nop 1
  s_cbranch_vccz L_wdone_130
  s_sleep 4
  s_branch L_poll_131
L_wdone_130:
  s_setprio 0
  s_barrier
  v_lshlrev_b32 v60, 4, v1
  s_mul_i32 s54, s27, 36864
  s_add_u32 s54, s54, s74
  s_add_u32 s50, s26, 0
  s_lshl_b32 s50, s50, 10
  s_mov_b32 m0, s50
  s_add_u32 s50, s50, s54
  buffer_load_dwordx4 v60, s[28:31], s50 offen sc1 lds
  s_add_u32 s50, s26, 8
  s_lshl_b32 s50, s50, 10
  s_mov_b32 m0, s50
  s_add_u32 s50, s50, s54
  buffer_load_dwordx4 v60, s[28:31], s50 offen sc1 lds
  s_add_u32 s50, s26, 16
  s_lshl_b32 s50, s50, 10
  s_mov_b32 m0, s50
  s_add_u32 s50, s50, s54
  buffer_load_dwordx4 v60, s[28:31], s50 offen sc1 lds
  s_add_u32 s50, s26, 24
  s_lshl_b32 s50, s50, 10
  s_mov_b32 m0, s50
  s_add_u32 s50, s50, s54
  buffer_load_dwordx4 v60, s[28:31], s50 offen sc1 lds
  s_cmp_ge_u32 s26, 4
  s_cbranch_scc1 L_tdma_132
  s_add_u32 s50, s26, 32
  s_lshl_b32 s50, s50, 10
  s_mov_b32 m0, s50
  s_add_u32 s50, s50, s54
  buffer_load_dwordx4 v60, s[28:31], s50 offen sc1 lds
L_tdma_132:
  s_and_b32 s50, s26, 1
  v_and_b32 v4, 1, v3
  v_xor_b32 v4, s50, v4
  v_lshlrev_b32 v5, 9, v3
  v_lshl_add_u32 v5, v4, 7, v5
  v_lshl_add_u32 v5, v2, 3, v5
  v_add_u32 v58, 40960, v5
  v_xor_b32 v59, 128, v58
  s_mul_i32 s58, s44, 9
  s_add_u32 s58, s58, 8
  s_mul_i32 s58, s58, 18432
  s_add_u32 s58, s58, 13393920
  s_add_u32 s59, s86, 13393920
  s_waitcnt vmcnt(4)
  s_barrier
  s_cmp_ge_u32 s26, 2
  s_cbranch_scc1 L_p8_noex_133
  ds_read_b64 v[16:17], v58 offset:0
  ds_read_b64 v[18:19], v58 offset:256
  ds_read_b64 v[20:21], v59 offset:0
  ds_read_b64 v[22:23], v59 offset:256
  ds_read_b64 v[24:25], v58 offset:2048
  ds_read_b64 v[26:27], v58 offset:2304
  ds_read_b64 v[28:29], v59 offset:2048
  ds_read_b64 v[30:31], v59 offset:2304
  s_waitcnt lgkmcnt(6)
  v_mfma_f32_16x16x32_bf16 v[40:43], v[64:67], v[16:19], 0
  ds_read_b64 v[32:33], v58 offset:4096
  ds_read_b64 v[34:35], v58 offset:4352
  v_mfma_f32_16x16x32_bf16 v[48:51], v[136:139], v[16:19], 0
  s_waitcnt lgkmcnt(6)
  v_mfma_f32_16x16x32_bf16 v[44:47], v[64:67], v[20:23], 0
  ds_read_b64 v[36:37], v59 offset:4096
  ds_read_b64 v[38:39], v59 offset:4352
  s_add_u32 s50, s58, 0
  buffer_load_dwordx4 v[136:139], v60, s[28:31], s50 offen sc1
  s_add_u32 s50, s59, 11264
  buffer_load_dwordx4 v[64:67], v60, s[28:31], s50 offen sc1
  s_waitcnt lgkmcnt(6)
  v_mfma_f32_16x16x32_bf16 v[40:43], v[68:71], v[24:27], v[40:43]
  ds_read_b64 v[16:17], v58 offset:6144
  ds_read_b64 v[18:19], v58 offset:6400
  v_mfma_f32_16x16x32_bf16 v[48:51], v[140:143], v[24:27], v[48:51]
  s_waitcnt lgkmcnt(6)
  v_mfma_f32_16x16x32_bf16 v[44:47], v[68:71], v[28:31], v[44:47]
  ds_read_b64 v[20:21], v59 offset:6144
  ds_read_b64 v[22:23], v59 offset:6400
  s_add_u32 s50, s58, 1024
  buffer_load_dwordx4 v[140:143], v60, s[28:31], s50 offen sc1
  s_add_u32 s50, s59, 12288
  buffer_load_dwordx4 v[68:71], v60, s[28:31], s50 offen sc1
  s_waitcnt lgkmcnt(6)
  v_mfma_f32_16x16x32_bf16 v[40:43], v[72:75], v[32:35], v[40:43]
  ds_read_b64 v[24:25], v58 offset:8192
  ds_read_b64 v[26:27], v58 offset:8448
  v_mfma_f32_16x16x32_bf16 v[48:51], v[144:147], v[32:35], v[48:51]
  s_waitcnt lgkmcnt(6)
  v_mfma_f32_16x16x32_bf16 v[44:47], v[72:75], v[36:39], v[44:47]
  ds_read_b64 v[28:29], v59 offset:8192
  ds_read_b64 v[30:31], v59 offset:8448
  s_add_u32 s50, s58, 2048
  buffer_load_dwordx4 v[144:147], v60, s[28:31], s50 offen sc1
  s_add_u32 s50, s59, 13312
  buffer_load_dwordx4 v[72:75], v60, s[28:31], s50 offen sc1
  s_waitcnt lgkmcnt(6)
  v_mfma_f32_16x16x32_bf16 v[40:43], v[76:79], v[16:19], v[40:43]
  ds_read_b64 v[32:33], v58 offset:10240
  ds_read_b64 v[34:35], v58 offset:10496
  v_mfma_f32_16x16x32_bf16 v[48:51], v[148:151], v[16:19], v[48:51]
  s_waitcnt lgkmcnt(6)
  v_mfma_f32_16x16x32_bf16 v[44:47], v[76:79], v[20:23], v[44:47]
  ds_read_b64 v[36:37], v59 offset:10240
  ds_read_b64 v[38:39], v59 offset:10496
  s_add_u32 s50, s58, 3072
  buffer_load_dwordx4 v[148:151], v60, s[28:31], s50 offen sc1
  s_add_u32 s50, s59, 14336
  buffer_load_dwordx4 v[76:79], v60, s[28:31], s50 offen sc1
  s_waitcnt lgkmcnt(6)
  v_mfma_f32_16x16x32_bf16 v[40:43], v[80:83], v[24:27], v[40:43]
  ds_read_b64 v[16:17], v58 offset:12288
  ds_read_b64 v[18:19], v58 offset:12544
  v_mfma_f32_16x16x32_bf16 v[48:51], v[152:155], v[24:27], v[48:51]
  s_waitcnt lgkmcnt(6)
  v_mfma_f32_16x16x32_bf16 v[44:47], v[80:83], v[28:31], v[44:47]
  ds_read_b64 v[20:21], v59 offset:12288
  ds_read_b64 v[22:23], v59 offset:12544
  s_add_u32 s50, s58, 4096
  buffer_load_dwordx4 v[152:155], v60, s[28:31], s50 offen sc1
  s_add_u32 s50, s59, 15360
  buffer_load_dwordx4 v[80:83], v60, s[28:31], s50 offen sc1
  s_waitcnt lgkmcnt(6)
  v_mfma_f32_16x16x32_bf16 v[40:43], v[84:87], v[32:35], v[40:43]
  ds_read_b64 v[24:25], v58 offset:14336
  ds_read_b64 v[26:27], v58 offset:14592
  v_mfma_f32_16x16x32_bf16 v[48:51], v[156:159], v[32:35], v[48:51]
  s_waitcnt lgkmcnt(6)
  v_mfma_f32_16x16x32_bf16 v[44:47], v[84:87], v[36:39], v[44:47]
  ds_read_b64 v[28:29], v59 offset:14336
  ds_read_b64 v[30:31], v59 offset:14592
  s_add_u32 s50, s58, 5120
  buffer_load_dwordx4 v[156:159], v60, s[28:31], s50 offen sc1
  s_add_u32 s50, s59, 16384
  buffer_load_dwordx4 v[84:87], v60, s[28:31], s50 offen sc1
  s_waitcnt lgkmcnt(6)
  v_mfma_f32_16x16x32_bf16 v[40:43], v[88:91], v[16:19], v[40:43]
  ds_read_b64 v[32:33], v58 offset:16384
  ds_read_b64 v[34:35], v58 offset:16640
  v_mfma_f32_16x16x32_bf16 v[48:51], v[160:163], v[16:19], v[48:51]
  s_waitcnt lgkmcnt(6)
  v_mfma_f32_16x16x32_bf16 v[44:47], v[88:91], v[20:23], v[44:47]
  ds_read_b64 v[36:37], v59 offset:16384
  ds_read_b64 v[38:39], v59 offset:16640
  s_add_u32 s50, s58, 6144
  buffer_load_dwordx4 v[160:163], v60, s[28:31], s50 offen sc1
  s_add_u32 s50, s59, 17408
  buffer_load_dwordx4 v[88:91], v60, s[28:31], s50 offen sc1
  s_waitcnt lgkmcnt(6)
  v_mfma_f32_16x16x32_bf16 v[40:43], v[92:95], v[24:27], v[40:43]
  ds_read_b64 v[16:17], v58 offset:18432
  ds_read_b64 v[18:19], v58 offset:18688
  v_mfma_f32_16x16x32_bf16 v[48:51], v[164:167], v[24:27], v[48:51]
  s_waitcnt lgkmcnt(6)
  v_mfma_f32_16x16x32_bf16 v[44:47], v[92:95], v[28:31], v[44:47]
  ds_read_b64 v[20:21], v59 offset:18432
  ds_read_b64 v[22:23], v59 offset:18688
  s_add_u32 s50, s58, 7168
  buffer_load_dwordx4 v[164:167], v60, s[28:31], s50 offen sc1
  s_waitcnt lgkmcnt(6)
  v_mfma_f32_16x16x32_bf16 v[40:43], v[96:99], v[32:35], v[40:43]
  ds_read_b64 v[24:25], v58 offset:20480
  ds_read_b64 v[26:27], v58 offset:20736
  v_mfma_f32_16x16x32_bf16 v[48:51], v[168:171], v[32:35], v[48:51]
  s_waitcnt lgkmcnt(6)
  v_mfma_f32_16x16x32_bf16 v[44:47], v[96:99], v[36:39], v[44:47]
  ds_read_b64 v[28:29], v59 offset:20480
  ds_read_b64 v[30:31], v59 offset:20736
  s_add_u32 s50, s58, 8192
  buffer_load_dwordx4 v[168:171], v60, s[28:31], s50 offen sc1
  s_waitcnt lgkmcnt(6)
  v_mfma_f32_16x16x32_bf16 v[40:43], v[100:103], v[16:19], v[40:43]
  ds_read_b64 v[32:33], v58 offset:22528
  ds_read_b64 v[34:35], v58 offset:22784
  v_mfma_f32_16x16x32_bf16 v[48:51], v[172:175], v[16:19], v[48:51]
  s_waitcnt lgkmcnt(6)
  v_mfma_f32_16x16x32_bf16 v[44:47], v[100:103], v[20:23], v[44:47]
  ds_read_b64 v[36:37], v59 offset:22528
  ds_read_b64 v[38:39], v59 offset:22784
  s_add_u32 s50, s58, 9216
  buffer_load_dwordx4 v[172:175], v60, s[28:31], s50 offen sc1
  s_waitcnt lgkmcnt(6)
  v_mfma_f32_16x16x32_bf16 v[40:43], v[104:107], v[24:27], v[40:43]
  ds_read_b64 v[16:17], v58 offset:24576
  ds_read_b64 v[18:19], v58 offset:24832
  v_mfma_f32_16x16x32_bf16 v[48:51], v[176:179], v[24:27], v[48:51]
  s_waitcnt lgkmcnt(6)
  v_mfma_f32_16x16x32_bf16 v[44:47], v[104:107], v[28:31], v[44:47]
  ds_read_b64 v[20:21], v59 offset:24576
  ds_read_b64 v[22:23], v59 offset:24832
  s_add_u32 s50, s58, 10240
  buffer_load_dwordx4 v[176:179], v60, s[28:31], s50 offen sc1
  s_waitcnt lgkmcnt(6)
  v_mfma_f32_16x16x32_bf16 v[40:43], v[108:111], v[32:35], v[40:43]
  ds_read_b64 v[24:25], v58 offset:26624
  ds_read_b64 v[26:27], v58 offset:26880
  v_mfma_f32_16x16x32_bf16 v[48:51], v[180:183], v[32:35], v[48:51]
  s_waitcnt lgkmcnt(6)
  v_mfma_f32_16x16x32_bf16 v[44:47], v[108:111], v[36:39], v[44:47]
  ds_read_b64 v[28:29], v59 offset:26624
  ds_read_b64 v[30:31], v59 offset:26880
  s_add_u32 s50, s58, 11264
  buffer_load_dwordx4 v[180:183], v60, s[28:31], s50 offen sc1
  s_waitcnt lgkmcnt(6)
  v_mfma_f32_16x16x32_bf16 v[40:43], v[112:115], v[16:19], v[40:43]
  ds_read_b64 v[32:33], v58 offset:28672
  ds_read_b64 v[34:35], v58 offset:28928
  v_mfma_f32_16x16x32_bf16 v[48:51], v[184:187], v[16:19], v[48:51]
  s_waitcnt lgkmcnt(6)
  v_mfma_f32_16x16x32_bf16 v[44:47], v[112:115], v[20:23], v[44:47]
  ds_read_b64 v[36:37], v59 offset:28672
  ds_read_b64 v[38:39], v59 offset:28928
  s_add_u32 s50, s58, 12288
  buffer_load_dwordx4 v[184:187], v60, s[28:31], s50 offen sc1
  s_waitcnt lgkmcnt(6)
  v_mfma_f32_16x16x32_bf16 v[40:43], v[116:119], v[24:27], v[40:43]
  ds_read_b64 v[16:17], v58 offset:30720
  ds_read_b64 v[18:19], v58 offset:30976
  v_mfma_f32_16x16x32_bf16 v[48:51], v[188:191], v[24:27], v[48:51]
  s_waitcnt lgkmcnt(6)
  v_mfma_f32_16x16x32_bf16 v[44:47], v[116:119], v[28:31], v[44:47]
  ds_read_b64 v[20:21], v59 offset:30720
  ds_read_b64 v[22:23], v59 offset:30976
  s_add_u32 s50, s58, 13312
  buffer_load_dwordx4 v[188:191], v60, s[28:31], s50 offen sc1
  s_waitcnt lgkmcnt(6)
  v_mfma_f32_16x16x32_bf16 v[40:43], v[120:123], v[32:35], v[40:43]
  ds_read_b64 v[24:25], v58 offset:32768
  ds_read_b64 v[26:27], v58 offset:33024
  v_mfma_f32_16x16x32_bf16 v[48:51], v[192:195], v[32:35], v[48:51]
  s_waitcnt lgkmcnt(6)
  v_mfma_f32_16x16x32_bf16 v[44:47], v[120:123], v[36:39], v[44:47]
  ds_read_b64 v[28:29], v59 offset:32768
  ds_read_b64 v[30:31], v59 offset:33024
  s_add_u32 s50, s58, 14336
  buffer_load_dwordx4 v[192:195], v60, s[28:31], s50 offen sc1
  s_waitcnt lgkmcnt(6)
  v_mfma_f32_16x16x32_bf16 v[40:43], v[124:127], v[16:19], v[40:43]
  ds_read_b64 v[32:33], v58 offset:34816
  ds_read_b64 v[34:35], v58 offset:35072
  v_mfma_f32_16x16x32_bf16 v[48:51], v[196:199], v[16:19], v[48:51]
  s_waitcnt lgkmcnt(6)
  v_mfma_f32_16x16x32_bf16 v[44:47], v[124:127], v[20:23], v[44:47]
  ds_read_b64 v[36:37], v59 offset:34816
  ds_read_b64 v[38:39], v59 offset:35072
  s_add_u32 s50, s58, 15360
  buffer_load_dwordx4 v[196:199], v60, s[28:31], s50 offen sc1
  s_waitcnt lgkmcnt(6)
  v_mfma_f32_16x16x32_bf16 v[40:43], v[128:131], v[24:27], v[40:43]
  v_mfma_f32_16x16x32_bf16 v[48:51], v[200:203], v[24:27], v[48:51]
  s_waitcnt lgkmcnt(4)
  v_mfma_f32_16x16x32_bf16 v[44:47], v[128:131], v[28:31], v[44:47]
  s_add_u32 s50, s58, 16384
  buffer_load_dwordx4 v[200:203], v60, s[28:31], s50 offen sc1
  s_waitcnt lgkmcnt(2)
  v_mfma_f32_16x16x32_bf16 v[40:43], v[132:135], v[32:35], v[40:43]
  v_mfma_f32_16x16x32_bf16 v[48:51], v[204:207], v[32:35], v[48:51]
  s_waitcnt lgkmcnt(0)
  v_mfma_f32_16x16x32_bf16 v[44:47], v[132:135], v[36:39], v[44:47]
  s_add_u32 s50, s58, 17408
  buffer_load_dwordx4 v[204:207], v60, s[28:31], s50 offen sc1
  s_nop 2
  v_cvt_pk_bf16_f32 v52, v40, v41
  v_cvt_pk_bf16_f32 v53, v42, v43
  v_lshlrev_b32 v40, 16, v52
  v_and_b32 v41, 0xffff0000, v52
  v_lshlrev_b32 v42, 16, v53
  v_and_b32 v43, 0xffff0000, v53
  v_cvt_pk_bf16_f32 v52, v44, v45
  v_cvt_pk_bf16_f32 v53, v46, v47
  v_lshlrev_b32 v44, 16, v52
  v_and_b32 v45, 0xffff0000, v52
  v_lshlrev_b32 v46, 16, v53
  v_and_b32 v47, 0xffff0000, v53
  v_cvt_pk_bf16_f32 v52, v48, v49
  v_cvt_pk_bf16_f32 v53, v50, v51
  v_lshlrev_b32 v48, 16, v52
  v_and_b32 v49, 0xffff0000, v52
  v_lshlrev_b32 v50, 16, v53
  v_and_b32 v51, 0xffff0000, v53
  s_and_b32 s50, s26, 1
  s_mul_i32 s50, s50, 18432
  v_lshlrev_b32 v56, 4, v1
  v_add_u32 v57, 18432, v56
  v_subrev_u32 v57, s50, v57
  v_add_u32 v56, s50, v56
  s_waitcnt vmcnt(25)
  s_barrier
  ds_read_b128 v[16:19], v56 offset:0
  ds_read_b128 v[20:23], v57 offset:0
  ds_read_b128 v[24:27], v56 offset:1024
  ds_read_b128 v[28:31], v57 offset:1024
  ds_read_b128 v[32:35], v56 offset:2048
  ds_read_b128 v[36:39], v57 offset:2048
  s_waitcnt vmcnt(24) lgkmcnt(4)
  v_mfma_f32_16x16x32_bf16 v[40:43], v[208:211], v[16:19], v[40:43]
  v_mfma_f32_16x16x32_bf16 v[44:47], v[208:211], v[20:23], v[44:47]
  v_mfma_f32_16x16x32_bf16 v[48:51], v[136:139], v[16:19], v[48:51]
  ds_read_b128 v[16:19], v56 offset:3072
  ds_read_b128 v[20:23], v57 offset:3072
  s_waitcnt vmcnt(22) lgkmcnt(4)
  v_mfma_f32_16x16x32_bf16 v[40:43], v[212:215], v[24:27], v[40:43]
  v_mfma_f32_16x16x32_bf16 v[44:47], v[212:215], v[28:31], v[44:47]
  v_mfma_f32_16x16x32_bf16 v[48:51], v[140:143], v[24:27], v[48:51]
  ds_read_b128 v[24:27], v56 offset:4096
  ds_read_b128 v[28:31], v57 offset:4096
  s_waitcnt vmcnt(20) lgkmcnt(4)
  v_mfma_f32_16x16x32_bf16 v[40:43], v[216:219], v[32:35], v[40:43]
  v_mfma_f32_16x16x32_bf16 v[44:47], v[216:219], v[36:39], v[44:47]
  v_mfma_f32_16x16x32_bf16 v[48:51], v[144:147], v[32:35], v[48:51]
  ds_read_b128 v[32:35], v56 offset:5120
  ds_read_b128 v[36:39], v57 offset:5120
  s_waitcnt vmcnt(18) lgkmcnt(4)
  v_mfma_f32_16x16x32_bf16 v[40:43], v[220:223], v[16:19], v[40:43]
  v_mfma_f32_16x16x32_bf16 v[44:47], v[220:223], v[20:23], v[44:47]
  v_mfma_f32_16x16x32_bf16 v[48:51], v[148:151], v[16:19], v[48:51]
  ds_read_b128 v[16:19], v56 offset:6144
  ds_read_b128 v[20:23], v57 offset:6144
  s_waitcnt vmcnt(16) lgkmcnt(4)
  v_mfma_f32_16x16x32_bf16 v[40:43], v[224:227], v[24:27], v[40:43]
  v_mfma_f32_16x16x32_bf16 v[44:47], v[224:227], v[28:31], v[44:47]
  v_mfma_f32_16x16x32_bf16 v[48:51], v[152:155], v[24:27], v[48:51]
  ds_read_b128 v[24:27], v56 offset:7168
  ds_read_b128 v[28:31], v57 offset:7168
  s_waitcnt vmcnt(14) lgkmcnt(4)
  v_mfma_f32_16x16x32_bf16 v[40:43], v[228:231], v[32:35], v[40:43]
  v_mfma_f32_16x16x32_bf16 v[44:47], v[228:231], v[36:39], v[44:47]
  v_mfma_f32_16x16x32_bf16 v[48:51], v[156:159], v[32:35], v[48:51]
  ds_read_b128 v[32:35], v56 offset:8192
  ds_read_b128 v[36:39], v57 offset:8192
  s_waitcnt vmcnt(12) lgkmcnt(4)
  v_mfma_f32_16x16x32_bf16 v[40:43], v[232:235], v[16:19], v[40:43]
  v_mfma_f32_16x16x32_bf16 v[44:47], v[232:235], v[20:23], v[44:47]
  v_mfma_f32_16x16x32_bf16 v[48:51], v[160:163], v[16:19], v[48:51]
  ds_read_b128 v[16:19], v56 offset:9216
  ds_read_b128 v[20:23], v57 offset:9216
  s_waitcnt vmcnt(10) lgkmcnt(4)
  v_mfma_f32_16x16x32_bf16 v[40:43], v[236:239], v[24:27], v[40:43]
  v_mfma_f32_16x16x32_bf16 v[44:47], v[236:239], v[28:31], v[44:47]
  v_mfma_f32_16x16x32_bf16 v[48:51], v[164:167], v[24:27], v[48:51]
  ds_read_b128 v[24:27], v56 offset:10240
  ds_read_b128 v[28:31], v57 offset:10240
  s_waitcnt vmcnt(9) lgkmcnt(4)
  v_mfma_f32_16x16x32_bf16 v[40:43], v[240:243], v[32:35], v[40:43]
  v_mfma_f32_16x16x32_bf16 v[44:47], v[240:243], v[36:39], v[44:47]
  v_mfma_f32_16x16x32_bf16 v[48:51], v[168:171], v[32:35], v[48:51]
  ds_read_b128 v[32:35], v56 offset:11264
  ds_read_b128 v[36:39], v57 offset:11264
  s_waitcnt vmcnt(8) lgkmcnt(4)
  v_mfma_f32_16x16x32_bf16 v[40:43], v[244:247], v[16:19], v[40:43]
  v_mfma_f32_16x16x32_bf16 v[44:47], v[244:247], v[20:23], v[44:47]
  v_mfma_f32_16x16x32_bf16 v[48:51], v[172:175], v[16:19], v[48:51]
  ds_read_b128 v[16:19], v56 offset:12288
  ds_read_b128 v[20:23], v57 offset:12288
  s_waitcnt vmcnt(7) lgkmcnt(4)
  v_mfma_f32_16x16x32_bf16 v[40:43], v[248:251], v[24:27], v[40:43]
  v_mfma_f32_16x16x32_bf16 v[44:47], v[248:251], v[28:31], v[44:47]
  v_mfma_f32_16x16x32_bf16 v[48:51], v[176:179], v[24:27], v[48:51]
  ds_read_b128 v[24:27], v56 offset:13312
  ds_read_b128 v[28:31], v57 offset:13312
  s_waitcnt vmcnt(6) lgkmcnt(4)
  v_mfma_f32_16x16x32_bf16 v[40:43], v[64:67], v[32:35], v[40:43]
  v_mfma_f32_16x16x32_bf16 v[44:47], v[64:67], v[36:39], v[44:47]
  v_mfma_f32_16x16x32_bf16 v[48:51], v[180:183], v[32:35], v[48:51]
  ds_read_b128 v[32:35], v56 offset:14336
  ds_read_b128 v[36:39], v57 offset:14336
  s_waitcnt vmcnt(5) lgkmcnt(4)
  v_mfma_f32_16x16x32_bf16 v[40:43], v[68:71], v[16:19], v[40:43]
  v_mfma_f32_16x16x32_bf16 v[44:47], v[68:71], v[20:23], v[44:47]
  v_mfma_f32_16x16x32_bf16 v[48:51], v[184:187], v[16:19], v[48:51]
  ds_read_b128 v[16:19], v56 offset:15360
  ds_read_b128 v[20:23], v57 offset:15360
  s_waitcnt vmcnt(4) lgkmcnt(4)
  v_mfma_f32_16x16x32_bf16 v[40:43], v[72:75], v[24:27], v[40:43]
  v_mfma_f32_16x16x32_bf16 v[44:47], v[72:75], v[28:31], v[44:47]
  v_mfma_f32_16x16x32_bf16 v[48:51], v[188:191], v[24:27], v[48:51]
  ds_read_b128 v[24:27], v56 offset:16384
  ds_read_b128 v[28:31], v57 offset:16384
  s_waitcnt vmcnt(3) lgkmcnt(4)
  v_mfma_f32_16x16x32_bf16 v[40:43], v[76:79], v[32:35], v[40:43]
  v_mfma_f32_16x16x32_bf16 v[44:47], v[76:79], v[36:39], v[44:47]
  v_mfma_f32_16x16x32_bf16 v[48:51], v[192:195], v[32:35], v[48:51]
  ds_read_b128 v[32:35], v56 offset:17408
  ds_read_b128 v[36:39], v57 offset:17408
  s_waitcnt vmcnt(2) lgkmcnt(4)
  v_mfma_f32_16x16x32_bf16 v[40:43], v[80:83], v[16:19], v[40:43]
  v_mfma_f32_16x16x32_bf16 v[44:47], v[80:83], v[20:23], v[44:47]
  v_mfma_f32_16x16x32_bf16 v[48:51], v[196:199], v[16:19], v[48:51]
  s_waitcnt vmcnt(1) lgkmcnt(2)
  v_mfma_f32_16x16x32_bf16 v[40:43], v[84:87], v[24:27], v[40:43]
  v_mfma_f32_16x16x32_bf16 v[44:47], v[84:87], v[28:31], v[44:47]
  v_mfma_f32_16x16x32_bf16 v[48:51], v[200:203], v[24:27], v[48:51]
  s_waitcnt vmcnt(0) lgkmcnt(0)
  v_mfma_f32_16x16x32_bf16 v[40:43], v[88:91], v[32:35], v[40:43]
  v_mfma_f32_16x16x32_bf16 v[44:47], v[88:91], v[36:39], v[44:47]
  v_mfma_f32_16x16x32_bf16 v[48:51], v[204:207], v[32:35], v[48:51]
  s_branch L_p8_fin_134
L_p8_noex_133:
  ds_read_b64 v[16:17], v58 offset:0
  ds_read_b64 v[18:19], v58 offset:256
  ds_read_b64 v[20:21], v59 offset:0
  ds_read_b64 v[22:23], v59 offset:256
  ds_read_b64 v[24:25], v58 offset:2048
  ds_read_b64 v[26:27], v58 offset:2304
  ds_read_b64 v[28:29], v59 offset:2048
  ds_read_b64 v[30:31], v59 offset:2304
  s_waitcnt lgkmcnt(6)
  v_mfma_f32_16x16x32_bf16 v[40:43], v[136:139], v[16:19], 0
  ds_read_b64 v[32:33], v58 offset:4096
  ds_read_b64 v[34:35], v58 offset:4352
  s_waitcnt lgkmcnt(6)
  v_mfma_f32_16x16x32_bf16 v[44:47], v[136:139], v[20:23], 0
  ds_read_b64 v[36:37], v59 offset:4096
  ds_read_b64 v[38:39], v59 offset:4352
  s_waitcnt lgkmcnt(6)
  v_mfma_f32_16x16x32_bf16 v[40:43], v[140:143], v[24:27], v[40:43]
  ds_read_b64 v[16:17], v58 offset:6144
  ds_read_b64 v[18:19], v58 offset:6400
  s_waitcnt lgkmcnt(6)
  v_mfma_f32_16x16x32_bf16 v[44:47], v[140:143], v[28:31], v[44:47]
  ds_read_b64 v[20:21], v59 offset:6144
  ds_read_b64 v[22:23], v59 offset:6400
  s_waitcnt lgkmcnt(6)
  v_mfma_f32_16x16x32_bf16 v[40:43], v[144:147], v[32:35], v[40:43]
  ds_read_b64 v[24:25], v58 offset:8192
  ds_read_b64 v[26:27], v58 offset:8448
  s_waitcnt lgkmcnt(6)
  v_mfma_f32_16x16x32_bf16 v[44:47], v[144:147], v[36:39], v[44:47]
  ds_read_b64 v[28:29], v59 offset:8192
  ds_read_b64 v[30:31], v59 offset:8448
  s_waitcnt lgkmcnt(6)
  v_mfma_f32_16x16x32_bf16 v[40:43], v[148:151], v[16:19], v[40:43]
  ds_read_b64 v[32:33], v58 offset:10240
  ds_read_b64 v[34:35], v58 offset:10496
  s_waitcnt lgkmcnt(6)
  v_mfma_f32_16x16x32_bf16 v[44:47], v[148:151], v[20:23], v[44:47]
  ds_read_b64 v[36:37], v59 offset:10240
  ds_read_b64 v[38:39], v59 offset:10496
  s_waitcnt lgkmcnt(6)
  v_mfma_f32_16x16x32_bf16 v[40:43], v[152:155], v[24:27], v[40:43]
  ds_read_b64 v[16:17], v58 offset:12288
  ds_read_b64 v[18:19], v58 offset:12544
  s_waitcnt lgkmcnt(6)
  v_mfma_f32_16x16x32_bf16 v[44:47], v[152:155], v[28:31], v[44:47]
  ds_read_b64 v[20:21], v59 offset:12288
  ds_read_b64 v[22:23], v59 offset:12544
  s_waitcnt lgkmcnt(6)
  v_mfma_f32_16x16x32_bf16 v[40:43], v[156:159], v[32:35], v[40:43]
  ds_read_b64 v[24:25], v58 offset:14336
  ds_read_b64 v[26:27], v58 offset:14592
  s_waitcnt lgkmcnt(6)
  v_mfma_f32_16x16x32_bf16 v[44:47], v[156:159], v[36:39], v[44:47]
  ds_read_b64 v[28:29], v59 offset:14336
  ds_read_b64 v[30:31], v59 offset:14592
  s_waitcnt lgkmcnt(6)
  v_mfma_f32_16x16x32_bf16 v[40:43], v[160:163], v[16:19], v[40:43]
  ds_read_b64 v[32:33], v58 offset:16384
  ds_read_b64 v[34:35], v58 offset:16640
  s_waitcnt lgkmcnt(6)
  v_mfma_f32_16x16x32_bf16 v[44:47], v[160:163], v[20:23], v[44:47]
  ds_read_b64 v[36:37], v59 offset:16384
  ds_read_b64 v[38:39], v59 offset:16640
  s_waitcnt lgkmcnt(6)
  v_mfma_f32_16x16x32_bf16 v[40:43], v[164:167], v[24:27], v[40:43]
  ds_read_b64 v[16:17], v58 offset:18432
  ds_read_b64 v[18:19], v58 offset:18688
  s_waitcnt lgkmcnt(6)
  v_mfma_f32_16x16x32_bf16 v[44:47], v[164:167], v[28:31], v[44:47]
  ds_read_b64 v[20:21], v59 offset:18432
  ds_read_b64 v[22:23], v59 offset:18688
  s_waitcnt lgkmcnt(6)
  v_mfma_f32_16x16x32_bf16 v[40:43], v[168:171], v[32:35], v[40:43]
  ds_read_b64 v[24:25], v58 offset:20480
  ds_read_b64 v[26:27], v58 offset:20736
  s_waitcnt lgkmcnt(6)
  v_mfma_f32_16x16x32_bf16 v[44:47], v[168:171], v[36:39], v[44:47]
  ds_read_b64 v[28:29], v59 offset:20480
  ds_read_b64 v[30:31], v59 offset:20736
  s_waitcnt lgkmcnt(6)
  v_mfma_f32_16x16x32_bf16 v[40:43], v[172:175], v[16:19], v[40:43]
  ds_read_b64 v[32:33], v58 offset:22528
  ds_read_b64 v[34:35], v58 offset:22784
  s_waitcnt lgkmcnt(6)
  v_mfma_f32_16x16x32_bf16 v[44:47], v[172:175], v[20:23], v[44:47]
  ds_read_b64 v[36:37], v59 offset:22528
  ds_read_b64 v[38:39], v59 offset:22784
  s_waitcnt lgkmcnt(6)
  v_mfma_f32_16x16x32_bf16 v[40:43], v[176:179], v[24:27], v[40:43]
  ds_read_b64 v[16:17], v58 offset:24576
  ds_read_b64 v[18:19], v58 offset:24832
  s_waitcnt lgkmcnt(6)
  v_mfma_f32_16x16x32_bf16 v[44:47], v[176:179], v[28:31], v[44:47]
  ds_read_b64 v[20:21], v59 offset:24576
  ds_read_b64 v[22:23], v59 offset:24832
  s_waitcnt lgkmcnt(6)
  v_mfma_f32_16x16x32_bf16 v[40:43], v[180:183], v[32:35], v[40:43]
  ds_read_b64 v[24:25], v58 offset:26624
  ds_read_b64 v[26:27], v58 offset:26880
  s_waitcnt lgkmcnt(6)
  v_mfma_f32_16x16x32_bf16 v[44:47], v[180:183], v[36:39], v[44:47]
  ds_read_b64 v[28:29], v59 offset:26624
  ds_read_b64 v[30:31], v59 offset:26880
  s_waitcnt lgkmcnt(6)
  v_mfma_f32_16x16x32_bf16 v[40:43], v[184:187], v[16:19], v[40:43]
  ds_read_b64 v[32:33], v58 offset:28672
  ds_read_b64 v[34:35], v58 offset:28928
  s_waitcnt lgkmcnt(6)
  v_mfma_f32_16x16x32_bf16 v[44:47], v[184:187], v[20:23], v[44:47]
  ds_read_b64 v[36:37], v59 offset:28672
  ds_read_b64 v[38:39], v59 offset:28928
  s_waitcnt lgkmcnt(6)
  v_mfma_f32_16x16x32_bf16 v[40:43], v[188:191], v[24:27], v[40:43]
  ds_read_b64 v[16:17], v58 offset:30720
  ds_read_b64 v[18:19], v58 offset:30976
  s_waitcnt lgkmcnt(6)
  v_mfma_f32_16x16x32_bf16 v[44:47], v[188:191], v[28:31], v[44:47]
  ds_read_b64 v[20:21], v59 offset:30720
  ds_read_b64 v[22:23], v59 offset:30976
  s_waitcnt lgkmcnt(6)
  v_mfma_f32_16x16x32_bf16 v[40:43], v[192:195], v[32:35], v[40:43]
  ds_read_b64 v[24:25], v58 offset:32768
  ds_read_b64 v[26:27], v58 offset:33024
  s_waitcnt lgkmcnt(6)
  v_mfma_f32_16x16x32_bf16 v[44:47], v[192:195], v[36:39], v[44:47]
  ds_read_b64 v[28:29], v59 offset:32768
  ds_read_b64 v[30:31], v59 offset:33024
  s_waitcnt lgkmcnt(6)
  v_mfma_f32_16x16x32_bf16 v[40:43], v[196:199], v[16:19], v[40:43]
  ds_read_b64 v[32:33], v58 offset:34816
  ds_read_b64 v[34:35], v58 offset:35072
  s_waitcnt lgkmcnt(6)
  v_mfma_f32_16x16x32_bf16 v[44:47], v[196:199], v[20:23], v[44:47]
  ds_read_b64 v[36:37], v59 offset:34816
  ds_read_b64 v[38:39], v59 offset:35072
  s_waitcnt lgkmcnt(6)
  v_mfma_f32_16x16x32_bf16 v[40:43], v[200:203], v[24:27], v[40:43]
  s_waitcnt lgkmcnt(4)
  v_mfma_f32_16x16x32_bf16 v[44:47], v[200:203], v[28:31], v[44:47]
  s_waitcnt lgkmcnt(2)
  v_mfma_f32_16x16x32_bf16 v[40:43], v[204:207], v[32:35], v[40:43]
  s_waitcnt lgkmcnt(0)
  v_mfma_f32_16x16x32_bf16 v[44:47], v[204:207], v[36:39], v[44:47]
  s_nop 5
  v_cvt_pk_bf16_f32 v52, v40, v41
  v_cvt_pk_bf16_f32 v53, v42, v43
  v_lshlrev_b32 v40, 16, v52
  v_and_b32 v41, 0xffff0000, v52
  v_lshlrev_b32 v42, 16, v53
  v_and_b32 v43, 0xffff0000, v53
  v_cvt_pk_bf16_f32 v52, v44, v45
  v_cvt_pk_bf16_f32 v53, v46, v47
  v_lshlrev_b32 v44, 16, v52
  v_and_b32 v45, 0xffff0000, v52
  v_lshlrev_b32 v46, 16, v53
  v_and_b32 v47, 0xffff0000, v53
  s_and_b32 s50, s26, 1
  s_mul_i32 s50, s50, 18432
  v_lshlrev_b32 v56, 4, v1
  v_add_u32 v57, 18432, v56
  v_subrev_u32 v57, s50, v57
  v_add_u32 v56, s50, v56
  s_waitcnt vmcnt(0)
  s_barrier
  ds_read_b128 v[16:19], v56 offset:0
  ds_read_b128 v[20:23], v57 offset:0
  ds_read_b128 v[24:27], v56 offset:1024
  ds_read_b128 v[28:31], v57 offset:1024
  ds_read_b128 v[32:35], v56 offset:2048
  ds_read_b128 v[36:39], v57 offset:2048
  s_waitcnt lgkmcnt(4)
  v_mfma_f32_16x16x32_bf16 v[40:43], v[64:67], v[16:19], v[40:43]
  v_mfma_f32_16x16x32_bf16 v[44:47], v[64:67], v[20:23], v[44:47]
  ds_read_b128 v[16:19], v56 offset:3072
  ds_read_b128 v[20:23], v57 offset:3072
  s_waitcnt lgkmcnt(4)
  v_mfma_f32_16x16x32_bf16 v[40:43], v[68:71], v[24:27], v[40:43]
  v_mfma_f32_16x16x32_bf16 v[44:47], v[68:71], v[28:31], v[44:47]
  ds_read_b128 v[24:27], v56 offset:4096
  ds_read_b128 v[28:31], v57 offset:4096
  s_waitcnt lgkmcnt(4)
  v_mfma_f32_16x16x32_bf16 v[40:43], v[72:75], v[32:35], v[40:43]
  v_mfma_f32_16x16x32_bf16 v[44:47], v[72:75], v[36:39], v[44:47]
  ds_read_b128 v[32:35], v56 offset:5120
  ds_read_b128 v[36:39], v57 offset:5120
  s_waitcnt lgkmcnt(4)
  v_mfma_f32_16x16x32_bf16 v[40:43], v[76:79], v[16:19], v[40:43]
  v_mfma_f32_16x16x32_bf16 v[44:47], v[76:79], v[20:23], v[44:47]
  ds_read_b128 v[16:19], v56 offset:6144
  ds_read_b128 v[20:23], v57 offset:6144
  s_waitcnt lgkmcnt(4)
  v_mfma_f32_16x16x32_bf16 v[40:43], v[80:83], v[24:27], v[40:43]
  v_mfma_f32_16x16x32_bf16 v[44:47], v[80:83], v[28:31], v[44:47]
  ds_read_b128 v[24:27], v56 offset:7168
  ds_read_b128 v[28:31], v57 offset:7168
  s_waitcnt lgkmcnt(4)
  v_mfma_f32_16x16x32_bf16 v[40:43], v[84:87], v[32:35], v[40:43]
  v_mfma_f32_16x16x32_bf16 v[44:47], v[84:87], v[36:39], v[44:47]
  ds_read_b128 v[32:35], v56 offset:8192
  ds_read_b128 v[36:39], v57 offset:8192
  s_waitcnt lgkmcnt(4)
  v_mfma_f32_16x16x32_bf16 v[40:43], v[88:91], v[16:19], v[40:43]
  v_mfma_f32_16x16x32_bf16 v[44:47], v[88:91], v[20:23], v[44:47]
  ds_read_b128 v[16:19], v56 offset:9216
  ds_read_b128 v[20:23], v57 offset:9216
  s_waitcnt lgkmcnt(4)
  v_mfma_f32_16x16x32_bf16 v[40:43], v[92:95], v[24:27], v[40:43]
  v_mfma_f32_16x16x32_bf16 v[44:47], v[92:95], v[28:31], v[44:47]
  ds_read_b128 v[24:27], v56 offset:10240
  ds_read_b128 v[28:31], v57 offset:10240
  s_waitcnt lgkmcnt(4)
  v_mfma_f32_16x16x32_bf16 v[40:43], v[96:99], v[32:35], v[40:43]
  v_mfma_f32_16x16x32_bf16 v[44:47], v[96:99], v[36:39], v[44:47]
  ds_read_b128 v[32:35], v56 offset:11264
  ds_read_b128 v[36:39], v57 offset:11264
  s_waitcnt lgkmcnt(4)
  v_mfma_f32_16x16x32_bf16 v[40:43], v[100:103], v[16:19], v[40:43]
  v_mfma_f32_16x16x32_bf16 v[44:47], v[100:103], v[20:23], v[44:47]
  ds_read_b128 v[16:19], v56 offset:12288
  ds_read_b128 v[20:23], v57 offset:12288
  s_waitcnt lgkmcnt(4)
  v_mfma_f32_16x16x32_bf16 v[40:43], v[104:107], v[24:27], v[40:43]
  v_mfma_f32_16x16x32_bf16 v[44:47], v[104:107], v[28:31], v[44:47]
  ds_read_b128 v[24:27], v56 offset:13312
  ds_read_b128 v[28:31], v57 offset:13312
  s_waitcnt lgkmcnt(4)
  v_mfma_f32_16x16x32_bf16 v[40:43], v[108:111], v[32:35], v[40:43]
  v_mfma_f32_16x16x32_bf16 v[44:47], v[108:111], v[36:39], v[44:47]
  ds_read_b128 v[32:35], v56 offset:14336
  ds_read_b128 v[36:39], v57 offset:14336
  s_waitcnt lgkmcnt(4)
  v_mfma_f32_16x16x32_bf16 v[40:43], v[112:115], v[16:19], v[40:43]
  v_mfma_f32_16x16x32_bf16 v[44:47], v[112:115], v[20:23], v[44:47]
  ds_read_b128 v[16:19], v56 offset:15360
  ds_read_b128 v[20:23], v57 offset:15360
  s_waitcnt lgkmcnt(4)
  v_mfma_f32_16x16x32_bf16 v[40:43], v[116:119], v[24:27], v[40:43]
  v_mfma_f32_16x16x32_bf16 v[44:47], v[116:119], v[28:31], v[44:47]
  ds_read_b128 v[24:27], v56 offset:16384
  ds_read_b128 v[28:31], v57 offset:16384
  s_waitcnt lgkmcnt(4)
  v_mfma_f32_16x16x32_bf16 v[40:43], v[120:123], v[32:35], v[40:43]
  v_mfma_f32_16x16x32_bf16 v[44:47], v[120:123], v[36:39], v[44:47]
  ds_read_b128 v[32:35], v56 offset:17408
  ds_read_b128 v[36:39], v57 offset:17408
  s_waitcnt lgkmcnt(4)
  v_mfma_f32_16x16x32_bf16 v[40:43], v[124:127], v[16:19], v[40:43]
  v_mfma_f32_16x16x32_bf16 v[44:47], v[124:127], v[20:23], v[44:47]
  s_waitcnt lgkmcnt(2)
  v_mfma_f32_16x16x32_bf16 v[40:43], v[128:131], v[24:27], v[40:43]
  v_mfma_f32_16x16x32_bf16 v[44:47], v[128:131], v[28:31], v[44:47]
  s_waitcnt lgkmcnt(0)
  v_mfma_f32_16x16x32_bf16 v[40:43], v[132:135], v[32:35], v[40:43]
  v_mfma_f32_16x16x32_bf16 v[44:47], v[132:135], v[36:39], v[44:47]
L_p8_fin_134:
  s_mov_b32 s32, s20
  s_mov_b32 s33, s21
  s_mov_b32 s34, 2359296
  s_mov_b32 s35, 0x20000
  s_and_b32 s50, s26, 1
  s_lshl_b32 s51, s50, 4
  s_lshl_b32 s52, s27, 5
  s_add_u32 s51, s51, s52
  v_add_u32 v4, s51, v2
  v_xor_b32 v5, 16, v4
  v_mul_u32_u24 v4, 1152, v4
  v_mul_u32_u24 v5, 1152, v5
  v_lshl_add_u32 v4, v3, 3, v4
  v_lshl_add_u32 v5, v3, 3, v5
  s_mul_i32 s53, s44, 288
  s_lshl_b32 s54, s26, 5
  s_add_u32 s54, s54, s53
  s_add_u32 s55, s53, 256
  v_cvt_pk_bf16_f32 v10, v40, v41
  v_cvt_pk_bf16_f32 v11, v42, v43
  buffer_store_dwordx2 v[10:11], v4, s[32:35], s54 offen
  v_cvt_pk_bf16_f32 v12, v44, v45
  v_cvt_pk_bf16_f32 v13, v46, v47
  buffer_store_dwordx2 v[12:13], v5, s[32:35], s54 offen
  s_cmp_ge_u32 s26, 2
  s_cbranch_scc1 L_oe_nx_135
  v_cvt_pk_bf16_f32 v14, v48, v49
  v_cvt_pk_bf16_f32 v15, v50, v51
  buffer_store_dwordx2 v[14:15], v4, s[32:35], s55 offen
L_oe_nx_135:
L_fin:
L_end:
  s_endpgm
L_code_end:
.section .rodata,"a"
.p2align 6
.amdhsa_kernel interleave_layers__spectral_gfnet__grouped_kv_mqa__prompt_kernel
  .amdhsa_next_free_vgpr 256
  .amdhsa_next_free_sgpr 102
  .amdhsa_accum_offset 256
  .amdhsa_group_segment_fixed_size 0
  .amdhsa_kernarg_size 88
  .amdhsa_user_sgpr_count 2
  .amdhsa_user_sgpr_kernarg_segment_ptr 1
  .amdhsa_system_sgpr_workgroup_id_x 1
  .amdhsa_float_denorm_mode_32 3
.end_amdhsa_kernel
```
